```python
import torch

def _softmax(x, axis=-1):
    return torch.softmax(x, dim=axis)
def _gelu(x):
    return torch.nn.functional.gelu(x, approximate="tanh")
def _silu(x):
    return torch.nn.functional.silu(x)
def _sigmoid(x):
    return torch.sigmoid(x)
def _layernorm(x, axis=-1, eps=1e-5):
    m = x.mean(dim=axis, keepdim=True)
    v = x.var(dim=axis, keepdim=True, unbiased=False)
    return (x - m) / torch.sqrt(v + eps)
def _scatter_add(tgt, idx, src, axis=0):
    return tgt.clone().index_add_(axis, idx, src)
def _segment_sum(src, seg, n):
    out = torch.zeros((n,) + src.shape[1:], dtype=src.dtype)
    return out.index_add_(0, seg, src)
def _pad(x, pw):
    flat = tuple(v for pair in reversed(pw) for v in pair)
    return torch.nn.functional.pad(x, flat)

kernel_name = 'standalone__gqa_block_cached__near_ridge'

def setup_inputs():

    _w = (lambda a: (lambda t: t.to(torch.bfloat16) if t.is_floating_point() else t)(torch.as_tensor(a)))
    B, Sq, D = 32, 96, 448
    Hq, Hkv, Sk, Dh = 16, 8, 512, 256
    assert Hq % Hkv == 0, (Hq, Hkv)
    return {
        "x": _w((lambda *s: torch.randn(*s, dtype=torch.bfloat16) * 0.8)(B, Sq, D)),
        "k_cache": _w((lambda *s: torch.randn(*s, dtype=torch.bfloat16) * 0.8)(B, Hkv, Sk, Dh)),
        "v_cache": _w((lambda *s: torch.randn(*s, dtype=torch.bfloat16) * 0.05)(B, Hkv, Sk, Dh)),
        "wq": _w((lambda *s: torch.randn(*s, dtype=torch.bfloat16) * 0.8)(D, Hq * Dh) * (D ** -0.5)),
        "wo": _w((lambda *s: torch.randn(*s, dtype=torch.bfloat16) * 0.05)(Hq * Dh, D) * ((Hq * Dh) ** -0.5)),
    }

def reference(x, k_cache, v_cache, wq, wo):
    B, Sq, D = x.shape
    Hq, Dh = 16, 256
    Hkv = k_cache.shape[1]
    rep = Hq // Hkv
    q = (lambda x, *d: x.permute(*d))((x @ wq).reshape(B, Sq, Hq, Dh), 0, 2, 1, 3)
    k = (lambda x, n, axis: torch.repeat_interleave(x, n, dim=axis))(k_cache, rep, axis=1)
    v = (lambda x, n, axis: torch.repeat_interleave(x, n, dim=axis))(v_cache, rep, axis=1)
    scores = torch.einsum("bhqd,bhkd->bhqk", q, k) * (Dh ** -0.5)
    p = _softmax(scores, axis=-1)
    o = torch.einsum("bhqk,bhkd->bhqd", p, v)
    return (lambda x, *d: x.permute(*d))(o, 0, 2, 1, 3).reshape(B, Sq, Hq * Dh) @ wo
```

```asm
; @launch grid=(256,1,1) block=(256,1,1) lds=163840
.amdgcn_target "amdgcn-amd-amdhsa--gfx950"
.text
.globl standalone__gqa_block_cached__near_ridge_kernel
.p2align 8
.type standalone__gqa_block_cached__near_ridge_kernel,@function
standalone__gqa_block_cached__near_ridge_kernel:
s_cmp_ge_u32 s2, 256
s_cbranch_scc1 L_end
s_load_dwordx8 s[40:47], s[0:1], 0
s_load_dwordx8 s[48:55], s[0:1], 32
s_getpc_b64 s[32:33]
L_pc:
s_mov_b32 s34, L_codeend-L_pc
s_mov_b32 s35, 0x00020000
v_lshlrev_b32 v83, 4, v0
s_lshr_b32 s94, s2, 3
s_lshl_b32 s94, s94, 12
s_add_u32 s94, s94, 4096
buffer_load_dwordx4 a[252:255], v83, s[32:35], 0 offen
buffer_load_dwordx4 a[252:255], v83, s[32:35], s94 offen
v_lshrrev_b32 v1, 6, v0
v_and_b32 v2, 63, v0
v_readfirstlane_b32 s56, v1
s_and_b32 s94, s2, 7
s_lshr_b32 s95, s2, 3
s_lshr_b32 s93, s95, 1
s_lshr_b32 s59, s94, 2
s_lshl_b32 s59, s59, 4
s_add_u32 s59, s59, s93
s_and_b32 s60, s94, 3
s_lshl_b32 s60, s60, 1
s_and_b32 s95, s95, 1
s_add_u32 s60, s60, s95
s_mov_b32 s68, 0
s_lshr_b32 s57, s56, 1
s_and_b32 s58, s56, 1
s_lshl_b32 s61, s56, 10
v_lshrrev_b32 v3, 3, v0
v_bfe_u32 v80, v0, 4, 1
v_bfe_u32 v81, v0, 6, 1
v_lshl_or_b32 v80, v81, 2, v80
v_and_b32 v81, 7, v0
v_xor_b32 v81, v80, v81
v_lshlrev_b32 v5, 13, v3
v_lshl_add_u32 v5, v81, 4, v5
v_lshrrev_b32 v83, 3, v0
v_bfe_u32 v84, v0, 4, 3
v_and_b32 v85, 7, v0
v_xor_b32 v84, v84, v85
v_mul_u32_u24 v83, 896, v83
v_lshl_add_u32 v4, v84, 4, v83
s_waitcnt lgkmcnt(0)
s_mul_i32 s94, s59, 86016
s_lshl_b32 s95, s60, 10
s_add_u32 s8, s46, s95
s_addc_u32 s9, s47, 0
s_mov_b32 s10, 3662848
s_mov_b32 s11, 0x00020000
s_add_u32 s4, s40, s94
s_addc_u32 s5, s41, 0
s_mov_b32 s6, 86016
s_mov_b32 s7, 0x00020000
L_start:
s_and_b32 s67, s60, 1
s_mul_i32 s85, s67, -512
s_mul_i32 s67, s67, 384
s_lshl_b32 s64, s67, 12
s_lshl_b32 s65, s85, 12
s_add_u32 m0, s61, 65536
s_add_u32 s62, s67, 0
buffer_load_dwordx4 v4, s[4:7], s62 offen lds
s_add_u32 m0, s61, 69632
s_add_u32 s62, s67, 28672
buffer_load_dwordx4 v4, s[4:7], s62 offen lds
s_add_u32 m0, s61, 73728
s_add_u32 s62, s67, 57344
buffer_load_dwordx4 v4, s[4:7], s62 offen lds
s_add_u32 m0, s61, 0
s_add_u32 s62, s64, 0
buffer_load_dwordx4 v5, s[8:11], s62 offen lds
s_add_u32 m0, s61, 4096
s_add_u32 s62, s64, 512
buffer_load_dwordx4 v5, s[8:11], s62 offen lds
s_add_u32 m0, s61, 8192
s_add_u32 s62, s64, 262144
buffer_load_dwordx4 v5, s[8:11], s62 offen lds
s_add_u32 m0, s61, 12288
s_add_u32 s62, s64, 262656
buffer_load_dwordx4 v5, s[8:11], s62 offen lds
s_add_u32 m0, s61, 16384
s_add_u32 s62, s64, 524288
buffer_load_dwordx4 v5, s[8:11], s62 offen lds
s_add_u32 m0, s61, 20480
s_add_u32 s62, s64, 524800
buffer_load_dwordx4 v5, s[8:11], s62 offen lds
s_add_u32 m0, s61, 24576
s_add_u32 s62, s64, 786432
buffer_load_dwordx4 v5, s[8:11], s62 offen lds
s_add_u32 m0, s61, 28672
s_add_u32 s62, s64, 786944
buffer_load_dwordx4 v5, s[8:11], s62 offen lds
s_add_u32 m0, s61, 77824
s_add_u32 s62, s67, 128
buffer_load_dwordx4 v4, s[4:7], s62 offen lds
s_add_u32 m0, s61, 81920
s_add_u32 s62, s67, 28800
buffer_load_dwordx4 v4, s[4:7], s62 offen lds
s_add_u32 m0, s61, 86016
s_add_u32 s62, s67, 57472
buffer_load_dwordx4 v4, s[4:7], s62 offen lds
v_lshlrev_b32 v78, 4, v2
v_lshl_add_u32 v78, v1, 13, v78
s_mul_i32 s69, s93, 229376
s_mov_b32 s84, s69
s_add_u32 s69, s84, 0
buffer_load_dwordx4 a[252:255], v5, s[8:11], s69 offen
s_add_u32 s69, s84, 512
buffer_load_dwordx4 a[252:255], v5, s[8:11], s69 offen
s_add_u32 s69, s84, 128
buffer_load_dwordx4 a[252:255], v5, s[8:11], s69 offen
s_add_u32 s69, s84, 640
buffer_load_dwordx4 a[252:255], v5, s[8:11], s69 offen
s_mov_b32 s69, 0
s_lshl_b32 s96, s59, 3
s_add_u32 s96, s96, s60
s_lshl_b32 s96, s96, 18
s_add_u32 s12, s42, s96
s_addc_u32 s13, s43, 0
s_mov_b32 s14, 262144
s_mov_b32 s15, 0x00020000
s_add_u32 s16, s44, s96
s_addc_u32 s17, s45, 0
s_mov_b32 s18, 262144
s_mov_b32 s19, 0x00020000
s_mul_i32 s96, s60, 458752
s_add_u32 s20, s48, s96
s_addc_u32 s21, s49, 0
s_mov_b32 s22, 458752
s_mov_b32 s23, 0x00020000
s_mul_i32 s94, s59, 86016
s_add_u32 s24, s50, s94
s_addc_u32 s25, s51, 0
s_mov_b32 s26, 86016
s_mov_b32 s27, 0x00020000
s_mov_b32 s28, s54
s_mov_b32 s29, s55
s_mov_b32 s30, 67108864
s_mov_b32 s31, 0x00020000
s_mov_b32 s32, s52
s_mov_b32 s33, s53
s_mov_b32 s34, 256
s_mov_b32 s35, 0x00020000
s_lshl_b32 s94, s59, 9
s_add_u32 s94, s94, 67108864
s_add_u32 s36, s54, s94
s_addc_u32 s37, s55, 0
s_mov_b32 s38, 512
s_mov_b32 s39, 0x00020000
v_and_b32 v2, 63, v0
v_and_b32 v83, 15, v2
v_lshrrev_b32 v84, 4, v2
v_lshrrev_b32 v79, 3, v0
v_bfe_u32 v80, v2, 1, 2
v_bfe_u32 v81, v2, 4, 2
v_xor_b32 v81, v80, v81
v_and_b32 v82, 1, v2
v_lshl_or_b32 v81, v81, 1, v82
v_lshlrev_b32 v81, 4, v81
v_lshl_add_u32 v8, v79, 9, v81
v_mul_u32_u24 v9, 896, v79
v_add_u32 v9, v9, v81
s_mul_i32 s96, s58, 48
v_add_u32 v80, s96, v83
v_lshlrev_b32 v80, 7, v80
v_add_u32 v80, 65536, v80
v_lshrrev_b32 v81, 1, v83
v_xor_b32 v81, v81, v84
v_lshl_add_u32 v14, v81, 4, v80
v_xor_b32 v15, 64, v14
v_lshrrev_b32 v80, 5, v2
s_lshl_b32 s95, s56, 1
v_add_u32 v80, s95, v80
v_and_b32 v81, 31, v2
v_xor_b32 v81, v81, v80
v_lshlrev_b32 v81, 4, v81
v_lshl_add_u32 v6, v80, 9, v81
v_xor_b32 v7, 128, v6
v_bfe_u32 v80, v2, 2, 2
v_bfe_u32 v81, v2, 3, 2
v_and_b32 v82, 3, v2
v_lshlrev_b32 v82, 3, v82
v_lshl_add_u32 v85, v84, 3, v80
v_lshlrev_b32 v85, 7, v85
s_lshl_b32 s94, s57, 12
v_add_u32 v85, s94, v85
v_bfe_u32 v86, v2, 3, 1
v_bfe_u32 v87, v2, 4, 1
v_lshl_or_b32 v86, v87, 2, v86
v_and_b32 v87, 3, v2
v_xor_b32 v86, v86, v87
v_lshl_add_u32 v85, v86, 4, v85
v_and_b32 v87, 1, v2
v_lshl_add_u32 v16, v87, 3, v85
v_xor_b32 v17, 8, v16
v_xor_b32 v18, 64, v16
v_xor_b32 v19, 72, v16
s_mov_b32 s98, 0xffff0000
s_mov_b32 s99, 0xffff0000
v_lshl_add_u32 v86, v84, 2, v80
v_lshl_add_u32 v86, v86, 7, v82
s_lshl_b32 s94, s57, 14
s_add_u32 s94, s94, 0
s_lshl_b32 s95, s57, 1
v_add_u32 v87, s94, v86
v_xor_b32 v1, s95, v81
v_lshl_add_u32 v28, v1, 5, v87
v_xor_b32 v29, 32, v28
v_xor_b32 v30, 16384, v28
v_xor_b32 v31, 16416, v28
v_add_u32 v86, 65536, v86
v_xor_b32 v80, 0, v81
v_lshl_add_u32 v24, v80, 5, v86
v_xor_b32 v80, 1, v81
v_lshl_add_u32 v25, v80, 5, v86
v_xor_b32 v80, 2, v81
v_lshl_add_u32 v26, v80, 5, v86
v_xor_b32 v80, 3, v81
v_lshl_add_u32 v27, v80, 5, v86
v_xor_b32 v81, v84, v83
v_lshlrev_b32 v85, 9, v83
v_add_u32 v85, 131072, v85
v_xor_b32 v80, 0, v81
v_lshl_add_u32 v20, v80, 4, v85
v_xor_b32 v80, 4, v81
v_lshl_add_u32 v21, v80, 4, v85
v_xor_b32 v80, 8, v81
v_lshl_add_u32 v22, v80, 4, v85
v_xor_b32 v80, 12, v81
v_lshl_add_u32 v23, v80, 4, v85
v_lshlrev_b32 v80, 4, v2
s_mul_i32 s94, s56, 6144
s_add_u32 s94, s94, 32768
v_add_u32 v10, s94, v80
s_xor_b32 s95, s56, 2
s_mul_i32 s94, s95, 6144
s_add_u32 s94, s94, 32768
v_add_u32 v11, s94, v80
s_mul_i32 s94, s56, 3072
v_add_u32 v12, s94, v80
v_cmp_eq_u32 vcc, 0, v0
v_mov_b32 v80, 2147483632
s_nop 0
v_cndmask_b32 v13, v80, 0, vcc
s_xor_b32 s60, s60, 3
s_add_u32 s94, s60, 1
s_sub_u32 s95, s94, 7
s_cmp_ge_u32 s94, 7
s_cselect_b32 s94, s95, s94
s_sub_u32 s95, s94, 7
s_cmp_ge_u32 s94, 7
s_cselect_b32 s94, s95, s94
s_lshl_b32 s70, s94, 7
s_lshl_b32 s95, s94, 3
s_add_u32 s95, s95, s60
s_lshl_b32 s86, s95, 3
s_mul_i32 s96, s59, 56
s_add_u32 s95, s95, s96
s_mul_i32 s77, s95, 12288
s_add_u32 s94, s60, 2
s_sub_u32 s95, s94, 7
s_cmp_ge_u32 s94, 7
s_cselect_b32 s94, s95, s94
s_sub_u32 s95, s94, 7
s_cmp_ge_u32 s94, 7
s_cselect_b32 s94, s95, s94
s_lshl_b32 s71, s94, 7
s_lshl_b32 s95, s94, 3
s_add_u32 s95, s95, s60
s_lshl_b32 s87, s95, 3
s_mul_i32 s96, s59, 56
s_add_u32 s95, s95, s96
s_mul_i32 s78, s95, 12288
s_add_u32 s94, s60, 3
s_sub_u32 s95, s94, 7
s_cmp_ge_u32 s94, 7
s_cselect_b32 s94, s95, s94
s_sub_u32 s95, s94, 7
s_cmp_ge_u32 s94, 7
s_cselect_b32 s94, s95, s94
s_lshl_b32 s72, s94, 7
s_lshl_b32 s95, s94, 3
s_add_u32 s95, s95, s60
s_lshl_b32 s88, s95, 3
s_mul_i32 s96, s59, 56
s_add_u32 s95, s95, s96
s_mul_i32 s79, s95, 12288
s_add_u32 s94, s60, 4
s_sub_u32 s95, s94, 7
s_cmp_ge_u32 s94, 7
s_cselect_b32 s94, s95, s94
s_sub_u32 s95, s94, 7
s_cmp_ge_u32 s94, 7
s_cselect_b32 s94, s95, s94
s_lshl_b32 s73, s94, 7
s_lshl_b32 s95, s94, 3
s_add_u32 s95, s95, s60
s_lshl_b32 s89, s95, 3
s_mul_i32 s96, s59, 56
s_add_u32 s95, s95, s96
s_mul_i32 s80, s95, 12288
s_add_u32 s94, s60, 5
s_sub_u32 s95, s94, 7
s_cmp_ge_u32 s94, 7
s_cselect_b32 s94, s95, s94
s_sub_u32 s95, s94, 7
s_cmp_ge_u32 s94, 7
s_cselect_b32 s94, s95, s94
s_lshl_b32 s74, s94, 7
s_lshl_b32 s95, s94, 3
s_add_u32 s95, s95, s60
s_lshl_b32 s90, s95, 3
s_mul_i32 s96, s59, 56
s_add_u32 s95, s95, s96
s_mul_i32 s81, s95, 12288
s_add_u32 s94, s60, 6
s_sub_u32 s95, s94, 7
s_cmp_ge_u32 s94, 7
s_cselect_b32 s94, s95, s94
s_sub_u32 s95, s94, 7
s_cmp_ge_u32 s94, 7
s_cselect_b32 s94, s95, s94
s_lshl_b32 s75, s94, 7
s_lshl_b32 s95, s94, 3
s_add_u32 s95, s95, s60
s_lshl_b32 s91, s95, 3
s_mul_i32 s96, s59, 56
s_add_u32 s95, s95, s96
s_mul_i32 s82, s95, 12288
s_add_u32 s94, s60, 7
s_sub_u32 s95, s94, 7
s_cmp_ge_u32 s94, 7
s_cselect_b32 s94, s95, s94
s_sub_u32 s95, s94, 7
s_cmp_ge_u32 s94, 7
s_cselect_b32 s94, s95, s94
s_lshl_b32 s76, s94, 7
s_lshl_b32 s95, s94, 3
s_add_u32 s95, s95, s60
s_lshl_b32 s92, s95, 3
s_mul_i32 s96, s59, 56
s_add_u32 s95, s95, s96
s_mul_i32 s83, s95, 12288
s_mov_b32 s3, 0x800000
s_lshr_b32 s94, s75, 7
s_lshl_b32 s94, 1, s94
s_or_b32 s3, s3, s94
s_lshr_b32 s94, s74, 7
s_lshl_b32 s94, 1, s94
s_or_b32 s3, s3, s94
s_lshr_b32 s94, s73, 7
s_lshl_b32 s94, 1, s94
s_or_b32 s3, s3, s94
s_lshr_b32 s94, s72, 7
s_lshl_b32 s94, 256, s94
s_or_b32 s3, s3, s94
s_lshr_b32 s94, s71, 7
s_lshl_b32 s94, 256, s94
s_or_b32 s3, s3, s94
s_lshr_b32 s94, s70, 7
s_lshl_b32 s94, 65536, s94
s_or_b32 s3, s3, s94
s_cmp_eq_u32 s60, 7
s_cselect_b32 s3, 0, s3
s_mov_b32 s66, 0x3db8aa3b
v_mov_b32 v80, 1065369472
v_accvgpr_write_b32 a248, v80
v_accvgpr_write_b32 a249, v80
v_accvgpr_write_b32 a250, v80
v_accvgpr_write_b32 a251, v80
v_mov_b32 v84, 4286578688
v_mov_b32 v85, 4286578688
v_mov_b32 v86, 4286578688
v_lshlrev_b32 v83, 4, v0
s_add_u32 m0, s61, 32768
s_add_u32 s62, s64, 1048576
buffer_load_dwordx4 v5, s[8:11], s62 offen lds
s_add_u32 m0, s61, 36864
s_add_u32 s62, s64, 1049088
buffer_load_dwordx4 v5, s[8:11], s62 offen lds
s_add_u32 m0, s61, 40960
s_add_u32 s62, s64, 1310720
buffer_load_dwordx4 v5, s[8:11], s62 offen lds
s_add_u32 m0, s61, 45056
s_add_u32 s62, s64, 1311232
buffer_load_dwordx4 v5, s[8:11], s62 offen lds
s_add_u32 m0, s61, 49152
s_add_u32 s62, s64, 1572864
buffer_load_dwordx4 v5, s[8:11], s62 offen lds
s_add_u32 m0, s61, 53248
s_add_u32 s62, s64, 1573376
buffer_load_dwordx4 v5, s[8:11], s62 offen lds
s_add_u32 m0, s61, 57344
s_add_u32 s62, s64, 1835008
buffer_load_dwordx4 v5, s[8:11], s62 offen lds
s_add_u32 m0, s61, 61440
s_add_u32 s62, s64, 1835520
buffer_load_dwordx4 v5, s[8:11], s62 offen lds
s_add_u32 m0, s61, 98304
s_add_u32 s62, s67, 256
buffer_load_dwordx4 v4, s[4:7], s62 offen lds
s_add_u32 m0, s61, 102400
s_add_u32 s62, s67, 28928
buffer_load_dwordx4 v4, s[4:7], s62 offen lds
s_add_u32 m0, s61, 106496
s_add_u32 s62, s67, 57600
buffer_load_dwordx4 v4, s[4:7], s62 offen lds
s_waitcnt vmcnt(15)
s_barrier
ds_read_b128 a[0:3], v14 offset:0
ds_read_b128 a[12:15], v15 offset:0
ds_read_b128 a[24:27], v14 offset:12288
ds_read_b128 a[36:39], v15 offset:12288
ds_read_b64_tr_b16 a[168:169], v16 offset:0
ds_read_b64_tr_b16 a[170:171], v16 offset:512
ds_read_b64_tr_b16 a[172:173], v16 offset:8192
ds_read_b64_tr_b16 a[174:175], v16 offset:8704
ds_read_b64_tr_b16 a[176:177], v16 offset:16384
ds_read_b64_tr_b16 a[178:179], v16 offset:16896
ds_read_b64_tr_b16 a[180:181], v16 offset:24576
ds_read_b64_tr_b16 a[182:183], v16 offset:25088
ds_read_b128 a[4:7], v14 offset:2048
ds_read_b128 a[16:19], v15 offset:2048
ds_read_b128 a[28:31], v14 offset:14336
ds_read_b128 a[40:43], v15 offset:14336
ds_read_b128 a[8:11], v14 offset:4096
ds_read_b128 a[20:23], v15 offset:4096
ds_read_b128 a[32:35], v14 offset:16384
ds_read_b128 a[44:47], v15 offset:16384
v_add_u32 v14, 32768, v14
v_add_u32 v15, 32768, v15
s_waitcnt lgkmcnt(14)
v_mfma_f32_16x16x32_bf16 v[232:235], a[168:171], a[0:3], 0
s_waitcnt lgkmcnt(12)
s_add_u32 m0, s61, 110592
s_add_u32 s62, s67, 384
v_mfma_f32_16x16x32_bf16 v[232:235], a[172:175], a[12:15], v[232:235]
s_waitcnt lgkmcnt(10)
s_add_u32 s63, s67, 29056
ds_read_b64_tr_b16 a[184:185], v17 offset:0
v_mfma_f32_16x16x32_bf16 v[232:235], a[176:179], a[24:27], v[232:235]
s_waitcnt lgkmcnt(9)
ds_read_b64_tr_b16 a[186:187], v17 offset:512
ds_read_b64_tr_b16 a[188:189], v17 offset:8192
v_mfma_f32_16x16x32_bf16 v[232:235], a[180:183], a[36:39], v[232:235]
s_waitcnt lgkmcnt(10)
ds_read_b64_tr_b16 a[190:191], v17 offset:8704
ds_read_b64_tr_b16 a[192:193], v17 offset:16384
v_mfma_f32_16x16x32_bf16 v[236:239], a[168:171], a[4:7], 0
s_waitcnt lgkmcnt(11)
buffer_load_dwordx4 v4, s[4:7], s62 offen lds
v_mfma_f32_16x16x32_bf16 v[236:239], a[172:175], a[16:19], v[236:239]
s_waitcnt lgkmcnt(10)
s_add_u32 m0, s61, 114688
s_add_u32 s62, s67, 57728
v_mfma_f32_16x16x32_bf16 v[236:239], a[176:179], a[28:31], v[236:239]
s_waitcnt lgkmcnt(5)
buffer_load_dwordx4 v4, s[4:7], s63 offen lds
v_mfma_f32_16x16x32_bf16 v[236:239], a[180:183], a[40:43], v[236:239]
s_add_u32 m0, s61, 118784
s_add_u32 s63, s85, 512
v_mfma_f32_16x16x32_bf16 v[240:243], a[168:171], a[8:11], 0
buffer_load_dwordx4 v4, s[4:7], s62 offen lds
v_mfma_f32_16x16x32_bf16 v[240:243], a[172:175], a[20:23], v[240:243]
s_add_u32 m0, s61, 122880
s_add_u32 s62, s85, 29184
v_mfma_f32_16x16x32_bf16 v[240:243], a[176:179], a[32:35], v[240:243]
buffer_load_dwordx4 v4, s[4:7], s63 offen lds
v_mfma_f32_16x16x32_bf16 v[240:243], a[180:183], a[44:47], v[240:243]
s_waitcnt lgkmcnt(0)
s_add_u32 m0, s61, 126976
s_add_u32 s63, s85, 57856
v_mfma_f32_16x16x32_bf16 v[244:247], a[184:187], a[0:3], 0
ds_read_b64_tr_b16 a[194:195], v17 offset:16896
ds_read_b64_tr_b16 a[196:197], v17 offset:24576
v_mfma_f32_16x16x32_bf16 v[244:247], a[188:191], a[12:15], v[244:247]
s_waitcnt lgkmcnt(1)
ds_read_b64_tr_b16 a[198:199], v17 offset:25088
ds_read_b64_tr_b16 a[200:201], v18 offset:0
v_mfma_f32_16x16x32_bf16 v[244:247], a[192:195], a[24:27], v[244:247]
s_waitcnt lgkmcnt(1)
buffer_load_dwordx4 v4, s[4:7], s62 offen lds
v_mfma_f32_16x16x32_bf16 v[244:247], a[196:199], a[36:39], v[244:247]
s_add_u32 m0, s61, 131072
s_add_u32 s62, s85, 640
ds_read_b64_tr_b16 a[202:203], v18 offset:512
v_mfma_f32_16x16x32_bf16 v[248:251], a[184:187], a[4:7], 0
buffer_load_dwordx4 v4, s[4:7], s63 offen lds
v_mfma_f32_16x16x32_bf16 v[248:251], a[188:191], a[16:19], v[248:251]
s_add_u32 m0, s61, 135168
s_add_u32 s63, s85, 29312
ds_read_b64_tr_b16 a[204:205], v18 offset:8192
v_mfma_f32_16x16x32_bf16 v[248:251], a[192:195], a[28:31], v[248:251]
ds_read_b64_tr_b16 a[206:207], v18 offset:8704
ds_read_b64_tr_b16 a[208:209], v18 offset:16384
v_mfma_f32_16x16x32_bf16 v[248:251], a[196:199], a[40:43], v[248:251]
ds_read_b64_tr_b16 a[210:211], v18 offset:16896
ds_read_b64_tr_b16 a[212:213], v18 offset:24576
v_mfma_f32_16x16x32_bf16 v[252:255], a[184:187], a[8:11], 0
ds_read_b64_tr_b16 a[214:215], v18 offset:25088
ds_read_b64_tr_b16 a[216:217], v19 offset:0
v_mfma_f32_16x16x32_bf16 v[252:255], a[188:191], a[20:23], v[252:255]
ds_read_b64_tr_b16 a[218:219], v19 offset:512
ds_read_b64_tr_b16 a[220:221], v19 offset:8192
v_mfma_f32_16x16x32_bf16 v[252:255], a[192:195], a[32:35], v[252:255]
ds_read_b64_tr_b16 a[222:223], v19 offset:8704
ds_read_b64_tr_b16 a[224:225], v19 offset:16384
v_mfma_f32_16x16x32_bf16 v[252:255], a[196:199], a[44:47], v[252:255]
s_waitcnt lgkmcnt(11)
ds_read_b64_tr_b16 a[226:227], v19 offset:16896
ds_read_b64_tr_b16 a[228:229], v19 offset:24576
v_mfma_f32_16x16x32_bf16 v[44:47], a[200:203], a[0:3], 0
s_waitcnt lgkmcnt(11)
ds_read_b64_tr_b16 a[230:231], v19 offset:25088
v_mfma_f32_16x16x32_bf16 v[44:47], a[204:207], a[12:15], v[44:47]
s_waitcnt lgkmcnt(10)
buffer_load_dwordx4 v4, s[4:7], s62 offen lds
v_mfma_f32_16x16x32_bf16 v[44:47], a[208:211], a[24:27], v[44:47]
s_waitcnt lgkmcnt(8)
s_add_u32 m0, s61, 139264
s_add_u32 s62, s85, 57984
v_mfma_f32_16x16x32_bf16 v[44:47], a[212:215], a[36:39], v[44:47]
buffer_load_dwordx4 v4, s[4:7], s63 offen lds
v_mfma_f32_16x16x32_bf16 v[48:51], a[200:203], a[4:7], 0
s_add_u32 m0, s61, 143360
s_add_u32 s63, s65, 2097152
v_mfma_f32_16x16x32_bf16 v[48:51], a[204:207], a[16:19], v[48:51]
buffer_load_dwordx4 v4, s[4:7], s62 offen lds
v_mfma_f32_16x16x32_bf16 v[48:51], a[208:211], a[28:31], v[48:51]
s_waitcnt vmcnt(6) lgkmcnt(0)
s_barrier
s_add_u32 m0, s61, 0
v_mfma_f32_16x16x32_bf16 v[48:51], a[212:215], a[40:43], v[48:51]
s_add_u32 s62, s65, 2097664
buffer_load_dwordx4 v5, s[8:11], s63 offen lds
v_mfma_f32_16x16x32_bf16 v[52:55], a[200:203], a[8:11], 0
s_add_u32 m0, s61, 4096
s_add_u32 s63, s65, 2359296
ds_read_b128 a[48:51], v14 offset:0
v_mfma_f32_16x16x32_bf16 v[52:55], a[204:207], a[20:23], v[52:55]
buffer_load_dwordx4 v5, s[8:11], s62 offen lds
v_mfma_f32_16x16x32_bf16 v[52:55], a[208:211], a[32:35], v[52:55]
s_add_u32 m0, s61, 8192
s_add_u32 s62, s65, 2359808
ds_read_b128 a[60:63], v15 offset:0
v_mfma_f32_16x16x32_bf16 v[52:55], a[212:215], a[44:47], v[52:55]
buffer_load_dwordx4 v5, s[8:11], s63 offen lds
v_mfma_f32_16x16x32_bf16 v[56:59], a[216:219], a[0:3], 0
s_add_u32 m0, s61, 12288
s_add_u32 s63, s65, 2621440
v_mfma_f32_16x16x32_bf16 v[56:59], a[220:223], a[12:15], v[56:59]
buffer_load_dwordx4 v5, s[8:11], s62 offen lds
v_mfma_f32_16x16x32_bf16 v[56:59], a[224:227], a[24:27], v[56:59]
s_add_u32 m0, s61, 16384
s_add_u32 s62, s65, 2621952
v_mfma_f32_16x16x32_bf16 v[56:59], a[228:231], a[36:39], v[56:59]
buffer_load_dwordx4 v5, s[8:11], s63 offen lds
v_mfma_f32_16x16x32_bf16 v[60:63], a[216:219], a[4:7], 0
s_add_u32 m0, s61, 20480
s_add_u32 s63, s65, 2883584
ds_read_b128 a[72:75], v14 offset:12288
v_mfma_f32_16x16x32_bf16 v[60:63], a[220:223], a[16:19], v[60:63]
buffer_load_dwordx4 v5, s[8:11], s62 offen lds
v_mfma_f32_16x16x32_bf16 v[60:63], a[224:227], a[28:31], v[60:63]
s_add_u32 m0, s61, 24576
s_add_u32 s62, s65, 2884096
ds_read_b128 a[84:87], v15 offset:12288
v_mfma_f32_16x16x32_bf16 v[60:63], a[228:231], a[40:43], v[60:63]
buffer_load_dwordx4 v5, s[8:11], s63 offen lds
v_mfma_f32_16x16x32_bf16 v[64:67], a[216:219], a[8:11], 0
s_add_u32 m0, s61, 28672
s_add_u32 s63, s85, 768
ds_read_b128 a[52:55], v14 offset:2048
v_mfma_f32_16x16x32_bf16 v[64:67], a[220:223], a[20:23], v[64:67]
buffer_load_dwordx4 v5, s[8:11], s62 offen lds
v_mfma_f32_16x16x32_bf16 v[64:67], a[224:227], a[32:35], v[64:67]
s_add_u32 m0, s61, 147456
ds_read_b64_tr_b16 a[168:169], v16 offset:32768
ds_read_b64_tr_b16 a[170:171], v16 offset:33280
v_mfma_f32_16x16x32_bf16 v[64:67], a[228:231], a[44:47], v[64:67]
s_waitcnt lgkmcnt(0)
ds_read_b64_tr_b16 a[172:173], v16 offset:40960
ds_read_b64_tr_b16 a[174:175], v16 offset:41472
v_mfma_f32_16x16x32_bf16 v[232:235], a[168:171], a[48:51], v[232:235]
s_waitcnt lgkmcnt(0)
ds_read_b64_tr_b16 a[176:177], v16 offset:49152
ds_read_b64_tr_b16 a[178:179], v16 offset:49664
v_mfma_f32_16x16x32_bf16 v[232:235], a[172:175], a[60:63], v[232:235]
s_waitcnt lgkmcnt(0)
ds_read_b64_tr_b16 a[180:181], v16 offset:57344
ds_read_b64_tr_b16 a[182:183], v16 offset:57856
v_mfma_f32_16x16x32_bf16 v[232:235], a[176:179], a[72:75], v[232:235]
s_waitcnt lgkmcnt(0)
s_add_u32 s62, s85, 29440
ds_read_b128 a[64:67], v15 offset:2048
v_mfma_f32_16x16x32_bf16 v[232:235], a[180:183], a[84:87], v[232:235]
buffer_load_dwordx4 v4, s[4:7], s63 offen lds
v_mfma_f32_16x16x32_bf16 v[236:239], a[168:171], a[52:55], v[236:239]
s_waitcnt lgkmcnt(0)
s_add_u32 m0, s61, 151552
ds_read_b128 a[76:79], v14 offset:14336
v_mfma_f32_16x16x32_bf16 v[236:239], a[172:175], a[64:67], v[236:239]
s_waitcnt lgkmcnt(0)
s_add_u32 s63, s85, 58112
ds_read_b128 a[88:91], v15 offset:14336
v_mfma_f32_16x16x32_bf16 v[236:239], a[176:179], a[76:79], v[236:239]
s_waitcnt lgkmcnt(0)
ds_read_b128 a[56:59], v14 offset:4096
ds_read_b128 a[68:71], v15 offset:4096
v_mfma_f32_16x16x32_bf16 v[236:239], a[180:183], a[88:91], v[236:239]
s_waitcnt lgkmcnt(1)
buffer_load_dwordx4 v4, s[4:7], s62 offen lds
v_mfma_f32_16x16x32_bf16 v[240:243], a[168:171], a[56:59], v[240:243]
s_waitcnt lgkmcnt(0)
s_add_u32 m0, s61, 155648
ds_read_b128 a[80:83], v14 offset:16384
v_mfma_f32_16x16x32_bf16 v[240:243], a[172:175], a[68:71], v[240:243]
s_waitcnt lgkmcnt(0)
s_add_u32 s62, s65, 3145728
ds_read_b128 a[92:95], v15 offset:16384
v_mfma_f32_16x16x32_bf16 v[240:243], a[176:179], a[80:83], v[240:243]
s_waitcnt lgkmcnt(0)
ds_read_b64_tr_b16 a[184:185], v17 offset:32768
ds_read_b64_tr_b16 a[186:187], v17 offset:33280
v_mfma_f32_16x16x32_bf16 v[240:243], a[180:183], a[92:95], v[240:243]
s_waitcnt lgkmcnt(0)
ds_read_b64_tr_b16 a[188:189], v17 offset:40960
ds_read_b64_tr_b16 a[190:191], v17 offset:41472
v_mfma_f32_16x16x32_bf16 v[244:247], a[184:187], a[48:51], v[244:247]
s_waitcnt lgkmcnt(0)
ds_read_b64_tr_b16 a[192:193], v17 offset:49152
ds_read_b64_tr_b16 a[194:195], v17 offset:49664
v_mfma_f32_16x16x32_bf16 v[244:247], a[188:191], a[60:63], v[244:247]
s_waitcnt lgkmcnt(0)
ds_read_b64_tr_b16 a[196:197], v17 offset:57344
ds_read_b64_tr_b16 a[198:199], v17 offset:57856
v_mfma_f32_16x16x32_bf16 v[244:247], a[192:195], a[72:75], v[244:247]
s_waitcnt lgkmcnt(0)
buffer_load_dwordx4 v4, s[4:7], s63 offen lds
v_mfma_f32_16x16x32_bf16 v[244:247], a[196:199], a[84:87], v[244:247]
s_add_u32 m0, s61, 65536
ds_read_b64_tr_b16 a[200:201], v18 offset:32768
ds_read_b64_tr_b16 a[202:203], v18 offset:33280
v_mfma_f32_16x16x32_bf16 v[248:251], a[184:187], a[52:55], v[248:251]
s_add_u32 s63, s65, 3146240
buffer_load_dwordx4 v5, s[8:11], s62 offen lds
v_mfma_f32_16x16x32_bf16 v[248:251], a[188:191], a[64:67], v[248:251]
s_add_u32 m0, s61, 69632
ds_read_b64_tr_b16 a[204:205], v18 offset:40960
ds_read_b64_tr_b16 a[206:207], v18 offset:41472
v_mfma_f32_16x16x32_bf16 v[248:251], a[192:195], a[76:79], v[248:251]
s_add_u32 s62, s65, 3407872
buffer_load_dwordx4 v5, s[8:11], s63 offen lds
v_mfma_f32_16x16x32_bf16 v[248:251], a[196:199], a[88:91], v[248:251]
s_add_u32 m0, s61, 73728
ds_read_b64_tr_b16 a[208:209], v18 offset:49152
ds_read_b64_tr_b16 a[210:211], v18 offset:49664
v_mfma_f32_16x16x32_bf16 v[252:255], a[184:187], a[56:59], v[252:255]
s_add_u32 s63, s65, 3408384
buffer_load_dwordx4 v5, s[8:11], s62 offen lds
v_mfma_f32_16x16x32_bf16 v[252:255], a[188:191], a[68:71], v[252:255]
s_add_u32 m0, s61, 77824
ds_read_b64_tr_b16 a[212:213], v18 offset:57344
ds_read_b64_tr_b16 a[214:215], v18 offset:57856
v_mfma_f32_16x16x32_bf16 v[252:255], a[192:195], a[80:83], v[252:255]
s_add_u32 s62, s64, 128
buffer_load_dwordx4 v5, s[8:11], s63 offen lds
v_mfma_f32_16x16x32_bf16 v[252:255], a[196:199], a[92:95], v[252:255]
s_waitcnt lgkmcnt(6)
ds_read_b64_tr_b16 a[216:217], v19 offset:32768
ds_read_b64_tr_b16 a[218:219], v19 offset:33280
v_mfma_f32_16x16x32_bf16 v[44:47], a[200:203], a[48:51], v[44:47]
s_waitcnt lgkmcnt(6)
ds_read_b64_tr_b16 a[220:221], v19 offset:40960
ds_read_b64_tr_b16 a[222:223], v19 offset:41472
v_mfma_f32_16x16x32_bf16 v[44:47], a[204:207], a[60:63], v[44:47]
s_waitcnt lgkmcnt(6)
ds_read_b64_tr_b16 a[224:225], v19 offset:49152
ds_read_b64_tr_b16 a[226:227], v19 offset:49664
v_mfma_f32_16x16x32_bf16 v[44:47], a[208:211], a[72:75], v[44:47]
s_waitcnt lgkmcnt(6)
ds_read_b64_tr_b16 a[228:229], v19 offset:57344
ds_read_b64_tr_b16 a[230:231], v19 offset:57856
v_mfma_f32_16x16x32_bf16 v[44:47], a[212:215], a[84:87], v[44:47]
s_add_u32 m0, s61, 81920
v_mfma_f32_16x16x32_bf16 v[48:51], a[200:203], a[52:55], v[48:51]
s_add_u32 s63, s64, 640
buffer_load_dwordx4 v5, s[8:11], s62 offen lds
v_mfma_f32_16x16x32_bf16 v[48:51], a[204:207], a[64:67], v[48:51]
s_add_u32 m0, s61, 86016
v_mfma_f32_16x16x32_bf16 v[48:51], a[208:211], a[76:79], v[48:51]
s_add_u32 s62, s64, 262272
buffer_load_dwordx4 v5, s[8:11], s63 offen lds
v_mfma_f32_16x16x32_bf16 v[48:51], a[212:215], a[88:91], v[48:51]
s_add_u32 m0, s61, 90112
v_mfma_f32_16x16x32_bf16 v[52:55], a[200:203], a[56:59], v[52:55]
s_waitcnt vmcnt(6) lgkmcnt(0)
s_barrier
s_add_u32 s63, s64, 262784
v_mfma_f32_16x16x32_bf16 v[52:55], a[204:207], a[68:71], v[52:55]
s_add_u32 s97, s84, 256
buffer_load_dwordx4 v5, s[8:11], s62 offen lds
v_mfma_f32_16x16x32_bf16 v[52:55], a[208:211], a[80:83], v[52:55]
s_add_u32 m0, s61, 94208
buffer_load_dwordx4 a[252:255], v5, s[8:11], s97 offen
v_mfma_f32_16x16x32_bf16 v[52:55], a[212:215], a[92:95], v[52:55]
buffer_load_dwordx4 v5, s[8:11], s63 offen lds
v_mfma_f32_16x16x32_bf16 v[56:59], a[216:219], a[48:51], v[56:59]
ds_read_b128 a[96:99], v14 offset:24576
ds_read_b128 a[108:111], v15 offset:24576
v_mfma_f32_16x16x32_bf16 v[56:59], a[220:223], a[60:63], v[56:59]
ds_read_b128 a[120:123], v14 offset:36864
ds_read_b128 a[132:135], v15 offset:36864
v_mfma_f32_16x16x32_bf16 v[56:59], a[224:227], a[72:75], v[56:59]
ds_read_b128 a[100:103], v14 offset:26624
ds_read_b128 a[112:115], v15 offset:26624
v_mfma_f32_16x16x32_bf16 v[56:59], a[228:231], a[84:87], v[56:59]
s_add_u32 s97, s84, 768
buffer_load_dwordx4 a[252:255], v5, s[8:11], s97 offen
v_mfma_f32_16x16x32_bf16 v[60:63], a[216:219], a[52:55], v[60:63]
s_add_u32 m0, s61, 32768
ds_read_b128 a[124:127], v14 offset:38912
ds_read_b128 a[136:139], v15 offset:38912
v_mfma_f32_16x16x32_bf16 v[60:63], a[220:223], a[64:67], v[60:63]
s_add_u32 s62, s64, 524416
buffer_load_dwordx4 v5, s[8:11], s62 offen lds
v_mfma_f32_16x16x32_bf16 v[60:63], a[224:227], a[76:79], v[60:63]
s_add_u32 m0, s61, 36864
ds_read_b128 a[104:107], v14 offset:28672
ds_read_b128 a[116:119], v15 offset:28672
v_mfma_f32_16x16x32_bf16 v[60:63], a[228:231], a[88:91], v[60:63]
s_add_u32 s63, s64, 524928
buffer_load_dwordx4 v5, s[8:11], s63 offen lds
v_mfma_f32_16x16x32_bf16 v[64:67], a[216:219], a[56:59], v[64:67]
s_add_u32 m0, s61, 40960
ds_read_b128 a[128:131], v14 offset:40960
ds_read_b128 a[140:143], v15 offset:40960
v_mfma_f32_16x16x32_bf16 v[64:67], a[220:223], a[68:71], v[64:67]
s_add_u32 s62, s64, 786560
buffer_load_dwordx4 v5, s[8:11], s62 offen lds
v_mfma_f32_16x16x32_bf16 v[64:67], a[224:227], a[80:83], v[64:67]
s_add_u32 m0, s61, 45056
ds_read_b64_tr_b16 a[168:169], v16 offset:0
ds_read_b64_tr_b16 a[170:171], v16 offset:512
v_mfma_f32_16x16x32_bf16 v[64:67], a[228:231], a[92:95], v[64:67]
s_waitcnt lgkmcnt(0)
ds_read_b64_tr_b16 a[172:173], v16 offset:8192
ds_read_b64_tr_b16 a[174:175], v16 offset:8704
v_mfma_f32_16x16x32_bf16 v[232:235], a[168:171], a[96:99], v[232:235]
s_waitcnt lgkmcnt(0)
ds_read_b64_tr_b16 a[176:177], v16 offset:16384
ds_read_b64_tr_b16 a[178:179], v16 offset:16896
v_mfma_f32_16x16x32_bf16 v[232:235], a[172:175], a[108:111], v[232:235]
s_waitcnt lgkmcnt(0)
ds_read_b64_tr_b16 a[180:181], v16 offset:24576
ds_read_b64_tr_b16 a[182:183], v16 offset:25088
v_mfma_f32_16x16x32_bf16 v[232:235], a[176:179], a[120:123], v[232:235]
s_waitcnt lgkmcnt(0)
ds_read_b64_tr_b16 a[184:185], v17 offset:0
ds_read_b64_tr_b16 a[186:187], v17 offset:512
v_mfma_f32_16x16x32_bf16 v[232:235], a[180:183], a[132:135], v[232:235]
ds_read_b64_tr_b16 a[188:189], v17 offset:8192
ds_read_b64_tr_b16 a[190:191], v17 offset:8704
v_mfma_f32_16x16x32_bf16 v[236:239], a[168:171], a[100:103], v[236:239]
ds_read_b64_tr_b16 a[192:193], v17 offset:16384
ds_read_b64_tr_b16 a[194:195], v17 offset:16896
v_mfma_f32_16x16x32_bf16 v[236:239], a[172:175], a[112:115], v[236:239]
ds_read_b64_tr_b16 a[196:197], v17 offset:24576
ds_read_b64_tr_b16 a[198:199], v17 offset:25088
v_mfma_f32_16x16x32_bf16 v[236:239], a[176:179], a[124:127], v[236:239]
ds_read_b64_tr_b16 a[200:201], v18 offset:0
ds_read_b64_tr_b16 a[202:203], v18 offset:512
v_mfma_f32_16x16x32_bf16 v[236:239], a[180:183], a[136:139], v[236:239]
ds_read_b64_tr_b16 a[204:205], v18 offset:8192
ds_read_b64_tr_b16 a[206:207], v18 offset:8704
v_mfma_f32_16x16x32_bf16 v[240:243], a[168:171], a[104:107], v[240:243]
ds_read_b64_tr_b16 a[208:209], v18 offset:16384
ds_read_b64_tr_b16 a[210:211], v18 offset:16896
v_mfma_f32_16x16x32_bf16 v[240:243], a[172:175], a[116:119], v[240:243]
ds_read_b64_tr_b16 a[212:213], v18 offset:24576
ds_read_b64_tr_b16 a[214:215], v18 offset:25088
v_mfma_f32_16x16x32_bf16 v[240:243], a[176:179], a[128:131], v[240:243]
ds_read_b64_tr_b16 a[216:217], v19 offset:0
ds_read_b64_tr_b16 a[218:219], v19 offset:512
v_mfma_f32_16x16x32_bf16 v[240:243], a[180:183], a[140:143], v[240:243]
s_waitcnt lgkmcnt(12)
ds_read_b64_tr_b16 a[220:221], v19 offset:8192
ds_read_b64_tr_b16 a[222:223], v19 offset:8704
v_mfma_f32_16x16x32_bf16 v[244:247], a[184:187], a[96:99], v[244:247]
ds_read_b64_tr_b16 a[224:225], v19 offset:16384
ds_read_b64_tr_b16 a[226:227], v19 offset:16896
v_mfma_f32_16x16x32_bf16 v[244:247], a[188:191], a[108:111], v[244:247]
ds_read_b64_tr_b16 a[228:229], v19 offset:24576
ds_read_b64_tr_b16 a[230:231], v19 offset:25088
v_mfma_f32_16x16x32_bf16 v[244:247], a[192:195], a[120:123], v[244:247]
s_waitcnt lgkmcnt(12)
ds_read_b128 a[144:147], v14 offset:49152
v_add_u32 v16, 0x10000, v16
v_mfma_f32_16x16x32_bf16 v[244:247], a[196:199], a[132:135], v[244:247]
s_add_u32 s63, s64, 787072
buffer_load_dwordx4 v5, s[8:11], s63 offen lds
v_mfma_f32_16x16x32_bf16 v[248:251], a[184:187], a[100:103], v[248:251]
s_add_u32 m0, s61, 49152
ds_read_b128 a[156:159], v15 offset:49152
v_add_u32 v17, 0x10000, v17
v_mfma_f32_16x16x32_bf16 v[248:251], a[188:191], a[112:115], v[248:251]
s_add_u32 s62, s64, 1048704
buffer_load_dwordx4 v5, s[8:11], s62 offen lds
v_mfma_f32_16x16x32_bf16 v[248:251], a[192:195], a[124:127], v[248:251]
s_add_u32 m0, s61, 53248
ds_read_b128 a[148:151], v14 offset:51200
v_add_u32 v18, 0x10000, v18
v_mfma_f32_16x16x32_bf16 v[248:251], a[196:199], a[136:139], v[248:251]
s_add_u32 s63, s64, 1049216
buffer_load_dwordx4 v5, s[8:11], s63 offen lds
v_mfma_f32_16x16x32_bf16 v[252:255], a[184:187], a[104:107], v[252:255]
s_add_u32 m0, s61, 57344
ds_read_b128 a[160:163], v15 offset:51200
v_add_u32 v19, 0x10000, v19
v_mfma_f32_16x16x32_bf16 v[252:255], a[188:191], a[116:119], v[252:255]
s_add_u32 s62, s64, 1310848
buffer_load_dwordx4 v5, s[8:11], s62 offen lds
v_mfma_f32_16x16x32_bf16 v[252:255], a[192:195], a[128:131], v[252:255]
s_add_u32 m0, s61, 61440
ds_read_b128 a[152:155], v14 offset:53248
ds_read_b128 a[164:167], v15 offset:53248
v_mfma_f32_16x16x32_bf16 v[252:255], a[196:199], a[140:143], v[252:255]
v_mfma_f32_16x16x32_bf16 v[44:47], a[200:203], a[96:99], v[44:47]
v_mfma_f32_16x16x32_bf16 v[44:47], a[204:207], a[108:111], v[44:47]
s_waitcnt lgkmcnt(3)
v_mfma_f32_16x16x32_bf16 v[44:47], a[208:211], a[120:123], v[44:47]
s_waitcnt vmcnt(8) lgkmcnt(0)
s_barrier
v_mfma_f32_16x16x32_bf16 v[44:47], a[212:215], a[132:135], v[44:47]
s_add_u32 s63, s64, 1311360
buffer_load_dwordx4 v5, s[8:11], s63 offen lds
v_mfma_f32_16x16x32_bf16 v[48:51], a[200:203], a[100:103], v[48:51]
s_add_u32 s62, s64, 1572992
ds_read_b64_tr_b16 a[168:169], v16 offset:0
ds_read_b64_tr_b16 a[170:171], v16 offset:512
v_mfma_f32_16x16x32_bf16 v[48:51], a[204:207], a[112:115], v[48:51]
s_add_u32 m0, s61, 0
ds_read_b64_tr_b16 a[172:173], v16 offset:8192
ds_read_b64_tr_b16 a[174:175], v16 offset:8704
v_mfma_f32_16x16x32_bf16 v[48:51], a[208:211], a[124:127], v[48:51]
s_add_u32 s63, s64, 1573504
buffer_load_dwordx4 v5, s[8:11], s62 offen lds
v_mfma_f32_16x16x32_bf16 v[48:51], a[212:215], a[136:139], v[48:51]
s_add_u32 m0, s61, 4096
ds_read_b64_tr_b16 a[176:177], v17 offset:0
ds_read_b64_tr_b16 a[178:179], v17 offset:512
v_mfma_f32_16x16x32_bf16 v[52:55], a[200:203], a[104:107], v[52:55]
s_add_u32 s62, s64, 1835136
buffer_load_dwordx4 v5, s[8:11], s63 offen lds
v_mfma_f32_16x16x32_bf16 v[52:55], a[204:207], a[116:119], v[52:55]
s_add_u32 m0, s61, 8192
ds_read_b64_tr_b16 a[180:181], v17 offset:8192
ds_read_b64_tr_b16 a[182:183], v17 offset:8704
v_mfma_f32_16x16x32_bf16 v[52:55], a[208:211], a[128:131], v[52:55]
s_add_u32 s63, s64, 1835648
buffer_load_dwordx4 v5, s[8:11], s62 offen lds
v_mfma_f32_16x16x32_bf16 v[52:55], a[212:215], a[140:143], v[52:55]
ds_read_b64_tr_b16 a[184:185], v18 offset:0
ds_read_b64_tr_b16 a[186:187], v18 offset:512
v_mfma_f32_16x16x32_bf16 v[56:59], a[216:219], a[96:99], v[56:59]
ds_read_b64_tr_b16 a[188:189], v18 offset:8192
ds_read_b64_tr_b16 a[190:191], v18 offset:8704
v_mfma_f32_16x16x32_bf16 v[56:59], a[220:223], a[108:111], v[56:59]
ds_read_b64_tr_b16 a[192:193], v19 offset:0
ds_read_b64_tr_b16 a[194:195], v19 offset:512
v_mfma_f32_16x16x32_bf16 v[56:59], a[224:227], a[120:123], v[56:59]
ds_read_b64_tr_b16 a[196:197], v19 offset:8192
ds_read_b64_tr_b16 a[198:199], v19 offset:8704
v_mfma_f32_16x16x32_bf16 v[56:59], a[228:231], a[132:135], v[56:59]
s_add_u32 m0, s61, 12288
ds_read_b64_tr_b16 a[200:201], v16 offset:16384
ds_read_b64_tr_b16 a[202:203], v16 offset:16896
v_mfma_f32_16x16x32_bf16 v[60:63], a[216:219], a[100:103], v[60:63]
s_add_u32 s62, s65, 2097280
buffer_load_dwordx4 v5, s[8:11], s63 offen lds
v_mfma_f32_16x16x32_bf16 v[60:63], a[220:223], a[112:115], v[60:63]
s_add_u32 m0, s61, 16384
ds_read_b64_tr_b16 a[204:205], v16 offset:24576
ds_read_b64_tr_b16 a[206:207], v16 offset:25088
v_mfma_f32_16x16x32_bf16 v[60:63], a[224:227], a[124:127], v[60:63]
s_add_u32 s63, s65, 2097792
ds_read_b64_tr_b16 a[208:209], v17 offset:16384
ds_read_b64_tr_b16 a[210:211], v17 offset:16896
v_mfma_f32_16x16x32_bf16 v[60:63], a[228:231], a[136:139], v[60:63]
buffer_load_dwordx4 v5, s[8:11], s62 offen lds
v_mfma_f32_16x16x32_bf16 v[64:67], a[216:219], a[104:107], v[64:67]
s_add_u32 m0, s61, 20480
ds_read_b64_tr_b16 a[212:213], v17 offset:24576
ds_read_b64_tr_b16 a[214:215], v17 offset:25088
v_mfma_f32_16x16x32_bf16 v[64:67], a[220:223], a[116:119], v[64:67]
s_add_u32 s62, s65, 2359424
ds_read_b64_tr_b16 a[216:217], v18 offset:16384
ds_read_b64_tr_b16 a[218:219], v18 offset:16896
v_mfma_f32_16x16x32_bf16 v[64:67], a[224:227], a[128:131], v[64:67]
ds_read_b64_tr_b16 a[220:221], v18 offset:24576
ds_read_b64_tr_b16 a[222:223], v18 offset:25088
v_mfma_f32_16x16x32_bf16 v[64:67], a[228:231], a[140:143], v[64:67]
s_waitcnt lgkmcnt(10)
ds_read_b64_tr_b16 a[224:225], v19 offset:16384
ds_read_b64_tr_b16 a[226:227], v19 offset:16896
v_mfma_f32_16x16x32_bf16 v[232:235], a[168:171], a[144:147], v[232:235]
buffer_load_dwordx4 v5, s[8:11], s63 offen lds
v_mfma_f32_16x16x32_bf16 v[232:235], a[172:175], a[156:159], v[232:235]
ds_read_b64_tr_b16 a[228:229], v19 offset:24576
ds_read_b64_tr_b16 a[230:231], v19 offset:25088
v_mfma_f32_16x16x32_bf16 v[236:239], a[168:171], a[148:151], v[236:239]
v_add_u32 v16, 0xffff8000, v16
v_add_u32 v17, 0xffff8000, v17
v_mfma_f32_16x16x32_bf16 v[236:239], a[172:175], a[160:163], v[236:239]
v_add_u32 v18, 0xffff8000, v18
v_add_u32 v19, 0xffff8000, v19
v_mfma_f32_16x16x32_bf16 v[240:243], a[168:171], a[152:155], v[240:243]
v_mul_f32 v232, s66, v232
v_mul_f32 v233, s66, v233
v_mfma_f32_16x16x32_bf16 v[240:243], a[172:175], a[164:167], v[240:243]
v_mul_f32 v234, s66, v234
v_mul_f32 v235, s66, v235
v_mfma_f32_16x16x32_bf16 v[244:247], a[176:179], a[144:147], v[244:247]
v_mul_f32 v236, s66, v236
v_mul_f32 v237, s66, v237
v_mfma_f32_16x16x32_bf16 v[244:247], a[180:183], a[156:159], v[244:247]
s_waitcnt vmcnt(6) lgkmcnt(0)
s_barrier
s_add_u32 m0, s61, 24576
v_mfma_f32_16x16x32_bf16 v[248:251], a[176:179], a[148:151], v[248:251]
s_add_u32 s63, s65, 2359936
buffer_load_dwordx4 v5, s[8:11], s62 offen lds
v_mfma_f32_16x16x32_bf16 v[248:251], a[180:183], a[160:163], v[248:251]
s_add_u32 m0, s61, 28672
ds_read_b64_tr_b16 a[168:169], v16 offset:0
v_mul_f32 v238, s66, v238
v_mfma_f32_16x16x32_bf16 v[252:255], a[176:179], a[152:155], v[252:255]
s_add_u32 s62, s65, 2621568
buffer_load_dwordx4 v5, s[8:11], s63 offen lds
v_mfma_f32_16x16x32_bf16 v[252:255], a[180:183], a[164:167], v[252:255]
ds_read_b64_tr_b16 a[170:171], v16 offset:512
v_mul_f32 v239, s66, v239
v_mfma_f32_16x16x32_bf16 v[44:47], a[184:187], a[144:147], v[44:47]
ds_read_b64_tr_b16 a[172:173], v16 offset:8192
v_mul_f32 v240, s66, v240
v_mfma_f32_16x16x32_bf16 v[44:47], a[188:191], a[156:159], v[44:47]
s_add_u32 m0, s61, 65536
ds_read_b64_tr_b16 a[174:175], v16 offset:8704
v_mul_f32 v241, s66, v241
v_mfma_f32_16x16x32_bf16 v[48:51], a[184:187], a[148:151], v[48:51]
s_add_u32 s63, s65, 2622080
buffer_load_dwordx4 v5, s[8:11], s62 offen lds
v_mfma_f32_16x16x32_bf16 v[48:51], a[188:191], a[160:163], v[48:51]
s_add_u32 m0, s61, 69632
ds_read_b64_tr_b16 a[176:177], v16 offset:16384
v_mul_f32 v242, s66, v242
v_mfma_f32_16x16x32_bf16 v[52:55], a[184:187], a[152:155], v[52:55]
s_add_u32 s62, s65, 2883712
ds_read_b64_tr_b16 a[178:179], v16 offset:16896
v_mul_f32 v243, s66, v243
v_mfma_f32_16x16x32_bf16 v[52:55], a[188:191], a[164:167], v[52:55]
ds_read_b64_tr_b16 a[180:181], v16 offset:24576
v_mul_f32 v244, s66, v244
v_mfma_f32_16x16x32_bf16 v[56:59], a[192:195], a[144:147], v[56:59]
buffer_load_dwordx4 v5, s[8:11], s63 offen lds
v_mfma_f32_16x16x32_bf16 v[56:59], a[196:199], a[156:159], v[56:59]
s_add_u32 m0, s61, 73728
ds_read_b64_tr_b16 a[182:183], v16 offset:25088
v_mul_f32 v245, s66, v245
v_mfma_f32_16x16x32_bf16 v[60:63], a[192:195], a[148:151], v[60:63]
s_add_u32 s63, s65, 2884224
ds_read_b64_tr_b16 a[184:185], v17 offset:0
v_mul_f32 v246, s66, v246
v_mfma_f32_16x16x32_bf16 v[60:63], a[196:199], a[160:163], v[60:63]
ds_read_b64_tr_b16 a[186:187], v17 offset:512
v_mul_f32 v247, s66, v247
v_mfma_f32_16x16x32_bf16 v[64:67], a[192:195], a[152:155], v[64:67]
buffer_load_dwordx4 v5, s[8:11], s62 offen lds
v_mfma_f32_16x16x32_bf16 v[64:67], a[196:199], a[164:167], v[64:67]
ds_read_b64_tr_b16 a[188:189], v17 offset:8192
v_mul_f32 v248, s66, v248
v_mfma_f32_16x16x32_bf16 v[184:187], a[200:203], a[0:3], 0
ds_read_b64_tr_b16 a[190:191], v17 offset:8704
v_mul_f32 v249, s66, v249
v_mfma_f32_16x16x32_bf16 v[184:187], a[204:207], a[12:15], v[184:187]
s_add_u32 m0, s61, 77824
ds_read_b64_tr_b16 a[192:193], v17 offset:16384
v_mul_f32 v250, s66, v250
v_mfma_f32_16x16x32_bf16 v[188:191], a[200:203], a[4:7], 0
s_add_u32 s62, s65, 3145856
ds_read_b64_tr_b16 a[194:195], v17 offset:16896
v_mul_f32 v251, s66, v251
v_mfma_f32_16x16x32_bf16 v[188:191], a[204:207], a[16:19], v[188:191]
buffer_load_dwordx4 v5, s[8:11], s63 offen lds
v_mfma_f32_16x16x32_bf16 v[192:195], a[200:203], a[8:11], 0
s_add_u32 m0, s61, 81920
ds_read_b64_tr_b16 a[196:197], v17 offset:24576
v_cvt_pk_bf16_f32 v232, v232, v233
v_mfma_f32_16x16x32_bf16 v[192:195], a[204:207], a[20:23], v[192:195]
ds_read_b64_tr_b16 a[198:199], v17 offset:25088
v_cvt_pk_bf16_f32 v234, v234, v235
v_mfma_f32_16x16x32_bf16 v[196:199], a[208:211], a[0:3], 0
ds_read_b64_tr_b16 a[200:201], v18 offset:0
v_mul_f32 v252, s66, v252
v_mfma_f32_16x16x32_bf16 v[196:199], a[212:215], a[12:15], v[196:199]
s_add_u32 s63, s65, 3146368
buffer_load_dwordx4 v5, s[8:11], s62 offen lds
v_mfma_f32_16x16x32_bf16 v[200:203], a[208:211], a[4:7], 0
s_add_u32 m0, s61, 86016
ds_read_b64_tr_b16 a[202:203], v18 offset:512
v_mul_f32 v253, s66, v253
v_mfma_f32_16x16x32_bf16 v[200:203], a[212:215], a[16:19], v[200:203]
s_add_u32 s62, s65, 3408000
ds_read_b64_tr_b16 a[204:205], v18 offset:8192
v_mul_f32 v254, s66, v254
v_mfma_f32_16x16x32_bf16 v[204:207], a[208:211], a[8:11], 0
ds_read_b64_tr_b16 a[206:207], v18 offset:8704
v_mul_f32 v255, s66, v255
v_mfma_f32_16x16x32_bf16 v[204:207], a[212:215], a[20:23], v[204:207]
ds_read_b64_tr_b16 a[208:209], v18 offset:16384
v_cvt_pk_bf16_f32 v236, v236, v237
v_mfma_f32_16x16x32_bf16 v[208:211], a[216:219], a[0:3], 0
buffer_load_dwordx4 v5, s[8:11], s63 offen lds
v_mfma_f32_16x16x32_bf16 v[208:211], a[220:223], a[12:15], v[208:211]
s_add_u32 m0, s61, 90112
ds_read_b64_tr_b16 a[210:211], v18 offset:16896
v_cvt_pk_bf16_f32 v238, v238, v239
v_mfma_f32_16x16x32_bf16 v[212:215], a[216:219], a[4:7], 0
s_add_u32 s63, s65, 3408512
ds_read_b64_tr_b16 a[212:213], v18 offset:24576
v_mul_f32 v44, s66, v44
v_mfma_f32_16x16x32_bf16 v[212:215], a[220:223], a[16:19], v[212:215]
ds_read_b64_tr_b16 a[214:215], v18 offset:25088
v_mul_f32 v45, s66, v45
v_mfma_f32_16x16x32_bf16 v[216:219], a[216:219], a[8:11], 0
ds_read_b64_tr_b16 a[216:217], v19 offset:0
v_mul_f32 v46, s66, v46
v_mfma_f32_16x16x32_bf16 v[216:219], a[220:223], a[20:23], v[216:219]
ds_read_b64_tr_b16 a[218:219], v19 offset:512
v_mul_f32 v47, s66, v47
v_mfma_f32_16x16x32_bf16 v[220:223], a[224:227], a[0:3], 0
ds_read_b64_tr_b16 a[220:221], v19 offset:8192
v_cvt_pk_bf16_f32 v240, v240, v241
v_mfma_f32_16x16x32_bf16 v[220:223], a[228:231], a[12:15], v[220:223]
ds_read_b64_tr_b16 a[222:223], v19 offset:8704
v_cvt_pk_bf16_f32 v242, v242, v243
v_mfma_f32_16x16x32_bf16 v[224:227], a[224:227], a[4:7], 0
buffer_load_dwordx4 v5, s[8:11], s62 offen lds
v_mfma_f32_16x16x32_bf16 v[224:227], a[228:231], a[16:19], v[224:227]
s_add_u32 m0, s61, 94208
v_mul_f32 v48, s66, v48
v_mul_f32 v49, s66, v49
v_mfma_f32_16x16x32_bf16 v[228:231], a[224:227], a[8:11], 0
s_mov_b32 s62, 0
ds_read_b64_tr_b16 a[224:225], v19 offset:16384
v_mul_f32 v50, s66, v50
v_mfma_f32_16x16x32_bf16 v[228:231], a[228:231], a[20:23], v[228:231]
s_waitcnt lgkmcnt(4)
ds_read_b64_tr_b16 a[226:227], v19 offset:16896
v_mul_f32 v51, s66, v51
v_mfma_f32_16x16x32_bf16 v[184:187], a[168:171], a[24:27], v[184:187]
ds_read_b64_tr_b16 a[228:229], v19 offset:24576
v_cvt_pk_bf16_f32 v244, v244, v245
v_mfma_f32_16x16x32_bf16 v[184:187], a[172:175], a[36:39], v[184:187]
ds_read_b64_tr_b16 a[230:231], v19 offset:25088
v_add_u32 v16, 0xffff8000, v16
v_mfma_f32_16x16x32_bf16 v[184:187], a[176:179], a[48:51], v[184:187]
buffer_load_dwordx4 v5, s[8:11], s63 offen lds
v_mfma_f32_16x16x32_bf16 v[184:187], a[180:183], a[60:63], v[184:187]
s_add_u32 m0, s61, 131072
v_add_u32 v17, 0xffff8000, v17
v_add_u32 v18, 0xffff8000, v18
v_mfma_f32_16x16x32_bf16 v[188:191], a[168:171], a[28:31], v[188:191]
s_mov_b32 s63, 4096
buffer_load_dwordx4 v6, s[12:15], s62 offen nt lds
v_mfma_f32_16x16x32_bf16 v[188:191], a[172:175], a[40:43], v[188:191]
s_add_u32 s97, s84, 384
v_add_u32 v19, 0xffff8000, v19
v_cvt_pk_bf16_f32 v246, v246, v247
v_mfma_f32_16x16x32_bf16 v[188:191], a[176:179], a[52:55], v[188:191]
s_add_u32 m0, s61, 135168
v_mul_f32 v52, s66, v52
v_mul_f32 v53, s66, v53
v_mfma_f32_16x16x32_bf16 v[188:191], a[180:183], a[64:67], v[188:191]
s_waitcnt vmcnt(9) lgkmcnt(0)
s_barrier
s_mov_b32 s62, 8192
v_mfma_f32_16x16x32_bf16 v[192:195], a[168:171], a[32:35], v[192:195]
buffer_load_dwordx4 a[252:255], v5, s[8:11], s97 offen
v_mfma_f32_16x16x32_bf16 v[192:195], a[172:175], a[44:47], v[192:195]
s_add_u32 s97, s84, 896
buffer_load_dwordx4 a[252:255], v5, s[8:11], s97 offen
v_mfma_f32_16x16x32_bf16 v[192:195], a[176:179], a[56:59], v[192:195]
ds_read_b64_tr_b16 a[168:169], v16 offset:0
v_mul_f32 v54, s66, v54
v_mfma_f32_16x16x32_bf16 v[192:195], a[180:183], a[68:71], v[192:195]
ds_read_b64_tr_b16 a[170:171], v16 offset:512
v_mul_f32 v55, s66, v55
v_mfma_f32_16x16x32_bf16 v[196:199], a[184:187], a[24:27], v[196:199]
ds_read_b64_tr_b16 a[172:173], v16 offset:8192
v_cvt_pk_bf16_f32 v248, v248, v249
v_mfma_f32_16x16x32_bf16 v[196:199], a[188:191], a[36:39], v[196:199]
ds_read_b64_tr_b16 a[174:175], v16 offset:8704
v_cvt_pk_bf16_f32 v250, v250, v251
v_mfma_f32_16x16x32_bf16 v[196:199], a[192:195], a[48:51], v[196:199]
buffer_load_dwordx4 v7, s[12:15], s63 offen nt lds
v_mfma_f32_16x16x32_bf16 v[196:199], a[196:199], a[60:63], v[196:199]
s_add_u32 m0, s61, 139264
ds_read_b64_tr_b16 a[176:177], v16 offset:16384
v_mul_f32 v56, s66, v56
v_mfma_f32_16x16x32_bf16 v[200:203], a[184:187], a[28:31], v[200:203]
s_mov_b32 s63, 12288
ds_read_b64_tr_b16 a[178:179], v16 offset:16896
v_mul_f32 v57, s66, v57
v_mfma_f32_16x16x32_bf16 v[200:203], a[188:191], a[40:43], v[200:203]
ds_read_b64_tr_b16 a[180:181], v16 offset:24576
v_mul_f32 v58, s66, v58
v_mfma_f32_16x16x32_bf16 v[200:203], a[192:195], a[52:55], v[200:203]
buffer_load_dwordx4 v6, s[12:15], s62 offen nt lds
v_mfma_f32_16x16x32_bf16 v[200:203], a[196:199], a[64:67], v[200:203]
s_add_u32 m0, s61, 143360
ds_read_b64_tr_b16 a[182:183], v16 offset:25088
v_mul_f32 v59, s66, v59
v_mfma_f32_16x16x32_bf16 v[204:207], a[184:187], a[32:35], v[204:207]
s_add_u32 s62, s64, 256
ds_read_b64_tr_b16 a[184:185], v17 offset:0
v_cvt_pk_bf16_f32 v252, v252, v253
v_mfma_f32_16x16x32_bf16 v[204:207], a[188:191], a[44:47], v[204:207]
ds_read_b64_tr_b16 a[186:187], v17 offset:512
v_cvt_pk_bf16_f32 v254, v254, v255
v_mfma_f32_16x16x32_bf16 v[204:207], a[192:195], a[56:59], v[204:207]
ds_read_b64_tr_b16 a[188:189], v17 offset:8192
v_mul_f32 v60, s66, v60
v_mfma_f32_16x16x32_bf16 v[204:207], a[196:199], a[68:71], v[204:207]
buffer_load_dwordx4 v7, s[12:15], s63 offen nt lds
v_mfma_f32_16x16x32_bf16 v[208:211], a[200:203], a[24:27], v[208:211]
ds_read_b64_tr_b16 a[190:191], v17 offset:8704
v_mul_f32 v61, s66, v61
v_mfma_f32_16x16x32_bf16 v[208:211], a[204:207], a[36:39], v[208:211]
ds_read_b64_tr_b16 a[192:193], v17 offset:16384
v_mul_f32 v62, s66, v62
v_mfma_f32_16x16x32_bf16 v[208:211], a[208:211], a[48:51], v[208:211]
ds_read_b64_tr_b16 a[194:195], v17 offset:16896
v_mul_f32 v63, s66, v63
v_mfma_f32_16x16x32_bf16 v[208:211], a[212:215], a[60:63], v[208:211]
s_add_u32 m0, s61, 32768
ds_read_b64_tr_b16 a[196:197], v17 offset:24576
v_cvt_pk_bf16_f32 v44, v44, v45
v_mfma_f32_16x16x32_bf16 v[212:215], a[200:203], a[28:31], v[212:215]
s_add_u32 s63, s64, 768
buffer_load_dwordx4 v5, s[8:11], s62 offen lds
v_mfma_f32_16x16x32_bf16 v[212:215], a[204:207], a[40:43], v[212:215]
s_add_u32 m0, s61, 36864
ds_read_b64_tr_b16 a[198:199], v17 offset:25088
v_cvt_pk_bf16_f32 v46, v46, v47
v_mfma_f32_16x16x32_bf16 v[212:215], a[208:211], a[52:55], v[212:215]
s_add_u32 s62, s64, 262400
v_mul_f32 v64, s66, v64
v_mul_f32 v65, s66, v65
v_mfma_f32_16x16x32_bf16 v[212:215], a[212:215], a[64:67], v[212:215]
v_mul_f32 v66, s66, v66
v_mul_f32 v67, s66, v67
v_mfma_f32_16x16x32_bf16 v[216:219], a[200:203], a[32:35], v[216:219]
buffer_load_dwordx4 v5, s[8:11], s63 offen lds
v_mfma_f32_16x16x32_bf16 v[216:219], a[204:207], a[44:47], v[216:219]
s_add_u32 m0, s61, 40960
ds_read_b64_tr_b16 a[200:201], v18 offset:0
v_cvt_pk_bf16_f32 v48, v48, v49
v_mfma_f32_16x16x32_bf16 v[216:219], a[208:211], a[56:59], v[216:219]
s_add_u32 s63, s64, 262912
ds_read_b64_tr_b16 a[202:203], v18 offset:512
v_cvt_pk_bf16_f32 v50, v50, v51
v_mfma_f32_16x16x32_bf16 v[216:219], a[212:215], a[68:71], v[216:219]
ds_read_b64_tr_b16 a[204:205], v18 offset:8192
v_cndmask_b32 v88, v232, v244, s[98:99]
v_mfma_f32_16x16x32_bf16 v[220:223], a[216:219], a[24:27], v[220:223]
buffer_load_dwordx4 v5, s[8:11], s62 offen lds
v_mfma_f32_16x16x32_bf16 v[220:223], a[220:223], a[36:39], v[220:223]
ds_read_b64_tr_b16 a[206:207], v18 offset:8704
v_cndmask_b32 v90, v244, v232, s[98:99]
v_mfma_f32_16x16x32_bf16 v[220:223], a[224:227], a[48:51], v[220:223]
ds_read_b64_tr_b16 a[208:209], v18 offset:16384
v_cndmask_b32 v89, v234, v246, s[98:99]
v_mfma_f32_16x16x32_bf16 v[220:223], a[228:231], a[60:63], v[220:223]
s_add_u32 m0, s61, 45056
ds_read_b64_tr_b16 a[210:211], v18 offset:16896
v_cndmask_b32 v91, v246, v234, s[98:99]
v_mfma_f32_16x16x32_bf16 v[224:227], a[216:219], a[28:31], v[224:227]
s_add_u32 s62, s64, 524544
ds_read_b64_tr_b16 a[212:213], v18 offset:24576
v_cvt_pk_bf16_f32 v52, v52, v53
v_mfma_f32_16x16x32_bf16 v[224:227], a[220:223], a[40:43], v[224:227]
ds_read_b64_tr_b16 a[214:215], v18 offset:25088
v_cvt_pk_bf16_f32 v54, v54, v55
v_mfma_f32_16x16x32_bf16 v[224:227], a[224:227], a[52:55], v[224:227]
v_cndmask_b32 v92, v236, v248, s[98:99]
v_cndmask_b32 v94, v248, v236, s[98:99]
v_mfma_f32_16x16x32_bf16 v[224:227], a[228:231], a[64:67], v[224:227]
v_cndmask_b32 v93, v238, v250, s[98:99]
v_cndmask_b32 v95, v250, v238, s[98:99]
v_mfma_f32_16x16x32_bf16 v[228:231], a[216:219], a[32:35], v[228:231]
ds_read_b64_tr_b16 a[216:217], v19 offset:0
v_cvt_pk_bf16_f32 v56, v56, v57
v_mfma_f32_16x16x32_bf16 v[228:231], a[220:223], a[44:47], v[228:231]
ds_read_b64_tr_b16 a[218:219], v19 offset:512
v_cvt_pk_bf16_f32 v58, v58, v59
v_mfma_f32_16x16x32_bf16 v[228:231], a[224:227], a[56:59], v[228:231]
ds_read_b64_tr_b16 a[220:221], v19 offset:8192
v_cndmask_b32 v96, v240, v252, s[98:99]
v_mfma_f32_16x16x32_bf16 v[228:231], a[228:231], a[68:71], v[228:231]
s_waitcnt lgkmcnt(4)
ds_read_b64_tr_b16 a[222:223], v19 offset:8704
v_cndmask_b32 v98, v252, v240, s[98:99]
v_mfma_f32_16x16x32_bf16 v[184:187], a[168:171], a[72:75], v[184:187]
ds_read_b64_tr_b16 a[224:225], v19 offset:16384
v_cndmask_b32 v97, v242, v254, s[98:99]
v_mfma_f32_16x16x32_bf16 v[184:187], a[172:175], a[84:87], v[184:187]
ds_read_b64_tr_b16 a[226:227], v19 offset:16896
v_cndmask_b32 v99, v254, v242, s[98:99]
v_mfma_f32_16x16x32_bf16 v[184:187], a[176:179], a[96:99], v[184:187]
ds_read_b64_tr_b16 a[228:229], v19 offset:24576
v_cvt_pk_bf16_f32 v60, v60, v61
v_mfma_f32_16x16x32_bf16 v[184:187], a[180:183], a[108:111], v[184:187]
ds_read_b64_tr_b16 a[230:231], v19 offset:25088
v_cvt_pk_bf16_f32 v62, v62, v63
v_mfma_f32_16x16x32_bf16 v[188:191], a[168:171], a[76:79], v[188:191]
buffer_load_dwordx4 v5, s[8:11], s63 offen lds
v_mfma_f32_16x16x32_bf16 v[188:191], a[172:175], a[88:91], v[188:191]
s_add_u32 m0, s61, 49152
v_cvt_pk_bf16_f32 v64, v64, v65
v_cvt_pk_bf16_f32 v66, v66, v67
v_mfma_f32_16x16x32_bf16 v[188:191], a[176:179], a[100:103], v[188:191]
s_add_u32 s63, s64, 525056
buffer_load_dwordx4 v5, s[8:11], s62 offen lds
v_mfma_f32_16x16x32_bf16 v[188:191], a[180:183], a[112:115], v[188:191]
s_add_u32 m0, s61, 53248
v_cndmask_b32 v100, v44, v56, s[98:99]
v_cndmask_b32 v102, v56, v44, s[98:99]
v_mfma_f32_16x16x32_bf16 v[192:195], a[168:171], a[80:83], v[192:195]
s_add_u32 s62, s64, 786688
v_cndmask_b32 v101, v46, v58, s[98:99]
v_cndmask_b32 v103, v58, v46, s[98:99]
v_mfma_f32_16x16x32_bf16 v[192:195], a[172:175], a[92:95], v[192:195]
s_waitcnt vmcnt(11) lgkmcnt(0)
s_barrier
v_cndmask_b32 v104, v48, v60, s[98:99]
v_mfma_f32_16x16x32_bf16 v[192:195], a[176:179], a[104:107], v[192:195]
v_cndmask_b32 v106, v60, v48, s[98:99]
v_cndmask_b32 v105, v50, v62, s[98:99]
v_mfma_f32_16x16x32_bf16 v[192:195], a[180:183], a[116:119], v[192:195]
v_cndmask_b32 v107, v62, v50, s[98:99]
v_cndmask_b32 v108, v52, v64, s[98:99]
v_mfma_f32_16x16x32_bf16 v[196:199], a[184:187], a[72:75], v[196:199]
buffer_load_dwordx4 v5, s[8:11], s63 offen lds
v_mfma_f32_16x16x32_bf16 v[196:199], a[188:191], a[84:87], v[196:199]
v_cndmask_b32 v110, v64, v52, s[98:99]
v_cndmask_b32 v109, v54, v66, s[98:99]
v_mfma_f32_16x16x32_bf16 v[196:199], a[192:195], a[96:99], v[196:199]
v_add_u32 v16, 0x10000, v16
v_cndmask_b32 v111, v66, v54, s[98:99]
v_mfma_f32_16x16x32_bf16 v[196:199], a[196:199], a[108:111], v[196:199]
s_add_u32 m0, s61, 57344
ds_read_b64_tr_b16 a[168:169], v16 offset:0
v_add_u32 v17, 0x10000, v17
v_mfma_f32_16x16x32_bf16 v[200:203], a[184:187], a[76:79], v[200:203]
s_add_u32 s63, s64, 787200
ds_read_b64_tr_b16 a[170:171], v16 offset:512
v_add_u32 v18, 0x10000, v18
v_mfma_f32_16x16x32_bf16 v[200:203], a[188:191], a[88:91], v[200:203]
ds_read_b64_tr_b16 a[172:173], v16 offset:8192
v_add_u32 v19, 0x10000, v19
v_mfma_f32_16x16x32_bf16 v[200:203], a[192:195], a[100:103], v[200:203]
buffer_load_dwordx4 v5, s[8:11], s62 offen lds
v_mfma_f32_16x16x32_bf16 v[200:203], a[196:199], a[112:115], v[200:203]
s_add_u32 m0, s61, 61440
ds_read_b64_tr_b16 a[174:175], v16 offset:8704
v_mfma_f32_16x16x32_bf16 v[204:207], a[184:187], a[80:83], v[204:207]
s_mov_b32 s62, 16384
buffer_load_dwordx4 v5, s[8:11], s63 offen lds
v_mfma_f32_16x16x32_bf16 v[204:207], a[188:191], a[92:95], v[204:207]
s_add_u32 m0, s61, 147456
ds_read_b64_tr_b16 a[176:177], v16 offset:16384
v_mfma_f32_16x16x32_bf16 v[204:207], a[192:195], a[104:107], v[204:207]
s_mov_b32 s63, 20480
buffer_load_dwordx4 v6, s[12:15], s62 offen nt lds
v_mfma_f32_16x16x32_bf16 v[204:207], a[196:199], a[116:119], v[204:207]
ds_read_b64_tr_b16 a[178:179], v16 offset:16896
v_mfma_f32_16x16x32_bf16 v[208:211], a[200:203], a[72:75], v[208:211]
ds_read_b64_tr_b16 a[180:181], v16 offset:24576
v_mfma_f32_16x16x32_bf16 v[208:211], a[204:207], a[84:87], v[208:211]
ds_read_b64_tr_b16 a[182:183], v16 offset:25088
v_mfma_f32_16x16x32_bf16 v[208:211], a[208:211], a[96:99], v[208:211]
ds_read_b64_tr_b16 a[184:185], v17 offset:0
v_mfma_f32_16x16x32_bf16 v[208:211], a[212:215], a[108:111], v[208:211]
s_add_u32 m0, s61, 151552
ds_read_b64_tr_b16 a[186:187], v17 offset:512
v_mfma_f32_16x16x32_bf16 v[212:215], a[200:203], a[76:79], v[212:215]
s_mov_b32 s62, 24576
buffer_load_dwordx4 v7, s[12:15], s63 offen nt lds
v_mfma_f32_16x16x32_bf16 v[212:215], a[204:207], a[88:91], v[212:215]
s_add_u32 m0, s61, 155648
ds_read_b64_tr_b16 a[188:189], v17 offset:8192
v_mfma_f32_16x16x32_bf16 v[212:215], a[208:211], a[100:103], v[212:215]
s_mov_b32 s63, 28672
ds_read_b64_tr_b16 a[190:191], v17 offset:8704
v_mfma_f32_16x16x32_bf16 v[212:215], a[212:215], a[112:115], v[212:215]
buffer_load_dwordx4 v6, s[12:15], s62 offen nt lds
v_mfma_f32_16x16x32_bf16 v[216:219], a[200:203], a[80:83], v[216:219]
s_add_u32 m0, s61, 159744
ds_read_b64_tr_b16 a[192:193], v17 offset:16384
v_mfma_f32_16x16x32_bf16 v[216:219], a[204:207], a[92:95], v[216:219]
s_add_u32 s62, s64, 1048832
ds_read_b64_tr_b16 a[194:195], v17 offset:16896
v_mfma_f32_16x16x32_bf16 v[216:219], a[208:211], a[104:107], v[216:219]
ds_read_b64_tr_b16 a[196:197], v17 offset:24576
v_mfma_f32_16x16x32_bf16 v[216:219], a[212:215], a[116:119], v[216:219]
ds_read_b64_tr_b16 a[198:199], v17 offset:25088
v_mfma_f32_16x16x32_bf16 v[220:223], a[216:219], a[72:75], v[220:223]
buffer_load_dwordx4 v7, s[12:15], s63 offen nt lds
v_mfma_f32_16x16x32_bf16 v[220:223], a[220:223], a[84:87], v[220:223]
ds_read_b64_tr_b16 a[200:201], v18 offset:0
v_mfma_f32_16x16x32_bf16 v[220:223], a[224:227], a[96:99], v[220:223]
ds_read_b64_tr_b16 a[202:203], v18 offset:512
v_mfma_f32_16x16x32_bf16 v[220:223], a[228:231], a[108:111], v[220:223]
s_add_u32 m0, s61, 0
ds_read_b64_tr_b16 a[204:205], v18 offset:8192
v_mfma_f32_16x16x32_bf16 v[224:227], a[216:219], a[76:79], v[224:227]
s_add_u32 s63, s64, 1049344
buffer_load_dwordx4 v5, s[8:11], s62 offen lds
v_mfma_f32_16x16x32_bf16 v[224:227], a[220:223], a[88:91], v[224:227]
s_add_u32 m0, s61, 4096
ds_read_b64_tr_b16 a[206:207], v18 offset:8704
v_mfma_f32_16x16x32_bf16 v[224:227], a[224:227], a[100:103], v[224:227]
s_add_u32 s62, s64, 1310976
ds_read_b64_tr_b16 a[208:209], v18 offset:16384
v_mfma_f32_16x16x32_bf16 v[224:227], a[228:231], a[112:115], v[224:227]
ds_read_b64_tr_b16 a[210:211], v18 offset:16896
v_mfma_f32_16x16x32_bf16 v[228:231], a[216:219], a[80:83], v[228:231]
ds_read_b64_tr_b16 a[212:213], v18 offset:24576
v_mfma_f32_16x16x32_bf16 v[228:231], a[220:223], a[92:95], v[228:231]
buffer_load_dwordx4 v5, s[8:11], s63 offen lds
v_mfma_f32_16x16x32_bf16 v[228:231], a[224:227], a[104:107], v[228:231]
s_add_u32 m0, s61, 8192
ds_read_b64_tr_b16 a[214:215], v18 offset:25088
v_mfma_f32_16x16x32_bf16 v[228:231], a[228:231], a[116:119], v[228:231]
s_waitcnt lgkmcnt(5)
ds_read_b64_tr_b16 a[216:217], v19 offset:0
v_mfma_f32_16x16x32_bf16 v[184:187], a[168:171], a[120:123], v[184:187]
ds_read_b64_tr_b16 a[218:219], v19 offset:512
v_mfma_f32_16x16x32_bf16 v[184:187], a[172:175], a[132:135], v[184:187]
buffer_load_dwordx4 v5, s[8:11], s62 offen lds
v_mfma_f32_16x16x32_bf16 v[184:187], a[176:179], a[144:147], v[184:187]
ds_read_b64_tr_b16 a[220:221], v19 offset:8192
v_mfma_f32_16x16x32_bf16 v[184:187], a[180:183], a[156:159], v[184:187]
s_add_u32 s63, s64, 1311488
ds_read_b64_tr_b16 a[222:223], v19 offset:8704
v_mfma_f32_16x16x32_bf16 v[188:191], a[168:171], a[124:127], v[188:191]
s_add_u32 m0, s61, 12288
ds_read_b64_tr_b16 a[224:225], v19 offset:16384
v_mfma_f32_16x16x32_bf16 v[188:191], a[172:175], a[136:139], v[188:191]
s_add_u32 s62, s64, 1573120
ds_read_b64_tr_b16 a[226:227], v19 offset:16896
v_mfma_f32_16x16x32_bf16 v[188:191], a[176:179], a[148:151], v[188:191]
buffer_load_dwordx4 v5, s[8:11], s63 offen lds
v_mfma_f32_16x16x32_bf16 v[188:191], a[180:183], a[160:163], v[188:191]
s_add_u32 m0, s61, 16384
ds_read_b64_tr_b16 a[228:229], v19 offset:24576
v_mul_f32 v184, s66, v184
v_mfma_f32_16x16x32_bf16 v[192:195], a[168:171], a[128:131], v[192:195]
s_add_u32 s63, s64, 1573632
ds_read_b64_tr_b16 a[230:231], v19 offset:25088
v_add_u32 v16, 0xffff8000, v16
v_mfma_f32_16x16x32_bf16 v[192:195], a[172:175], a[140:143], v[192:195]
v_add_u32 v17, 0xffff8000, v17
v_add_u32 v18, 0xffff8000, v18
v_mfma_f32_16x16x32_bf16 v[192:195], a[176:179], a[152:155], v[192:195]
buffer_load_dwordx4 v5, s[8:11], s62 offen lds
v_mfma_f32_16x16x32_bf16 v[192:195], a[180:183], a[164:167], v[192:195]
v_add_u32 v19, 0xffff8000, v19
v_mul_f32 v185, s66, v185
v_mfma_f32_16x16x32_bf16 v[196:199], a[184:187], a[120:123], v[196:199]
v_mul_f32 v186, s66, v186
v_mul_f32 v187, s66, v187
v_mfma_f32_16x16x32_bf16 v[196:199], a[188:191], a[132:135], v[196:199]
v_mul_f32 v188, s66, v188
v_mul_f32 v189, s66, v189
v_mfma_f32_16x16x32_bf16 v[196:199], a[192:195], a[144:147], v[196:199]
s_waitcnt vmcnt(9) lgkmcnt(0)
s_barrier
v_mfma_f32_16x16x32_bf16 v[196:199], a[196:199], a[156:159], v[196:199]
s_add_u32 m0, s61, 20480
ds_read_b64_tr_b16 a[168:169], v16 offset:0
v_mul_f32 v190, s66, v190
v_mfma_f32_16x16x32_bf16 v[200:203], a[184:187], a[124:127], v[200:203]
s_add_u32 s62, s64, 1835264
buffer_load_dwordx4 v5, s[8:11], s63 offen lds
v_mfma_f32_16x16x32_bf16 v[200:203], a[188:191], a[136:139], v[200:203]
s_add_u32 m0, s61, 24576
ds_read_b64_tr_b16 a[170:171], v16 offset:512
v_mul_f32 v191, s66, v191
v_mfma_f32_16x16x32_bf16 v[200:203], a[192:195], a[148:151], v[200:203]
s_add_u32 s63, s64, 1835776
ds_read_b64_tr_b16 a[172:173], v16 offset:8192
v_mul_f32 v192, s66, v192
v_mfma_f32_16x16x32_bf16 v[200:203], a[196:199], a[160:163], v[200:203]
buffer_load_dwordx4 v5, s[8:11], s62 offen lds
v_mfma_f32_16x16x32_bf16 v[204:207], a[184:187], a[128:131], v[204:207]
s_add_u32 m0, s61, 28672
ds_read_b64_tr_b16 a[174:175], v16 offset:8704
v_mul_f32 v193, s66, v193
v_mfma_f32_16x16x32_bf16 v[204:207], a[188:191], a[140:143], v[204:207]
s_mov_b32 s62, 32768
ds_read_b64_tr_b16 a[176:177], v16 offset:16384
v_mul_f32 v194, s66, v194
v_mfma_f32_16x16x32_bf16 v[204:207], a[192:195], a[152:155], v[204:207]
ds_read_b64_tr_b16 a[178:179], v16 offset:16896
v_mul_f32 v195, s66, v195
v_mfma_f32_16x16x32_bf16 v[204:207], a[196:199], a[164:167], v[204:207]
ds_read_b64_tr_b16 a[180:181], v16 offset:24576
v_cvt_pk_bf16_f32 v184, v184, v185
v_mfma_f32_16x16x32_bf16 v[208:211], a[200:203], a[120:123], v[208:211]
buffer_load_dwordx4 v5, s[8:11], s63 offen lds
v_mfma_f32_16x16x32_bf16 v[208:211], a[204:207], a[132:135], v[208:211]
ds_read_b64_tr_b16 a[182:183], v16 offset:25088
v_cvt_pk_bf16_f32 v186, v186, v187
v_mfma_f32_16x16x32_bf16 v[208:211], a[208:211], a[144:147], v[208:211]
ds_read_b64_tr_b16 a[184:185], v17 offset:0
v_mul_f32 v196, s66, v196
v_mfma_f32_16x16x32_bf16 v[208:211], a[212:215], a[156:159], v[208:211]
s_add_u32 m0, s61, 98304
ds_read_b64_tr_b16 a[186:187], v17 offset:512
v_mul_f32 v197, s66, v197
v_mfma_f32_16x16x32_bf16 v[212:215], a[200:203], a[124:127], v[212:215]
s_mov_b32 s63, 36864
buffer_load_dwordx4 v6, s[12:15], s62 offen nt lds
v_mfma_f32_16x16x32_bf16 v[212:215], a[204:207], a[136:139], v[212:215]
s_add_u32 m0, s61, 102400
ds_read_b64_tr_b16 a[188:189], v17 offset:8192
v_mul_f32 v198, s66, v198
v_mfma_f32_16x16x32_bf16 v[212:215], a[208:211], a[148:151], v[212:215]
s_mov_b32 s62, 40960
ds_read_b64_tr_b16 a[190:191], v17 offset:8704
v_mul_f32 v199, s66, v199
v_mfma_f32_16x16x32_bf16 v[212:215], a[212:215], a[160:163], v[212:215]
ds_read_b64_tr_b16 a[192:193], v17 offset:16384
v_cvt_pk_bf16_f32 v188, v188, v189
v_mfma_f32_16x16x32_bf16 v[216:219], a[200:203], a[128:131], v[216:219]
ds_read_b64_tr_b16 a[194:195], v17 offset:16896
v_cvt_pk_bf16_f32 v190, v190, v191
v_mfma_f32_16x16x32_bf16 v[216:219], a[204:207], a[140:143], v[216:219]
buffer_load_dwordx4 v7, s[12:15], s63 offen nt lds
v_mfma_f32_16x16x32_bf16 v[216:219], a[208:211], a[152:155], v[216:219]
s_add_u32 m0, s61, 106496
ds_read_b64_tr_b16 a[196:197], v17 offset:24576
v_mul_f32 v200, s66, v200
v_mfma_f32_16x16x32_bf16 v[216:219], a[212:215], a[164:167], v[216:219]
ds_read_b64_tr_b16 a[198:199], v17 offset:25088
v_mul_f32 v201, s66, v201
v_mfma_f32_16x16x32_bf16 v[220:223], a[216:219], a[120:123], v[220:223]
ds_read_b64_tr_b16 a[200:201], v18 offset:0
v_mul_f32 v202, s66, v202
v_mfma_f32_16x16x32_bf16 v[220:223], a[220:223], a[132:135], v[220:223]
buffer_load_dwordx4 v6, s[12:15], s62 offen nt lds
v_mfma_f32_16x16x32_bf16 v[220:223], a[224:227], a[144:147], v[220:223]
ds_read_b64_tr_b16 a[202:203], v18 offset:512
v_mul_f32 v203, s66, v203
v_mfma_f32_16x16x32_bf16 v[220:223], a[228:231], a[156:159], v[220:223]
s_add_u32 m0, s61, 110592
ds_read_b64_tr_b16 a[204:205], v18 offset:8192
v_cvt_pk_bf16_f32 v192, v192, v193
v_mfma_f32_16x16x32_bf16 v[224:227], a[216:219], a[124:127], v[224:227]
s_mov_b32 s63, 45056
ds_read_b64_tr_b16 a[206:207], v18 offset:8704
v_cvt_pk_bf16_f32 v194, v194, v195
v_mfma_f32_16x16x32_bf16 v[224:227], a[220:223], a[136:139], v[224:227]
s_add_u32 s62, s65, 2097408
ds_read_b64_tr_b16 a[208:209], v18 offset:16384
v_mul_f32 v204, s66, v204
v_mfma_f32_16x16x32_bf16 v[224:227], a[224:227], a[148:151], v[224:227]
buffer_load_dwordx4 v7, s[12:15], s63 offen nt lds
v_mfma_f32_16x16x32_bf16 v[224:227], a[228:231], a[160:163], v[224:227]
s_add_u32 m0, s61, 65536
ds_read_b64_tr_b16 a[210:211], v18 offset:16896
v_mul_f32 v205, s66, v205
v_mfma_f32_16x16x32_bf16 v[228:231], a[216:219], a[128:131], v[228:231]
s_add_u32 s63, s65, 2097920
ds_read_b64_tr_b16 a[212:213], v18 offset:24576
v_mul_f32 v206, s66, v206
v_mfma_f32_16x16x32_bf16 v[228:231], a[220:223], a[140:143], v[228:231]
ds_read_b64_tr_b16 a[214:215], v18 offset:25088
v_mul_f32 v207, s66, v207
v_mfma_f32_16x16x32_bf16 v[228:231], a[224:227], a[152:155], v[228:231]
buffer_load_dwordx4 v5, s[8:11], s62 offen lds
v_mfma_f32_16x16x32_bf16 v[228:231], a[228:231], a[164:167], v[228:231]
s_waitcnt lgkmcnt(4)
ds_read_b64_tr_b16 a[216:217], v19 offset:0
v_cvt_pk_bf16_f32 v196, v196, v197
v_mfma_f32_16x16x32_bf16 v[232:235], a[168:171], a[0:3], 0
ds_read_b64_tr_b16 a[218:219], v19 offset:512
v_cvt_pk_bf16_f32 v198, v198, v199
v_mfma_f32_16x16x32_bf16 v[232:235], a[172:175], a[12:15], v[232:235]
ds_read_b64_tr_b16 a[220:221], v19 offset:8192
v_mul_f32 v208, s66, v208
v_mfma_f32_16x16x32_bf16 v[232:235], a[176:179], a[24:27], v[232:235]
ds_read_b64_tr_b16 a[222:223], v19 offset:8704
v_mul_f32 v209, s66, v209
v_mfma_f32_16x16x32_bf16 v[232:235], a[180:183], a[36:39], v[232:235]
s_add_u32 m0, s61, 69632
ds_read_b64_tr_b16 a[224:225], v19 offset:16384
v_mul_f32 v210, s66, v210
v_mfma_f32_16x16x32_bf16 v[236:239], a[168:171], a[4:7], 0
s_add_u32 s62, s65, 2359552
buffer_load_dwordx4 v5, s[8:11], s63 offen lds
v_mfma_f32_16x16x32_bf16 v[236:239], a[172:175], a[16:19], v[236:239]
s_add_u32 m0, s61, 73728
ds_read_b64_tr_b16 a[226:227], v19 offset:16896
v_mul_f32 v211, s66, v211
v_mfma_f32_16x16x32_bf16 v[236:239], a[176:179], a[28:31], v[236:239]
s_add_u32 s63, s65, 2360064
ds_read_b64_tr_b16 a[228:229], v19 offset:24576
v_cvt_pk_bf16_f32 v200, v200, v201
v_mfma_f32_16x16x32_bf16 v[236:239], a[180:183], a[40:43], v[236:239]
buffer_load_dwordx4 v5, s[8:11], s62 offen lds
v_mfma_f32_16x16x32_bf16 v[240:243], a[168:171], a[8:11], 0
s_add_u32 m0, s61, 77824
ds_read_b64_tr_b16 a[230:231], v19 offset:25088
v_add_u32 v16, 0xffff8000, v16
v_mfma_f32_16x16x32_bf16 v[240:243], a[172:175], a[20:23], v[240:243]
s_add_u32 s62, s65, 2621696
v_add_u32 v17, 0xffff8000, v17
v_add_u32 v18, 0xffff8000, v18
v_mfma_f32_16x16x32_bf16 v[240:243], a[176:179], a[32:35], v[240:243]
v_add_u32 v19, 0xffff8000, v19
v_cvt_pk_bf16_f32 v202, v202, v203
v_mfma_f32_16x16x32_bf16 v[240:243], a[180:183], a[44:47], v[240:243]
v_mul_f32 v212, s66, v212
v_mul_f32 v213, s66, v213
v_mfma_f32_16x16x32_bf16 v[244:247], a[184:187], a[0:3], 0
buffer_load_dwordx4 v5, s[8:11], s63 offen lds
v_mfma_f32_16x16x32_bf16 v[244:247], a[188:191], a[12:15], v[244:247]
v_mul_f32 v214, s66, v214
v_mul_f32 v215, s66, v215
v_mfma_f32_16x16x32_bf16 v[244:247], a[192:195], a[24:27], v[244:247]
s_waitcnt vmcnt(8) lgkmcnt(0)
s_barrier
v_mfma_f32_16x16x32_bf16 v[244:247], a[196:199], a[36:39], v[244:247]
s_add_u32 m0, s61, 81920
ds_read_b64_tr_b16 a[168:169], v16 offset:0
v_cvt_pk_bf16_f32 v204, v204, v205
v_mfma_f32_16x16x32_bf16 v[248:251], a[184:187], a[4:7], 0
s_add_u32 s63, s65, 2622208
buffer_load_dwordx4 v5, s[8:11], s62 offen lds
v_mfma_f32_16x16x32_bf16 v[248:251], a[188:191], a[16:19], v[248:251]
s_add_u32 m0, s61, 86016
ds_read_b64_tr_b16 a[170:171], v16 offset:512
v_cvt_pk_bf16_f32 v206, v206, v207
v_mfma_f32_16x16x32_bf16 v[248:251], a[192:195], a[28:31], v[248:251]
s_add_u32 s62, s65, 2883840
ds_read_b64_tr_b16 a[172:173], v16 offset:8192
v_cndmask_b32 v112, v184, v196, s[98:99]
v_mfma_f32_16x16x32_bf16 v[248:251], a[196:199], a[40:43], v[248:251]
ds_read_b64_tr_b16 a[174:175], v16 offset:8704
v_cndmask_b32 v114, v196, v184, s[98:99]
v_mfma_f32_16x16x32_bf16 v[252:255], a[184:187], a[8:11], 0
ds_read_b64_tr_b16 a[176:177], v16 offset:16384
v_cndmask_b32 v113, v186, v198, s[98:99]
v_mfma_f32_16x16x32_bf16 v[252:255], a[188:191], a[20:23], v[252:255]
buffer_load_dwordx4 v5, s[8:11], s63 offen lds
v_mfma_f32_16x16x32_bf16 v[252:255], a[192:195], a[32:35], v[252:255]
s_add_u32 m0, s61, 90112
ds_read_b64_tr_b16 a[178:179], v16 offset:16896
v_cndmask_b32 v115, v198, v186, s[98:99]
v_mfma_f32_16x16x32_bf16 v[252:255], a[196:199], a[44:47], v[252:255]
ds_read_b64_tr_b16 a[180:181], v16 offset:24576
v_mul_f32 v216, s66, v216
v_mfma_f32_16x16x32_bf16 v[44:47], a[200:203], a[0:3], 0
ds_read_b64_tr_b16 a[182:183], v16 offset:25088
v_mul_f32 v217, s66, v217
v_mfma_f32_16x16x32_bf16 v[44:47], a[204:207], a[12:15], v[44:47]
buffer_load_dwordx4 v5, s[8:11], s62 offen lds
v_mfma_f32_16x16x32_bf16 v[44:47], a[208:211], a[24:27], v[44:47]
ds_read_b64_tr_b16 a[184:185], v17 offset:0
v_mul_f32 v218, s66, v218
v_mfma_f32_16x16x32_bf16 v[44:47], a[212:215], a[36:39], v[44:47]
s_add_u32 s63, s65, 2884352
ds_read_b64_tr_b16 a[186:187], v17 offset:512
v_mul_f32 v219, s66, v219
v_mfma_f32_16x16x32_bf16 v[48:51], a[200:203], a[4:7], 0
s_add_u32 m0, s61, 94208
ds_read_b64_tr_b16 a[188:189], v17 offset:8192
v_cvt_pk_bf16_f32 v208, v208, v209
v_mfma_f32_16x16x32_bf16 v[48:51], a[204:207], a[16:19], v[48:51]
s_mov_b32 s62, 49152
ds_read_b64_tr_b16 a[190:191], v17 offset:8704
v_cvt_pk_bf16_f32 v210, v210, v211
v_mfma_f32_16x16x32_bf16 v[48:51], a[208:211], a[28:31], v[48:51]
buffer_load_dwordx4 v5, s[8:11], s63 offen lds
v_mfma_f32_16x16x32_bf16 v[48:51], a[212:215], a[40:43], v[48:51]
s_add_u32 m0, s61, 114688
ds_read_b64_tr_b16 a[192:193], v17 offset:16384
v_cndmask_b32 v116, v188, v200, s[98:99]
v_mfma_f32_16x16x32_bf16 v[52:55], a[200:203], a[8:11], 0
s_mov_b32 s63, 53248
ds_read_b64_tr_b16 a[194:195], v17 offset:16896
v_cndmask_b32 v118, v200, v188, s[98:99]
v_mfma_f32_16x16x32_bf16 v[52:55], a[204:207], a[20:23], v[52:55]
ds_read_b64_tr_b16 a[196:197], v17 offset:24576
v_cndmask_b32 v117, v190, v202, s[98:99]
v_mfma_f32_16x16x32_bf16 v[52:55], a[208:211], a[32:35], v[52:55]
buffer_load_dwordx4 v6, s[12:15], s62 offen nt lds
v_mfma_f32_16x16x32_bf16 v[52:55], a[212:215], a[44:47], v[52:55]
ds_read_b64_tr_b16 a[198:199], v17 offset:25088
v_cndmask_b32 v119, v202, v190, s[98:99]
v_mfma_f32_16x16x32_bf16 v[56:59], a[216:219], a[0:3], 0
ds_read_b64_tr_b16 a[200:201], v18 offset:0
v_mul_f32 v220, s66, v220
v_mfma_f32_16x16x32_bf16 v[56:59], a[220:223], a[12:15], v[56:59]
ds_read_b64_tr_b16 a[202:203], v18 offset:512
v_mul_f32 v221, s66, v221
v_mfma_f32_16x16x32_bf16 v[56:59], a[224:227], a[24:27], v[56:59]
ds_read_b64_tr_b16 a[204:205], v18 offset:8192
v_mul_f32 v222, s66, v222
v_mfma_f32_16x16x32_bf16 v[56:59], a[228:231], a[36:39], v[56:59]
s_add_u32 m0, s61, 118784
ds_read_b64_tr_b16 a[206:207], v18 offset:8704
v_mul_f32 v223, s66, v223
v_mfma_f32_16x16x32_bf16 v[60:63], a[216:219], a[4:7], 0
s_mov_b32 s62, 57344
buffer_load_dwordx4 v7, s[12:15], s63 offen nt lds
v_mfma_f32_16x16x32_bf16 v[60:63], a[220:223], a[16:19], v[60:63]
s_add_u32 m0, s61, 122880
ds_read_b64_tr_b16 a[208:209], v18 offset:16384
v_cvt_pk_bf16_f32 v212, v212, v213
v_mfma_f32_16x16x32_bf16 v[60:63], a[224:227], a[28:31], v[60:63]
s_mov_b32 s63, 61440
ds_read_b64_tr_b16 a[210:211], v18 offset:16896
v_cvt_pk_bf16_f32 v214, v214, v215
v_mfma_f32_16x16x32_bf16 v[60:63], a[228:231], a[40:43], v[60:63]
buffer_load_dwordx4 v6, s[12:15], s62 offen nt lds
v_mfma_f32_16x16x32_bf16 v[64:67], a[216:219], a[8:11], 0
s_add_u32 m0, s61, 126976
ds_read_b64_tr_b16 a[212:213], v18 offset:24576
v_cndmask_b32 v120, v192, v204, s[98:99]
v_mfma_f32_16x16x32_bf16 v[64:67], a[220:223], a[20:23], v[64:67]
s_add_u32 s62, s65, 3145984
ds_read_b64_tr_b16 a[214:215], v18 offset:25088
v_cndmask_b32 v122, v204, v192, s[98:99]
v_mfma_f32_16x16x32_bf16 v[64:67], a[224:227], a[32:35], v[64:67]
ds_read_b64_tr_b16 a[216:217], v19 offset:0
v_cndmask_b32 v121, v194, v206, s[98:99]
v_mfma_f32_16x16x32_bf16 v[64:67], a[228:231], a[44:47], v[64:67]
s_waitcnt lgkmcnt(5)
ds_read_b64_tr_b16 a[218:219], v19 offset:512
v_cndmask_b32 v123, v206, v194, s[98:99]
v_mfma_f32_16x16x32_bf16 v[232:235], a[168:171], a[48:51], v[232:235]
buffer_load_dwordx4 v7, s[12:15], s63 offen nt lds
v_mfma_f32_16x16x32_bf16 v[232:235], a[172:175], a[60:63], v[232:235]
ds_read_b64_tr_b16 a[220:221], v19 offset:8192
v_mul_f32 v224, s66, v224
v_mfma_f32_16x16x32_bf16 v[232:235], a[176:179], a[72:75], v[232:235]
ds_read_b64_tr_b16 a[222:223], v19 offset:8704
v_mul_f32 v225, s66, v225
v_mfma_f32_16x16x32_bf16 v[232:235], a[180:183], a[84:87], v[232:235]
s_add_u32 m0, s61, 32768
ds_read_b64_tr_b16 a[224:225], v19 offset:16384
v_mul_f32 v226, s66, v226
v_mfma_f32_16x16x32_bf16 v[236:239], a[168:171], a[52:55], v[236:239]
s_add_u32 s63, s65, 3146496
buffer_load_dwordx4 v5, s[8:11], s62 offen lds
v_mfma_f32_16x16x32_bf16 v[236:239], a[172:175], a[64:67], v[236:239]
s_add_u32 m0, s61, 36864
ds_read_b64_tr_b16 a[226:227], v19 offset:16896
v_mul_f32 v227, s66, v227
v_mfma_f32_16x16x32_bf16 v[236:239], a[176:179], a[76:79], v[236:239]
s_add_u32 s62, s65, 3408128
ds_read_b64_tr_b16 a[228:229], v19 offset:24576
v_cvt_pk_bf16_f32 v216, v216, v217
v_mfma_f32_16x16x32_bf16 v[236:239], a[180:183], a[88:91], v[236:239]
ds_read_b64_tr_b16 a[230:231], v19 offset:25088
v_add_u32 v16, 0x10000, v16
v_mfma_f32_16x16x32_bf16 v[240:243], a[168:171], a[56:59], v[240:243]
v_add_u32 v17, 0x10000, v17
v_add_u32 v18, 0x10000, v18
v_mfma_f32_16x16x32_bf16 v[240:243], a[172:175], a[68:71], v[240:243]
buffer_load_dwordx4 v5, s[8:11], s63 offen lds
v_mfma_f32_16x16x32_bf16 v[240:243], a[176:179], a[80:83], v[240:243]
s_add_u32 m0, s61, 40960
v_add_u32 v19, 0x10000, v19
v_cvt_pk_bf16_f32 v218, v218, v219
v_mfma_f32_16x16x32_bf16 v[240:243], a[180:183], a[92:95], v[240:243]
v_mul_f32 v228, s66, v228
v_mul_f32 v229, s66, v229
v_mfma_f32_16x16x32_bf16 v[244:247], a[184:187], a[48:51], v[244:247]
v_mul_f32 v230, s66, v230
v_mul_f32 v231, s66, v231
v_mfma_f32_16x16x32_bf16 v[244:247], a[188:191], a[60:63], v[244:247]
s_waitcnt vmcnt(6) lgkmcnt(0)
s_barrier
v_mfma_f32_16x16x32_bf16 v[244:247], a[192:195], a[72:75], v[244:247]
buffer_load_dwordx4 v5, s[8:11], s62 offen lds
v_mfma_f32_16x16x32_bf16 v[244:247], a[196:199], a[84:87], v[244:247]
s_add_u32 s63, s65, 3408640
ds_read_b64_tr_b16 a[168:169], v16 offset:0
v_cvt_pk_bf16_f32 v220, v220, v221
v_mfma_f32_16x16x32_bf16 v[248:251], a[184:187], a[52:55], v[248:251]
s_add_u32 m0, s61, 45056
ds_read_b64_tr_b16 a[170:171], v16 offset:512
v_cvt_pk_bf16_f32 v222, v222, v223
v_mfma_f32_16x16x32_bf16 v[248:251], a[188:191], a[64:67], v[248:251]
s_add_u32 s62, s64, 384
ds_read_b64_tr_b16 a[172:173], v16 offset:8192
v_cvt_pk_bf16_f32 v224, v224, v225
v_mfma_f32_16x16x32_bf16 v[248:251], a[192:195], a[76:79], v[248:251]
buffer_load_dwordx4 v5, s[8:11], s63 offen lds
v_mfma_f32_16x16x32_bf16 v[248:251], a[196:199], a[88:91], v[248:251]
s_add_u32 m0, s61, 49152
ds_read_b64_tr_b16 a[174:175], v16 offset:8704
v_cvt_pk_bf16_f32 v226, v226, v227
v_mfma_f32_16x16x32_bf16 v[252:255], a[184:187], a[56:59], v[252:255]
s_add_u32 s63, s64, 896
ds_read_b64_tr_b16 a[176:177], v16 offset:16384
v_cvt_pk_bf16_f32 v228, v228, v229
v_mfma_f32_16x16x32_bf16 v[252:255], a[188:191], a[68:71], v[252:255]
ds_read_b64_tr_b16 a[178:179], v16 offset:16896
v_cvt_pk_bf16_f32 v230, v230, v231
v_mfma_f32_16x16x32_bf16 v[252:255], a[192:195], a[80:83], v[252:255]
buffer_load_dwordx4 v5, s[8:11], s62 offen lds
v_mfma_f32_16x16x32_bf16 v[252:255], a[196:199], a[92:95], v[252:255]
ds_read_b64_tr_b16 a[180:181], v16 offset:24576
v_cndmask_b32 v124, v208, v220, s[98:99]
v_mfma_f32_16x16x32_bf16 v[44:47], a[200:203], a[48:51], v[44:47]
ds_read_b64_tr_b16 a[182:183], v16 offset:25088
v_cndmask_b32 v126, v220, v208, s[98:99]
v_mfma_f32_16x16x32_bf16 v[44:47], a[204:207], a[60:63], v[44:47]
ds_read_b64_tr_b16 a[184:185], v17 offset:0
v_cndmask_b32 v125, v210, v222, s[98:99]
v_mfma_f32_16x16x32_bf16 v[44:47], a[208:211], a[72:75], v[44:47]
ds_read_b64_tr_b16 a[186:187], v17 offset:512
v_cndmask_b32 v127, v222, v210, s[98:99]
v_mfma_f32_16x16x32_bf16 v[44:47], a[212:215], a[84:87], v[44:47]
s_add_u32 m0, s61, 53248
ds_read_b64_tr_b16 a[188:189], v17 offset:8192
v_cndmask_b32 v128, v212, v224, s[98:99]
v_mfma_f32_16x16x32_bf16 v[48:51], a[200:203], a[52:55], v[48:51]
s_add_u32 s62, s64, 262528
buffer_load_dwordx4 v5, s[8:11], s63 offen lds
v_mfma_f32_16x16x32_bf16 v[48:51], a[204:207], a[64:67], v[48:51]
s_add_u32 m0, s61, 57344
ds_read_b64_tr_b16 a[190:191], v17 offset:8704
v_cndmask_b32 v130, v224, v212, s[98:99]
v_mfma_f32_16x16x32_bf16 v[48:51], a[208:211], a[76:79], v[48:51]
s_add_u32 s63, s64, 263040
ds_read_b64_tr_b16 a[192:193], v17 offset:16384
v_cndmask_b32 v129, v214, v226, s[98:99]
v_mfma_f32_16x16x32_bf16 v[48:51], a[212:215], a[88:91], v[48:51]
buffer_load_dwordx4 v5, s[8:11], s62 offen lds
v_mfma_f32_16x16x32_bf16 v[52:55], a[200:203], a[56:59], v[52:55]
s_add_u32 m0, s61, 61440
ds_read_b64_tr_b16 a[194:195], v17 offset:16896
v_cndmask_b32 v131, v226, v214, s[98:99]
v_mfma_f32_16x16x32_bf16 v[52:55], a[204:207], a[68:71], v[52:55]
s_add_u32 s62, s64, 524672
ds_read_b64_tr_b16 a[196:197], v17 offset:24576
v_cndmask_b32 v132, v216, v228, s[98:99]
v_mfma_f32_16x16x32_bf16 v[52:55], a[208:211], a[80:83], v[52:55]
ds_read_b64_tr_b16 a[198:199], v17 offset:25088
v_cndmask_b32 v134, v228, v216, s[98:99]
v_mfma_f32_16x16x32_bf16 v[52:55], a[212:215], a[92:95], v[52:55]
ds_read_b64_tr_b16 a[200:201], v18 offset:0
v_cndmask_b32 v133, v218, v230, s[98:99]
v_mfma_f32_16x16x32_bf16 v[56:59], a[216:219], a[48:51], v[56:59]
buffer_load_dwordx4 v5, s[8:11], s63 offen lds
v_mfma_f32_16x16x32_bf16 v[56:59], a[220:223], a[60:63], v[56:59]
ds_read_b64_tr_b16 a[202:203], v18 offset:512
v_cndmask_b32 v135, v230, v218, s[98:99]
v_mfma_f32_16x16x32_bf16 v[56:59], a[224:227], a[72:75], v[56:59]
ds_read_b64_tr_b16 a[204:205], v18 offset:8192
v_mfma_f32_16x16x32_bf16 v[56:59], a[228:231], a[84:87], v[56:59]
s_add_u32 m0, s61, 0
ds_read_b64_tr_b16 a[206:207], v18 offset:8704
v_mfma_f32_16x16x32_bf16 v[60:63], a[216:219], a[52:55], v[60:63]
s_add_u32 s63, s64, 525184
buffer_load_dwordx4 v5, s[8:11], s62 offen lds
v_mfma_f32_16x16x32_bf16 v[60:63], a[220:223], a[64:67], v[60:63]
s_add_u32 m0, s61, 4096
ds_read_b64_tr_b16 a[208:209], v18 offset:16384
v_mfma_f32_16x16x32_bf16 v[60:63], a[224:227], a[76:79], v[60:63]
s_add_u32 s62, s64, 786816
ds_read_b64_tr_b16 a[210:211], v18 offset:16896
v_mfma_f32_16x16x32_bf16 v[60:63], a[228:231], a[88:91], v[60:63]
ds_read_b64_tr_b16 a[212:213], v18 offset:24576
v_mfma_f32_16x16x32_bf16 v[64:67], a[216:219], a[56:59], v[64:67]
ds_read_b64_tr_b16 a[214:215], v18 offset:25088
v_mfma_f32_16x16x32_bf16 v[64:67], a[220:223], a[68:71], v[64:67]
buffer_load_dwordx4 v5, s[8:11], s63 offen lds
v_mfma_f32_16x16x32_bf16 v[64:67], a[224:227], a[80:83], v[64:67]
s_add_u32 m0, s61, 8192
ds_read_b64_tr_b16 a[216:217], v19 offset:0
v_mfma_f32_16x16x32_bf16 v[64:67], a[228:231], a[92:95], v[64:67]
s_waitcnt lgkmcnt(5)
ds_read_b64_tr_b16 a[218:219], v19 offset:512
v_mfma_f32_16x16x32_bf16 v[232:235], a[168:171], a[96:99], v[232:235]
ds_read_b64_tr_b16 a[220:221], v19 offset:8192
v_mfma_f32_16x16x32_bf16 v[232:235], a[172:175], a[108:111], v[232:235]
buffer_load_dwordx4 v5, s[8:11], s62 offen lds
v_mfma_f32_16x16x32_bf16 v[232:235], a[176:179], a[120:123], v[232:235]
ds_read_b64_tr_b16 a[222:223], v19 offset:8704
v_mfma_f32_16x16x32_bf16 v[232:235], a[180:183], a[132:135], v[232:235]
s_add_u32 s63, s64, 787328
ds_read_b64_tr_b16 a[224:225], v19 offset:16384
v_mfma_f32_16x16x32_bf16 v[236:239], a[168:171], a[100:103], v[236:239]
s_add_u32 m0, s61, 12288
ds_read_b64_tr_b16 a[226:227], v19 offset:16896
v_mfma_f32_16x16x32_bf16 v[236:239], a[172:175], a[112:115], v[236:239]
s_add_u32 s62, s64, 1048960
ds_read_b64_tr_b16 a[228:229], v19 offset:24576
v_mfma_f32_16x16x32_bf16 v[236:239], a[176:179], a[124:127], v[236:239]
buffer_load_dwordx4 v5, s[8:11], s63 offen lds
v_mfma_f32_16x16x32_bf16 v[236:239], a[180:183], a[136:139], v[236:239]
s_add_u32 m0, s61, 16384
ds_read_b64_tr_b16 a[230:231], v19 offset:25088
v_add_u32 v16, 0xffff8000, v16
v_mfma_f32_16x16x32_bf16 v[240:243], a[168:171], a[104:107], v[240:243]
s_add_u32 s63, s64, 1049472
v_add_u32 v17, 0xffff8000, v17
v_add_u32 v18, 0xffff8000, v18
v_mfma_f32_16x16x32_bf16 v[240:243], a[172:175], a[116:119], v[240:243]
v_add_u32 v19, 0xffff8000, v19
v_mfma_f32_16x16x32_bf16 v[240:243], a[176:179], a[128:131], v[240:243]
buffer_load_dwordx4 v5, s[8:11], s62 offen lds
v_mfma_f32_16x16x32_bf16 v[240:243], a[180:183], a[140:143], v[240:243]
v_mfma_f32_16x16x32_bf16 v[244:247], a[184:187], a[96:99], v[244:247]
v_mfma_f32_16x16x32_bf16 v[244:247], a[188:191], a[108:111], v[244:247]
s_waitcnt vmcnt(5) lgkmcnt(0)
s_barrier
v_mfma_f32_16x16x32_bf16 v[244:247], a[192:195], a[120:123], v[244:247]
ds_read_b64_tr_b16 a[168:169], v16 offset:0
v_mfma_f32_16x16x32_bf16 v[244:247], a[196:199], a[132:135], v[244:247]
s_add_u32 m0, s61, 20480
ds_read_b64_tr_b16 a[170:171], v16 offset:512
v_mfma_f32_16x16x32_bf16 v[248:251], a[184:187], a[100:103], v[248:251]
s_add_u32 s62, s64, 1311104
buffer_load_dwordx4 v5, s[8:11], s63 offen lds
v_mfma_f32_16x16x32_bf16 v[248:251], a[188:191], a[112:115], v[248:251]
s_add_u32 m0, s61, 24576
ds_read_b64_tr_b16 a[172:173], v16 offset:8192
v_mfma_f32_16x16x32_bf16 v[248:251], a[192:195], a[124:127], v[248:251]
s_add_u32 s63, s64, 1311616
ds_read_b64_tr_b16 a[174:175], v16 offset:8704
v_mfma_f32_16x16x32_bf16 v[248:251], a[196:199], a[136:139], v[248:251]
buffer_load_dwordx4 v5, s[8:11], s62 offen lds
v_mfma_f32_16x16x32_bf16 v[252:255], a[184:187], a[104:107], v[252:255]
s_add_u32 m0, s61, 28672
ds_read_b64_tr_b16 a[176:177], v17 offset:0
v_mfma_f32_16x16x32_bf16 v[252:255], a[188:191], a[116:119], v[252:255]
s_add_u32 s62, s64, 1573248
ds_read_b64_tr_b16 a[178:179], v17 offset:512
v_mfma_f32_16x16x32_bf16 v[252:255], a[192:195], a[128:131], v[252:255]
ds_read_b64_tr_b16 a[180:181], v17 offset:8192
v_mfma_f32_16x16x32_bf16 v[252:255], a[196:199], a[140:143], v[252:255]
ds_read_b64_tr_b16 a[182:183], v17 offset:8704
v_mfma_f32_16x16x32_bf16 v[44:47], a[200:203], a[96:99], v[44:47]
buffer_load_dwordx4 v5, s[8:11], s63 offen lds
v_mfma_f32_16x16x32_bf16 v[44:47], a[204:207], a[108:111], v[44:47]
ds_read_b64_tr_b16 a[184:185], v18 offset:0
v_mfma_f32_16x16x32_bf16 v[44:47], a[208:211], a[120:123], v[44:47]
ds_read_b64_tr_b16 a[186:187], v18 offset:512
v_mfma_f32_16x16x32_bf16 v[44:47], a[212:215], a[132:135], v[44:47]
s_add_u32 m0, s61, 65536
ds_read_b64_tr_b16 a[188:189], v18 offset:8192
v_mfma_f32_16x16x32_bf16 v[48:51], a[200:203], a[100:103], v[48:51]
s_add_u32 s63, s64, 1573760
buffer_load_dwordx4 v5, s[8:11], s62 offen lds
v_mfma_f32_16x16x32_bf16 v[48:51], a[204:207], a[112:115], v[48:51]
s_add_u32 m0, s61, 69632
ds_read_b64_tr_b16 a[190:191], v18 offset:8704
v_mfma_f32_16x16x32_bf16 v[48:51], a[208:211], a[124:127], v[48:51]
s_add_u32 s62, s64, 1835392
ds_read_b64_tr_b16 a[192:193], v19 offset:0
v_mfma_f32_16x16x32_bf16 v[48:51], a[212:215], a[136:139], v[48:51]
ds_read_b64_tr_b16 a[194:195], v19 offset:512
v_mfma_f32_16x16x32_bf16 v[52:55], a[200:203], a[104:107], v[52:55]
ds_read_b64_tr_b16 a[196:197], v19 offset:8192
v_mfma_f32_16x16x32_bf16 v[52:55], a[204:207], a[116:119], v[52:55]
buffer_load_dwordx4 v5, s[8:11], s63 offen lds
v_mfma_f32_16x16x32_bf16 v[52:55], a[208:211], a[128:131], v[52:55]
s_add_u32 m0, s61, 73728
ds_read_b64_tr_b16 a[198:199], v19 offset:8704
v_mfma_f32_16x16x32_bf16 v[52:55], a[212:215], a[140:143], v[52:55]
ds_read_b64_tr_b16 a[200:201], v16 offset:16384
v_mfma_f32_16x16x32_bf16 v[56:59], a[216:219], a[96:99], v[56:59]
ds_read_b64_tr_b16 a[202:203], v16 offset:16896
v_mfma_f32_16x16x32_bf16 v[56:59], a[220:223], a[108:111], v[56:59]
buffer_load_dwordx4 v5, s[8:11], s62 offen lds
v_mfma_f32_16x16x32_bf16 v[56:59], a[224:227], a[120:123], v[56:59]
ds_read_b64_tr_b16 a[204:205], v16 offset:24576
v_mfma_f32_16x16x32_bf16 v[56:59], a[228:231], a[132:135], v[56:59]
s_add_u32 s63, s64, 1835904
ds_read_b64_tr_b16 a[206:207], v16 offset:25088
v_mfma_f32_16x16x32_bf16 v[60:63], a[216:219], a[100:103], v[60:63]
s_add_u32 m0, s61, 77824
ds_read_b64_tr_b16 a[208:209], v17 offset:16384
v_mfma_f32_16x16x32_bf16 v[60:63], a[220:223], a[112:115], v[60:63]
s_add_u32 s62, s65, 2097536
ds_read_b64_tr_b16 a[210:211], v17 offset:16896
v_mfma_f32_16x16x32_bf16 v[60:63], a[224:227], a[124:127], v[60:63]
buffer_load_dwordx4 v5, s[8:11], s63 offen lds
v_mfma_f32_16x16x32_bf16 v[60:63], a[228:231], a[136:139], v[60:63]
s_add_u32 m0, s61, 81920
ds_read_b64_tr_b16 a[212:213], v17 offset:24576
v_mfma_f32_16x16x32_bf16 v[64:67], a[216:219], a[104:107], v[64:67]
s_add_u32 s63, s65, 2098048
ds_read_b64_tr_b16 a[214:215], v17 offset:25088
v_mfma_f32_16x16x32_bf16 v[64:67], a[220:223], a[116:119], v[64:67]
ds_read_b64_tr_b16 a[216:217], v18 offset:16384
v_mfma_f32_16x16x32_bf16 v[64:67], a[224:227], a[128:131], v[64:67]
buffer_load_dwordx4 v5, s[8:11], s62 offen lds
v_mfma_f32_16x16x32_bf16 v[64:67], a[228:231], a[140:143], v[64:67]
s_waitcnt lgkmcnt(4)
ds_read_b64_tr_b16 a[218:219], v18 offset:16896
v_mfma_f32_16x16x32_bf16 v[232:235], a[168:171], a[144:147], v[232:235]
ds_read_b64_tr_b16 a[220:221], v18 offset:24576
v_mfma_f32_16x16x32_bf16 v[232:235], a[172:175], a[156:159], v[232:235]
s_add_u32 m0, s61, 86016
ds_read_b64_tr_b16 a[222:223], v18 offset:25088
v_mfma_f32_16x16x32_bf16 v[236:239], a[168:171], a[148:151], v[236:239]
s_add_u32 s62, s65, 2359680
ds_read_b64_tr_b16 a[224:225], v19 offset:16384
v_mfma_f32_16x16x32_bf16 v[236:239], a[172:175], a[160:163], v[236:239]
buffer_load_dwordx4 v5, s[8:11], s63 offen lds
v_mfma_f32_16x16x32_bf16 v[240:243], a[168:171], a[152:155], v[240:243]
s_add_u32 m0, s61, 90112
ds_read_b64_tr_b16 a[226:227], v19 offset:16896
v_mul_f32 v232, s66, v232
v_mfma_f32_16x16x32_bf16 v[240:243], a[172:175], a[164:167], v[240:243]
ds_read_b64_tr_b16 a[228:229], v19 offset:24576
v_mul_f32 v233, s66, v233
v_mfma_f32_16x16x32_bf16 v[244:247], a[176:179], a[144:147], v[244:247]
ds_read_b64_tr_b16 a[230:231], v19 offset:25088
v_add_u32 v16, 0xffff8000, v16
v_mfma_f32_16x16x32_bf16 v[244:247], a[180:183], a[156:159], v[244:247]
s_add_u32 s63, s65, 2360192
v_add_u32 v17, 0xffff8000, v17
v_add_u32 v18, 0xffff8000, v18
v_mfma_f32_16x16x32_bf16 v[248:251], a[176:179], a[148:151], v[248:251]
v_add_u32 v19, 0xffff8000, v19
v_mul_f32 v234, s66, v234
v_mfma_f32_16x16x32_bf16 v[248:251], a[180:183], a[160:163], v[248:251]
buffer_load_dwordx4 v5, s[8:11], s62 offen lds
v_mfma_f32_16x16x32_bf16 v[252:255], a[176:179], a[152:155], v[252:255]
s_add_u32 m0, s61, 94208
v_mul_f32 v235, s66, v235
v_mul_f32 v236, s66, v236
v_mfma_f32_16x16x32_bf16 v[252:255], a[180:183], a[164:167], v[252:255]
v_mul_f32 v237, s66, v237
v_mul_f32 v238, s66, v238
v_mfma_f32_16x16x32_bf16 v[44:47], a[184:187], a[144:147], v[44:47]
s_waitcnt vmcnt(7) lgkmcnt(0)
s_barrier
v_mfma_f32_16x16x32_bf16 v[44:47], a[188:191], a[156:159], v[44:47]
s_add_u32 s62, s65, 2621824
buffer_load_dwordx4 v5, s[8:11], s63 offen lds
v_mfma_f32_16x16x32_bf16 v[48:51], a[184:187], a[148:151], v[48:51]
s_add_u32 m0, s61, 32768
ds_read_b64_tr_b16 a[168:169], v16 offset:0
v_mul_f32 v239, s66, v239
v_mfma_f32_16x16x32_bf16 v[48:51], a[188:191], a[160:163], v[48:51]
s_add_u32 s63, s65, 2622336
ds_read_b64_tr_b16 a[170:171], v16 offset:512
v_mul_f32 v240, s66, v240
v_mfma_f32_16x16x32_bf16 v[52:55], a[184:187], a[152:155], v[52:55]
buffer_load_dwordx4 v5, s[8:11], s62 offen lds
v_mfma_f32_16x16x32_bf16 v[52:55], a[188:191], a[164:167], v[52:55]
ds_read_b64_tr_b16 a[172:173], v16 offset:8192
v_mul_f32 v241, s66, v241
v_mfma_f32_16x16x32_bf16 v[56:59], a[192:195], a[144:147], v[56:59]
ds_read_b64_tr_b16 a[174:175], v16 offset:8704
v_mul_f32 v242, s66, v242
v_mfma_f32_16x16x32_bf16 v[56:59], a[196:199], a[156:159], v[56:59]
s_add_u32 m0, s61, 36864
ds_read_b64_tr_b16 a[176:177], v16 offset:16384
v_mul_f32 v243, s66, v243
v_mfma_f32_16x16x32_bf16 v[60:63], a[192:195], a[148:151], v[60:63]
s_add_u32 s62, s65, 2883968
ds_read_b64_tr_b16 a[178:179], v16 offset:16896
v_mul_f32 v244, s66, v244
v_mfma_f32_16x16x32_bf16 v[60:63], a[196:199], a[160:163], v[60:63]
buffer_load_dwordx4 v5, s[8:11], s63 offen lds
v_mfma_f32_16x16x32_bf16 v[64:67], a[192:195], a[152:155], v[64:67]
s_add_u32 m0, s61, 40960
ds_read_b64_tr_b16 a[180:181], v16 offset:24576
v_mul_f32 v245, s66, v245
v_mfma_f32_16x16x32_bf16 v[64:67], a[196:199], a[164:167], v[64:67]
ds_read_b64_tr_b16 a[182:183], v16 offset:25088
v_mul_f32 v246, s66, v246
v_mfma_f32_16x16x32_bf16 v[184:187], a[200:203], a[0:3], 0
ds_read_b64_tr_b16 a[184:185], v17 offset:0
v_mul_f32 v247, s66, v247
v_mfma_f32_16x16x32_bf16 v[184:187], a[204:207], a[12:15], v[184:187]
s_add_u32 s63, s65, 2884480
buffer_load_dwordx4 v5, s[8:11], s62 offen lds
v_mfma_f32_16x16x32_bf16 v[188:191], a[200:203], a[4:7], 0
s_add_u32 m0, s61, 45056
ds_read_b64_tr_b16 a[186:187], v17 offset:512
v_mul_f32 v248, s66, v248
v_mfma_f32_16x16x32_bf16 v[188:191], a[204:207], a[16:19], v[188:191]
s_add_u32 s62, s65, 3146112
ds_read_b64_tr_b16 a[188:189], v17 offset:8192
v_mul_f32 v249, s66, v249
v_mfma_f32_16x16x32_bf16 v[192:195], a[200:203], a[8:11], 0
ds_read_b64_tr_b16 a[190:191], v17 offset:8704
v_mul_f32 v250, s66, v250
v_mfma_f32_16x16x32_bf16 v[192:195], a[204:207], a[20:23], v[192:195]
ds_read_b64_tr_b16 a[192:193], v17 offset:16384
v_mul_f32 v251, s66, v251
v_mfma_f32_16x16x32_bf16 v[196:199], a[208:211], a[0:3], 0
buffer_load_dwordx4 v5, s[8:11], s63 offen lds
v_mfma_f32_16x16x32_bf16 v[196:199], a[212:215], a[12:15], v[196:199]
s_add_u32 m0, s61, 49152
ds_read_b64_tr_b16 a[194:195], v17 offset:16896
v_cvt_pk_bf16_f32 v232, v232, v233
v_mfma_f32_16x16x32_bf16 v[200:203], a[208:211], a[4:7], 0
s_add_u32 s63, s65, 3146624
ds_read_b64_tr_b16 a[196:197], v17 offset:24576
v_cvt_pk_bf16_f32 v234, v234, v235
v_mfma_f32_16x16x32_bf16 v[200:203], a[212:215], a[16:19], v[200:203]
ds_read_b64_tr_b16 a[198:199], v17 offset:25088
v_mul_f32 v252, s66, v252
v_mfma_f32_16x16x32_bf16 v[204:207], a[208:211], a[8:11], 0
buffer_load_dwordx4 v5, s[8:11], s62 offen lds
v_mfma_f32_16x16x32_bf16 v[204:207], a[212:215], a[20:23], v[204:207]
ds_read_b64_tr_b16 a[200:201], v18 offset:0
v_mul_f32 v253, s66, v253
v_mfma_f32_16x16x32_bf16 v[208:211], a[216:219], a[0:3], 0
ds_read_b64_tr_b16 a[202:203], v18 offset:512
v_mul_f32 v254, s66, v254
v_mfma_f32_16x16x32_bf16 v[208:211], a[220:223], a[12:15], v[208:211]
s_add_u32 m0, s61, 53248
ds_read_b64_tr_b16 a[204:205], v18 offset:8192
v_mul_f32 v255, s66, v255
v_mfma_f32_16x16x32_bf16 v[212:215], a[216:219], a[4:7], 0
s_add_u32 s62, s65, 3408256
ds_read_b64_tr_b16 a[206:207], v18 offset:8704
v_cvt_pk_bf16_f32 v236, v236, v237
v_mfma_f32_16x16x32_bf16 v[212:215], a[220:223], a[16:19], v[212:215]
buffer_load_dwordx4 v5, s[8:11], s63 offen lds
v_mfma_f32_16x16x32_bf16 v[216:219], a[216:219], a[8:11], 0
s_add_u32 m0, s61, 57344
ds_read_b64_tr_b16 a[208:209], v18 offset:16384
v_cvt_pk_bf16_f32 v238, v238, v239
v_mfma_f32_16x16x32_bf16 v[216:219], a[220:223], a[20:23], v[216:219]
ds_read_b64_tr_b16 a[210:211], v18 offset:16896
v_mul_f32 v44, s66, v44
v_mfma_f32_16x16x32_bf16 v[220:223], a[224:227], a[0:3], 0
ds_read_b64_tr_b16 a[212:213], v18 offset:24576
v_mul_f32 v45, s66, v45
v_mfma_f32_16x16x32_bf16 v[220:223], a[228:231], a[12:15], v[220:223]
s_add_u32 s63, s65, 3408768
ds_read_b64_tr_b16 a[214:215], v18 offset:25088
v_mul_f32 v46, s66, v46
v_mfma_f32_16x16x32_bf16 v[224:227], a[224:227], a[4:7], 0
ds_read_b64_tr_b16 a[216:217], v19 offset:0
v_mul_f32 v47, s66, v47
v_mfma_f32_16x16x32_bf16 v[224:227], a[228:231], a[16:19], v[224:227]
ds_read_b64_tr_b16 a[218:219], v19 offset:512
v_cvt_pk_bf16_f32 v240, v240, v241
v_mfma_f32_16x16x32_bf16 v[228:231], a[224:227], a[8:11], 0
ds_read_b64_tr_b16 a[220:221], v19 offset:8192
v_cvt_pk_bf16_f32 v242, v242, v243
v_mfma_f32_16x16x32_bf16 v[228:231], a[228:231], a[20:23], v[228:231]
s_waitcnt lgkmcnt(6)
ds_read_b64_tr_b16 a[222:223], v19 offset:8704
v_mul_f32 v48, s66, v48
v_mfma_f32_16x16x32_bf16 v[184:187], a[168:171], a[24:27], v[184:187]
ds_read_b64_tr_b16 a[224:225], v19 offset:16384
v_mul_f32 v49, s66, v49
v_mfma_f32_16x16x32_bf16 v[184:187], a[172:175], a[36:39], v[184:187]
ds_read_b64_tr_b16 a[226:227], v19 offset:16896
v_mul_f32 v50, s66, v50
v_mfma_f32_16x16x32_bf16 v[184:187], a[176:179], a[48:51], v[184:187]
ds_read_b64_tr_b16 a[228:229], v19 offset:24576
v_mul_f32 v51, s66, v51
v_mfma_f32_16x16x32_bf16 v[184:187], a[180:183], a[60:63], v[184:187]
ds_read_b64_tr_b16 a[230:231], v19 offset:25088
v_add_u32 v16, 0x10000, v16
v_mfma_f32_16x16x32_bf16 v[188:191], a[168:171], a[28:31], v[188:191]
buffer_load_dwordx4 v5, s[8:11], s62 offen lds
v_mfma_f32_16x16x32_bf16 v[188:191], a[172:175], a[40:43], v[188:191]
s_add_u32 m0, s61, 61440
v_add_u32 v17, 0x10000, v17
v_add_u32 v18, 0x10000, v18
v_mfma_f32_16x16x32_bf16 v[188:191], a[176:179], a[52:55], v[188:191]
s_mov_b32 s62, 65536
buffer_load_dwordx4 v5, s[8:11], s63 offen lds
v_mfma_f32_16x16x32_bf16 v[188:191], a[180:183], a[64:67], v[188:191]
s_add_u32 m0, s61, 0
v_add_u32 v19, 0x10000, v19
v_cvt_pk_bf16_f32 v244, v244, v245
v_mfma_f32_16x16x32_bf16 v[192:195], a[168:171], a[32:35], v[192:195]
s_mov_b32 s63, 69632
v_cvt_pk_bf16_f32 v246, v246, v247
v_mul_f32 v52, s66, v52
v_mfma_f32_16x16x32_bf16 v[192:195], a[172:175], a[44:47], v[192:195]
s_waitcnt vmcnt(8) lgkmcnt(0)
s_barrier
ds_read_b64_tr_b16 a[168:169], v16 offset:0
v_mfma_f32_16x16x32_bf16 v[192:195], a[176:179], a[56:59], v[192:195]
buffer_load_dwordx4 v6, s[12:15], s62 offen nt lds
v_mfma_f32_16x16x32_bf16 v[192:195], a[180:183], a[68:71], v[192:195]
ds_read_b64_tr_b16 a[170:171], v16 offset:512
v_mul_f32 v53, s66, v53
v_mfma_f32_16x16x32_bf16 v[196:199], a[184:187], a[24:27], v[196:199]
ds_read_b64_tr_b16 a[172:173], v16 offset:8192
v_mul_f32 v54, s66, v54
v_mfma_f32_16x16x32_bf16 v[196:199], a[188:191], a[36:39], v[196:199]
ds_read_b64_tr_b16 a[174:175], v16 offset:8704
v_mul_f32 v55, s66, v55
v_mfma_f32_16x16x32_bf16 v[196:199], a[192:195], a[48:51], v[196:199]
ds_read_b64_tr_b16 a[176:177], v16 offset:16384
v_cvt_pk_bf16_f32 v248, v248, v249
v_mfma_f32_16x16x32_bf16 v[196:199], a[196:199], a[60:63], v[196:199]
s_add_u32 m0, s61, 4096
ds_read_b64_tr_b16 a[178:179], v16 offset:16896
v_cvt_pk_bf16_f32 v250, v250, v251
v_mfma_f32_16x16x32_bf16 v[200:203], a[184:187], a[28:31], v[200:203]
s_mov_b32 s62, 73728
ds_read_b64_tr_b16 a[180:181], v16 offset:24576
v_mul_f32 v56, s66, v56
v_mfma_f32_16x16x32_bf16 v[200:203], a[188:191], a[40:43], v[200:203]
ds_read_b64_tr_b16 a[182:183], v16 offset:25088
v_mul_f32 v57, s66, v57
v_mfma_f32_16x16x32_bf16 v[200:203], a[192:195], a[52:55], v[200:203]
buffer_load_dwordx4 v7, s[12:15], s63 offen nt lds
v_mfma_f32_16x16x32_bf16 v[200:203], a[196:199], a[64:67], v[200:203]
s_add_u32 m0, s61, 8192
v_mul_f32 v58, s66, v58
v_mul_f32 v59, s66, v59
v_mfma_f32_16x16x32_bf16 v[204:207], a[184:187], a[32:35], v[204:207]
s_mov_b32 s63, 77824
ds_read_b64_tr_b16 a[184:185], v17 offset:0
v_cvt_pk_bf16_f32 v252, v252, v253
v_mfma_f32_16x16x32_bf16 v[204:207], a[188:191], a[44:47], v[204:207]
ds_read_b64_tr_b16 a[186:187], v17 offset:512
v_cvt_pk_bf16_f32 v254, v254, v255
v_mfma_f32_16x16x32_bf16 v[204:207], a[192:195], a[56:59], v[204:207]
ds_read_b64_tr_b16 a[188:189], v17 offset:8192
v_mul_f32 v60, s66, v60
v_mfma_f32_16x16x32_bf16 v[204:207], a[196:199], a[68:71], v[204:207]
ds_read_b64_tr_b16 a[190:191], v17 offset:8704
v_mul_f32 v61, s66, v61
v_mfma_f32_16x16x32_bf16 v[208:211], a[200:203], a[24:27], v[208:211]
ds_read_b64_tr_b16 a[192:193], v17 offset:16384
v_mul_f32 v62, s66, v62
v_mfma_f32_16x16x32_bf16 v[208:211], a[204:207], a[36:39], v[208:211]
ds_read_b64_tr_b16 a[194:195], v17 offset:16896
v_mul_f32 v63, s66, v63
v_mfma_f32_16x16x32_bf16 v[208:211], a[208:211], a[48:51], v[208:211]
buffer_load_dwordx4 v6, s[12:15], s62 offen nt lds
v_mfma_f32_16x16x32_bf16 v[208:211], a[212:215], a[60:63], v[208:211]
s_add_u32 m0, s61, 12288
ds_read_b64_tr_b16 a[196:197], v17 offset:24576
v_cvt_pk_bf16_f32 v44, v44, v45
v_mfma_f32_16x16x32_bf16 v[212:215], a[200:203], a[28:31], v[212:215]
s_mov_b32 s62, 81920
ds_read_b64_tr_b16 a[198:199], v17 offset:25088
v_cvt_pk_bf16_f32 v46, v46, v47
v_mfma_f32_16x16x32_bf16 v[212:215], a[204:207], a[40:43], v[212:215]
buffer_load_dwordx4 v7, s[12:15], s63 offen nt lds
v_mfma_f32_16x16x32_bf16 v[212:215], a[208:211], a[52:55], v[212:215]
s_add_u32 m0, s61, 16384
v_mul_f32 v64, s66, v64
v_mul_f32 v65, s66, v65
v_mfma_f32_16x16x32_bf16 v[212:215], a[212:215], a[64:67], v[212:215]
s_mov_b32 s63, 86016
buffer_load_dwordx4 v6, s[12:15], s62 offen nt lds
v_mfma_f32_16x16x32_bf16 v[216:219], a[200:203], a[32:35], v[216:219]
s_add_u32 m0, s61, 20480
ds_read_b64_tr_b16 a[200:201], v18 offset:0
v_mul_f32 v66, s66, v66
v_mfma_f32_16x16x32_bf16 v[216:219], a[204:207], a[44:47], v[216:219]
s_mov_b32 s62, 90112
ds_read_b64_tr_b16 a[202:203], v18 offset:512
v_mul_f32 v67, s66, v67
v_mfma_f32_16x16x32_bf16 v[216:219], a[208:211], a[56:59], v[216:219]
ds_read_b64_tr_b16 a[204:205], v18 offset:8192
v_cvt_pk_bf16_f32 v48, v48, v49
v_mfma_f32_16x16x32_bf16 v[216:219], a[212:215], a[68:71], v[216:219]
ds_read_b64_tr_b16 a[206:207], v18 offset:8704
v_cvt_pk_bf16_f32 v50, v50, v51
v_mfma_f32_16x16x32_bf16 v[220:223], a[216:219], a[24:27], v[220:223]
ds_read_b64_tr_b16 a[208:209], v18 offset:16384
v_cndmask_b32 v136, v232, v244, s[98:99]
v_mfma_f32_16x16x32_bf16 v[220:223], a[220:223], a[36:39], v[220:223]
ds_read_b64_tr_b16 a[210:211], v18 offset:16896
v_cndmask_b32 v138, v244, v232, s[98:99]
v_mfma_f32_16x16x32_bf16 v[220:223], a[224:227], a[48:51], v[220:223]
ds_read_b64_tr_b16 a[212:213], v18 offset:24576
v_cndmask_b32 v137, v234, v246, s[98:99]
v_mfma_f32_16x16x32_bf16 v[220:223], a[228:231], a[60:63], v[220:223]
ds_read_b64_tr_b16 a[214:215], v18 offset:25088
v_cndmask_b32 v139, v246, v234, s[98:99]
v_mfma_f32_16x16x32_bf16 v[224:227], a[216:219], a[28:31], v[224:227]
v_cvt_pk_bf16_f32 v52, v52, v53
v_cvt_pk_bf16_f32 v54, v54, v55
v_mfma_f32_16x16x32_bf16 v[224:227], a[220:223], a[40:43], v[224:227]
v_cndmask_b32 v140, v236, v248, s[98:99]
v_cndmask_b32 v142, v248, v236, s[98:99]
v_mfma_f32_16x16x32_bf16 v[224:227], a[224:227], a[52:55], v[224:227]
v_cndmask_b32 v141, v238, v250, s[98:99]
v_cndmask_b32 v143, v250, v238, s[98:99]
v_mfma_f32_16x16x32_bf16 v[224:227], a[228:231], a[64:67], v[224:227]
v_cvt_pk_bf16_f32 v56, v56, v57
v_cvt_pk_bf16_f32 v58, v58, v59
v_mfma_f32_16x16x32_bf16 v[228:231], a[216:219], a[32:35], v[228:231]
ds_read_b64_tr_b16 a[216:217], v19 offset:0
v_cndmask_b32 v144, v240, v252, s[98:99]
v_mfma_f32_16x16x32_bf16 v[228:231], a[220:223], a[44:47], v[228:231]
ds_read_b64_tr_b16 a[218:219], v19 offset:512
v_cndmask_b32 v146, v252, v240, s[98:99]
v_mfma_f32_16x16x32_bf16 v[228:231], a[224:227], a[56:59], v[228:231]
ds_read_b64_tr_b16 a[220:221], v19 offset:8192
v_cndmask_b32 v145, v242, v254, s[98:99]
v_mfma_f32_16x16x32_bf16 v[228:231], a[228:231], a[68:71], v[228:231]
s_waitcnt lgkmcnt(3)
ds_read_b64_tr_b16 a[222:223], v19 offset:8704
v_cndmask_b32 v147, v254, v242, s[98:99]
v_mfma_f32_16x16x32_bf16 v[184:187], a[168:171], a[72:75], v[184:187]
ds_read_b64_tr_b16 a[224:225], v19 offset:16384
v_cvt_pk_bf16_f32 v60, v60, v61
v_mfma_f32_16x16x32_bf16 v[184:187], a[172:175], a[84:87], v[184:187]
ds_read_b64_tr_b16 a[226:227], v19 offset:16896
v_cvt_pk_bf16_f32 v62, v62, v63
v_mfma_f32_16x16x32_bf16 v[184:187], a[176:179], a[96:99], v[184:187]
ds_read_b64_tr_b16 a[228:229], v19 offset:24576
v_cvt_pk_bf16_f32 v64, v64, v65
v_mfma_f32_16x16x32_bf16 v[184:187], a[180:183], a[108:111], v[184:187]
ds_read_b64_tr_b16 a[230:231], v19 offset:25088
v_cvt_pk_bf16_f32 v66, v66, v67
v_mfma_f32_16x16x32_bf16 v[188:191], a[168:171], a[76:79], v[188:191]
v_cndmask_b32 v148, v44, v56, s[98:99]
v_cndmask_b32 v150, v56, v44, s[98:99]
v_mfma_f32_16x16x32_bf16 v[188:191], a[172:175], a[88:91], v[188:191]
v_cndmask_b32 v149, v46, v58, s[98:99]
v_cndmask_b32 v151, v58, v46, s[98:99]
v_mfma_f32_16x16x32_bf16 v[188:191], a[176:179], a[100:103], v[188:191]
v_cndmask_b32 v152, v48, v60, s[98:99]
v_cndmask_b32 v154, v60, v48, s[98:99]
v_mfma_f32_16x16x32_bf16 v[188:191], a[180:183], a[112:115], v[188:191]
v_cndmask_b32 v153, v50, v62, s[98:99]
v_cndmask_b32 v155, v62, v50, s[98:99]
v_mfma_f32_16x16x32_bf16 v[192:195], a[168:171], a[80:83], v[192:195]
v_cndmask_b32 v156, v52, v64, s[98:99]
v_cndmask_b32 v158, v64, v52, s[98:99]
v_mfma_f32_16x16x32_bf16 v[192:195], a[172:175], a[92:95], v[192:195]
s_waitcnt vmcnt(5) lgkmcnt(0)
s_barrier
v_cndmask_b32 v157, v54, v66, s[98:99]
v_mfma_f32_16x16x32_bf16 v[192:195], a[176:179], a[104:107], v[192:195]
v_add_u32 v16, 0xffff8000, v16
v_cndmask_b32 v159, v66, v54, s[98:99]
v_mfma_f32_16x16x32_bf16 v[192:195], a[180:183], a[116:119], v[192:195]
ds_read_b64_tr_b16 a[168:169], v16 offset:0
v_add_u32 v17, 0xffff8000, v17
v_mfma_f32_16x16x32_bf16 v[196:199], a[184:187], a[72:75], v[196:199]
ds_read_b64_tr_b16 a[170:171], v16 offset:512
v_add_u32 v18, 0xffff8000, v18
v_mfma_f32_16x16x32_bf16 v[196:199], a[188:191], a[84:87], v[196:199]
ds_read_b64_tr_b16 a[172:173], v16 offset:8192
v_add_u32 v19, 0xffff8000, v19
v_mfma_f32_16x16x32_bf16 v[196:199], a[192:195], a[96:99], v[196:199]
buffer_load_dwordx4 v7, s[12:15], s63 offen nt lds
v_mfma_f32_16x16x32_bf16 v[196:199], a[196:199], a[108:111], v[196:199]
s_add_u32 m0, s61, 24576
ds_read_b64_tr_b16 a[174:175], v16 offset:8704
v_mfma_f32_16x16x32_bf16 v[200:203], a[184:187], a[76:79], v[200:203]
s_mov_b32 s63, 94208
buffer_load_dwordx4 v6, s[12:15], s62 offen nt lds
v_mfma_f32_16x16x32_bf16 v[200:203], a[188:191], a[88:91], v[200:203]
s_add_u32 m0, s61, 28672
ds_read_b64_tr_b16 a[176:177], v16 offset:16384
v_mfma_f32_16x16x32_bf16 v[200:203], a[192:195], a[100:103], v[200:203]
s_mov_b32 s62, 98304
buffer_load_dwordx4 v7, s[12:15], s63 offen nt lds
v_mfma_f32_16x16x32_bf16 v[200:203], a[196:199], a[112:115], v[200:203]
s_add_u32 m0, s61, 65536
ds_read_b64_tr_b16 a[178:179], v16 offset:16896
v_mfma_f32_16x16x32_bf16 v[204:207], a[184:187], a[80:83], v[204:207]
s_mov_b32 s63, 102400
ds_read_b64_tr_b16 a[180:181], v16 offset:24576
v_mfma_f32_16x16x32_bf16 v[204:207], a[188:191], a[92:95], v[204:207]
ds_read_b64_tr_b16 a[182:183], v16 offset:25088
v_mfma_f32_16x16x32_bf16 v[204:207], a[192:195], a[104:107], v[204:207]
ds_read_b64_tr_b16 a[184:185], v17 offset:0
v_mfma_f32_16x16x32_bf16 v[204:207], a[196:199], a[116:119], v[204:207]
buffer_load_dwordx4 v6, s[12:15], s62 offen nt lds
v_mfma_f32_16x16x32_bf16 v[208:211], a[200:203], a[72:75], v[208:211]
ds_read_b64_tr_b16 a[186:187], v17 offset:512
v_mfma_f32_16x16x32_bf16 v[208:211], a[204:207], a[84:87], v[208:211]
ds_read_b64_tr_b16 a[188:189], v17 offset:8192
v_mfma_f32_16x16x32_bf16 v[208:211], a[208:211], a[96:99], v[208:211]
ds_read_b64_tr_b16 a[190:191], v17 offset:8704
v_mfma_f32_16x16x32_bf16 v[208:211], a[212:215], a[108:111], v[208:211]
s_add_u32 m0, s61, 69632
ds_read_b64_tr_b16 a[192:193], v17 offset:16384
v_mfma_f32_16x16x32_bf16 v[212:215], a[200:203], a[76:79], v[212:215]
s_mov_b32 s62, 106496
buffer_load_dwordx4 v7, s[12:15], s63 offen nt lds
v_mfma_f32_16x16x32_bf16 v[212:215], a[204:207], a[88:91], v[212:215]
s_add_u32 m0, s61, 73728
ds_read_b64_tr_b16 a[194:195], v17 offset:16896
v_mfma_f32_16x16x32_bf16 v[212:215], a[208:211], a[100:103], v[212:215]
s_mov_b32 s63, 110592
ds_read_b64_tr_b16 a[196:197], v17 offset:24576
v_mfma_f32_16x16x32_bf16 v[212:215], a[212:215], a[112:115], v[212:215]
ds_read_b64_tr_b16 a[198:199], v17 offset:25088
v_mfma_f32_16x16x32_bf16 v[216:219], a[200:203], a[80:83], v[216:219]
buffer_load_dwordx4 v6, s[12:15], s62 offen nt lds
v_mfma_f32_16x16x32_bf16 v[216:219], a[204:207], a[92:95], v[216:219]
s_add_u32 m0, s61, 77824
ds_read_b64_tr_b16 a[200:201], v18 offset:0
v_mfma_f32_16x16x32_bf16 v[216:219], a[208:211], a[104:107], v[216:219]
s_mov_b32 s62, 114688
ds_read_b64_tr_b16 a[202:203], v18 offset:512
v_mfma_f32_16x16x32_bf16 v[216:219], a[212:215], a[116:119], v[216:219]
ds_read_b64_tr_b16 a[204:205], v18 offset:8192
v_mfma_f32_16x16x32_bf16 v[220:223], a[216:219], a[72:75], v[220:223]
buffer_load_dwordx4 v7, s[12:15], s63 offen nt lds
v_mfma_f32_16x16x32_bf16 v[220:223], a[220:223], a[84:87], v[220:223]
ds_read_b64_tr_b16 a[206:207], v18 offset:8704
v_mfma_f32_16x16x32_bf16 v[220:223], a[224:227], a[96:99], v[220:223]
ds_read_b64_tr_b16 a[208:209], v18 offset:16384
v_mfma_f32_16x16x32_bf16 v[220:223], a[228:231], a[108:111], v[220:223]
s_add_u32 m0, s61, 81920
ds_read_b64_tr_b16 a[210:211], v18 offset:16896
v_mfma_f32_16x16x32_bf16 v[224:227], a[216:219], a[76:79], v[224:227]
s_mov_b32 s63, 118784
ds_read_b64_tr_b16 a[212:213], v18 offset:24576
v_mfma_f32_16x16x32_bf16 v[224:227], a[220:223], a[88:91], v[224:227]
ds_read_b64_tr_b16 a[214:215], v18 offset:25088
v_mfma_f32_16x16x32_bf16 v[224:227], a[224:227], a[100:103], v[224:227]
v_mfma_f32_16x16x32_bf16 v[224:227], a[228:231], a[112:115], v[224:227]
v_mfma_f32_16x16x32_bf16 v[228:231], a[216:219], a[80:83], v[228:231]
ds_read_b64_tr_b16 a[216:217], v19 offset:0
v_mfma_f32_16x16x32_bf16 v[228:231], a[220:223], a[92:95], v[228:231]
ds_read_b64_tr_b16 a[218:219], v19 offset:512
v_mfma_f32_16x16x32_bf16 v[228:231], a[224:227], a[104:107], v[228:231]
ds_read_b64_tr_b16 a[220:221], v19 offset:8192
v_mfma_f32_16x16x32_bf16 v[228:231], a[228:231], a[116:119], v[228:231]
s_waitcnt lgkmcnt(4)
ds_read_b64_tr_b16 a[222:223], v19 offset:8704
v_mfma_f32_16x16x32_bf16 v[184:187], a[168:171], a[120:123], v[184:187]
buffer_load_dwordx4 v6, s[12:15], s62 offen nt lds
v_mfma_f32_16x16x32_bf16 v[184:187], a[172:175], a[132:135], v[184:187]
ds_read_b64_tr_b16 a[224:225], v19 offset:16384
v_mfma_f32_16x16x32_bf16 v[184:187], a[176:179], a[144:147], v[184:187]
ds_read_b64_tr_b16 a[226:227], v19 offset:16896
v_mfma_f32_16x16x32_bf16 v[184:187], a[180:183], a[156:159], v[184:187]
s_add_u32 m0, s61, 86016
ds_read_b64_tr_b16 a[228:229], v19 offset:24576
v_mfma_f32_16x16x32_bf16 v[188:191], a[168:171], a[124:127], v[188:191]
s_mov_b32 s62, 122880
ds_read_b64_tr_b16 a[230:231], v19 offset:25088
v_mfma_f32_16x16x32_bf16 v[188:191], a[172:175], a[136:139], v[188:191]
v_mfma_f32_16x16x32_bf16 v[188:191], a[176:179], a[148:151], v[188:191]
v_mul_f32 v184, s66, v184
v_mul_f32 v185, s66, v185
v_mfma_f32_16x16x32_bf16 v[188:191], a[180:183], a[160:163], v[188:191]
v_mul_f32 v186, s66, v186
v_mul_f32 v187, s66, v187
v_mfma_f32_16x16x32_bf16 v[192:195], a[168:171], a[128:131], v[192:195]
v_cvt_pk_bf16_f32 v184, v184, v185
v_cvt_pk_bf16_f32 v186, v186, v187
v_mfma_f32_16x16x32_bf16 v[192:195], a[172:175], a[140:143], v[192:195]
v_mfma_f32_16x16x32_bf16 v[192:195], a[176:179], a[152:155], v[192:195]
s_waitcnt lgkmcnt(0)
s_barrier
ds_read_b128 a[0:3], v20 offset:0
v_mfma_f32_16x16x32_bf16 v[192:195], a[180:183], a[164:167], v[192:195]
ds_read_b128 a[4:7], v21 offset:0
v_mul_f32 v188, s66, v188
v_mfma_f32_16x16x32_bf16 v[196:199], a[184:187], a[120:123], v[196:199]
ds_read_b128 a[8:11], v22 offset:0
v_mul_f32 v189, s66, v189
v_mfma_f32_16x16x32_bf16 v[196:199], a[188:191], a[132:135], v[196:199]
ds_read_b128 a[12:15], v23 offset:0
v_mul_f32 v190, s66, v190
v_mfma_f32_16x16x32_bf16 v[196:199], a[192:195], a[144:147], v[196:199]
buffer_load_dwordx4 v7, s[12:15], s63 offen nt lds
v_mfma_f32_16x16x32_bf16 v[196:199], a[196:199], a[156:159], v[196:199]
s_add_u32 m0, s61, 90112
ds_read_b128 a[16:19], v20 offset:256
v_mul_f32 v191, s66, v191
v_mfma_f32_16x16x32_bf16 v[200:203], a[184:187], a[124:127], v[200:203]
s_mov_b32 s63, 126976
ds_read_b128 a[20:23], v21 offset:256
v_mul_f32 v192, s66, v192
v_mfma_f32_16x16x32_bf16 v[200:203], a[188:191], a[136:139], v[200:203]
ds_read_b128 a[32:35], v20 offset:8192
v_mul_f32 v193, s66, v193
v_mfma_f32_16x16x32_bf16 v[200:203], a[192:195], a[148:151], v[200:203]
ds_read_b128 a[36:39], v21 offset:8192
v_mul_f32 v194, s66, v194
v_mfma_f32_16x16x32_bf16 v[200:203], a[196:199], a[160:163], v[200:203]
ds_read_b128 a[40:43], v22 offset:8192
v_mul_f32 v195, s66, v195
v_mfma_f32_16x16x32_bf16 v[204:207], a[184:187], a[128:131], v[204:207]
ds_read_b128 a[44:47], v23 offset:8192
v_mul_f32 v196, s66, v196
v_mfma_f32_16x16x32_bf16 v[204:207], a[188:191], a[140:143], v[204:207]
ds_read_b128 a[48:51], v20 offset:8448
v_mul_f32 v197, s66, v197
v_mfma_f32_16x16x32_bf16 v[204:207], a[192:195], a[152:155], v[204:207]
ds_read_b128 a[52:55], v21 offset:8448
v_mul_f32 v198, s66, v198
v_mfma_f32_16x16x32_bf16 v[204:207], a[196:199], a[164:167], v[204:207]
ds_read_b128 a[24:27], v22 offset:256
v_mul_f32 v199, s66, v199
v_mfma_f32_16x16x32_bf16 v[208:211], a[200:203], a[120:123], v[208:211]
ds_read_b128 a[28:31], v23 offset:256
v_cvt_pk_bf16_f32 v188, v188, v189
v_mfma_f32_16x16x32_bf16 v[208:211], a[204:207], a[132:135], v[208:211]
ds_read_b128 a[56:59], v22 offset:8448
v_cvt_pk_bf16_f32 v190, v190, v191
v_mfma_f32_16x16x32_bf16 v[208:211], a[208:211], a[144:147], v[208:211]
ds_read_b128 a[60:63], v23 offset:8448
v_mul_f32 v200, s66, v200
v_mfma_f32_16x16x32_bf16 v[208:211], a[212:215], a[156:159], v[208:211]
v_mul_f32 v201, s66, v201
v_mul_f32 v202, s66, v202
v_mfma_f32_16x16x32_bf16 v[212:215], a[200:203], a[124:127], v[212:215]
buffer_load_dwordx4 v6, s[12:15], s62 offen nt lds
v_mfma_f32_16x16x32_bf16 v[212:215], a[204:207], a[136:139], v[212:215]
s_add_u32 m0, s61, 94208
v_cvt_pk_bf16_f32 v196, v196, v197
v_mul_f32 v203, s66, v203
v_mfma_f32_16x16x32_bf16 v[212:215], a[208:211], a[148:151], v[212:215]
s_mov_b32 s62, 131072
v_cvt_pk_bf16_f32 v198, v198, v199
v_cndmask_b32 v160, v184, v196, s[98:99]
v_mfma_f32_16x16x32_bf16 v[212:215], a[212:215], a[160:163], v[212:215]
v_cndmask_b32 v162, v196, v184, s[98:99]
v_cndmask_b32 v161, v186, v198, s[98:99]
v_mfma_f32_16x16x32_bf16 v[216:219], a[200:203], a[128:131], v[216:219]
v_cndmask_b32 v163, v198, v186, s[98:99]
v_cvt_pk_bf16_f32 v200, v200, v201
v_mfma_f32_16x16x32_bf16 v[216:219], a[204:207], a[140:143], v[216:219]
v_cvt_pk_bf16_f32 v202, v202, v203
v_cndmask_b32 v164, v188, v200, s[98:99]
v_mfma_f32_16x16x32_bf16 v[216:219], a[208:211], a[152:155], v[216:219]
v_cndmask_b32 v166, v200, v188, s[98:99]
v_cndmask_b32 v165, v190, v202, s[98:99]
v_mfma_f32_16x16x32_bf16 v[216:219], a[212:215], a[164:167], v[216:219]
v_cndmask_b32 v167, v202, v190, s[98:99]
v_cvt_pk_bf16_f32 v192, v192, v193
v_mfma_f32_16x16x32_bf16 v[220:223], a[216:219], a[120:123], v[220:223]
v_cvt_pk_bf16_f32 v194, v194, v195
v_mul_f32 v204, s66, v204
v_mfma_f32_16x16x32_bf16 v[220:223], a[220:223], a[132:135], v[220:223]
v_mul_f32 v205, s66, v205
v_cvt_pk_bf16_f32 v204, v204, v205
v_mfma_f32_16x16x32_bf16 v[220:223], a[224:227], a[144:147], v[220:223]
v_mul_f32 v206, s66, v206
v_mul_f32 v207, s66, v207
v_mfma_f32_16x16x32_bf16 v[220:223], a[228:231], a[156:159], v[220:223]
v_cvt_pk_bf16_f32 v206, v206, v207
v_cndmask_b32 v168, v192, v204, s[98:99]
v_mfma_f32_16x16x32_bf16 v[224:227], a[216:219], a[124:127], v[224:227]
v_cndmask_b32 v170, v204, v192, s[98:99]
v_cndmask_b32 v169, v194, v206, s[98:99]
v_mfma_f32_16x16x32_bf16 v[224:227], a[220:223], a[136:139], v[224:227]
v_cndmask_b32 v171, v206, v194, s[98:99]
v_mul_f32 v208, s66, v208
v_mfma_f32_16x16x32_bf16 v[224:227], a[224:227], a[148:151], v[224:227]
v_mul_f32 v209, s66, v209
v_cvt_pk_bf16_f32 v208, v208, v209
v_mfma_f32_16x16x32_bf16 v[224:227], a[228:231], a[160:163], v[224:227]
buffer_load_dwordx4 v7, s[12:15], s63 offen nt lds
v_mfma_f32_16x16x32_bf16 v[228:231], a[216:219], a[128:131], v[228:231]
s_add_u32 m0, s61, 32768
v_mul_f32 v210, s66, v210
v_mul_f32 v211, s66, v211
v_mfma_f32_16x16x32_bf16 v[228:231], a[220:223], a[140:143], v[228:231]
s_mov_b32 s63, 135168
v_cvt_pk_bf16_f32 v210, v210, v211
v_mul_f32 v220, s66, v220
v_mfma_f32_16x16x32_bf16 v[228:231], a[224:227], a[152:155], v[228:231]
v_mul_f32 v221, s66, v221
v_cvt_pk_bf16_f32 v220, v220, v221
v_mfma_f32_16x16x32_bf16 v[228:231], a[228:231], a[164:167], v[228:231]
s_waitcnt lgkmcnt(0)
v_mul_f32 v222, s66, v222
v_mul_f32 v223, s66, v223
v_mfma_f32_16x16x32_bf16 v[44:47], a[0:3], v[88:91], 0
v_cvt_pk_bf16_f32 v222, v222, v223
v_cndmask_b32 v172, v208, v220, s[98:99]
v_mfma_f32_16x16x32_bf16 v[44:47], a[4:7], v[100:103], v[44:47]
v_cndmask_b32 v174, v220, v208, s[98:99]
v_cndmask_b32 v173, v210, v222, s[98:99]
v_mfma_f32_16x16x32_bf16 v[44:47], a[8:11], v[112:115], v[44:47]
v_cndmask_b32 v175, v222, v210, s[98:99]
v_mul_f32 v212, s66, v212
v_mfma_f32_16x16x32_bf16 v[44:47], a[12:15], v[124:127], v[44:47]
v_mul_f32 v213, s66, v213
v_cvt_pk_bf16_f32 v212, v212, v213
v_mfma_f32_16x16x32_bf16 v[44:47], a[16:19], v[136:139], v[44:47]
v_mul_f32 v214, s66, v214
v_mul_f32 v215, s66, v215
v_mfma_f32_16x16x32_bf16 v[44:47], a[20:23], v[148:151], v[44:47]
s_mov_b32 s67, 0x4e800000
v_cvt_pk_bf16_f32 v214, v214, v215
v_mul_f32 v224, s66, v224
v_mfma_f32_16x16x32_bf16 v[48:51], a[0:3], v[92:95], 0
v_mul_f32 v225, s66, v225
v_cvt_pk_bf16_f32 v224, v224, v225
v_mfma_f32_16x16x32_bf16 v[48:51], a[4:7], v[104:107], v[48:51]
v_mul_f32 v226, s66, v226
v_mul_f32 v227, s66, v227
v_mfma_f32_16x16x32_bf16 v[48:51], a[8:11], v[116:119], v[48:51]
v_cvt_pk_bf16_f32 v226, v226, v227
v_cndmask_b32 v176, v212, v224, s[98:99]
v_mfma_f32_16x16x32_bf16 v[48:51], a[12:15], v[128:131], v[48:51]
buffer_load_dwordx4 v6, s[12:15], s62 offen nt lds
v_mfma_f32_16x16x32_bf16 v[48:51], a[16:19], v[140:143], v[48:51]
s_add_u32 m0, s61, 36864
v_cndmask_b32 v178, v224, v212, s[98:99]
v_cndmask_b32 v177, v214, v226, s[98:99]
v_mfma_f32_16x16x32_bf16 v[48:51], a[20:23], v[152:155], v[48:51]
s_mov_b32 s62, 139264
v_cndmask_b32 v179, v226, v214, s[98:99]
v_mul_f32 v216, s66, v216
v_mfma_f32_16x16x32_bf16 v[52:55], a[0:3], v[96:99], 0
ds_read_b128 a[0:3], v20 offset:16384
v_mul_f32 v217, s66, v217
v_mfma_f32_16x16x32_bf16 v[52:55], a[4:7], v[108:111], v[52:55]
ds_read_b128 a[4:7], v21 offset:16384
v_cvt_pk_bf16_f32 v216, v216, v217
v_mfma_f32_16x16x32_bf16 v[52:55], a[8:11], v[120:123], v[52:55]
ds_read_b128 a[8:11], v22 offset:16384
v_mul_f32 v218, s66, v218
v_mfma_f32_16x16x32_bf16 v[52:55], a[12:15], v[132:135], v[52:55]
ds_read_b128 a[12:15], v23 offset:16384
v_mul_f32 v219, s66, v219
v_mfma_f32_16x16x32_bf16 v[52:55], a[16:19], v[144:147], v[52:55]
ds_read_b128 a[16:19], v20 offset:16640
v_cvt_pk_bf16_f32 v218, v218, v219
v_mfma_f32_16x16x32_bf16 v[52:55], a[20:23], v[156:159], v[52:55]
ds_read_b128 a[20:23], v21 offset:16640
v_mul_f32 v228, s66, v228
v_mfma_f32_16x16x32_bf16 v[56:59], a[32:35], v[88:91], 0
v_mul_f32 v229, s66, v229
v_cvt_pk_bf16_f32 v228, v228, v229
v_mfma_f32_16x16x32_bf16 v[56:59], a[36:39], v[100:103], v[56:59]
v_mul_f32 v230, s66, v230
v_mul_f32 v231, s66, v231
v_mfma_f32_16x16x32_bf16 v[56:59], a[40:43], v[112:115], v[56:59]
v_cvt_pk_bf16_f32 v230, v230, v231
v_cndmask_b32 v180, v216, v228, s[98:99]
v_mfma_f32_16x16x32_bf16 v[56:59], a[44:47], v[124:127], v[56:59]
v_cndmask_b32 v182, v228, v216, s[98:99]
v_cndmask_b32 v181, v218, v230, s[98:99]
v_mfma_f32_16x16x32_bf16 v[56:59], a[48:51], v[136:139], v[56:59]
v_cndmask_b32 v183, v230, v218, s[98:99]
v_mfma_f32_16x16x32_bf16 v[56:59], a[52:55], v[148:151], v[56:59]
s_cmp_eq_u32 s68, 1
s_cbranch_scc1 L_maxpass
L_maxret:
buffer_load_dwordx4 v7, s[12:15], s63 offen nt lds
v_mfma_f32_16x16x32_bf16 v[60:63], a[32:35], v[92:95], 0
s_add_u32 m0, s61, 40960
v_mfma_f32_16x16x32_bf16 v[60:63], a[36:39], v[104:107], v[60:63]
s_mov_b32 s63, 143360
v_mfma_f32_16x16x32_bf16 v[60:63], a[40:43], v[116:119], v[60:63]
v_mfma_f32_16x16x32_bf16 v[60:63], a[44:47], v[128:131], v[60:63]
v_mfma_f32_16x16x32_bf16 v[60:63], a[48:51], v[140:143], v[60:63]
v_mfma_f32_16x16x32_bf16 v[60:63], a[52:55], v[152:155], v[60:63]
v_mfma_f32_16x16x32_bf16 v[64:67], a[32:35], v[96:99], 0
v_mfma_f32_16x16x32_bf16 v[64:67], a[36:39], v[108:111], v[64:67]
v_mfma_f32_16x16x32_bf16 v[64:67], a[40:43], v[120:123], v[64:67]
v_mfma_f32_16x16x32_bf16 v[64:67], a[44:47], v[132:135], v[64:67]
v_mfma_f32_16x16x32_bf16 v[64:67], a[48:51], v[144:147], v[64:67]
v_mfma_f32_16x16x32_bf16 v[64:67], a[52:55], v[156:159], v[64:67]
v_mfma_f32_16x16x32_bf16 v[44:47], a[24:27], v[160:163], v[44:47]
v_mfma_f32_16x16x32_bf16 v[44:47], a[28:31], v[172:175], v[44:47]
buffer_load_dwordx4 v6, s[12:15], s62 offen nt lds
v_mfma_f32_16x16x32_bf16 v[48:51], a[24:27], v[164:167], v[48:51]
s_add_u32 m0, s61, 45056
v_mfma_f32_16x16x32_bf16 v[48:51], a[28:31], v[176:179], v[48:51]
s_mov_b32 s62, 147456
v_mfma_f32_16x16x32_bf16 v[52:55], a[24:27], v[168:171], v[52:55]
ds_read_b128 a[24:27], v22 offset:16640
v_max3_f32 v76, v44, v45, v46
v_mfma_f32_16x16x32_bf16 v[52:55], a[28:31], v[180:183], v[52:55]
ds_read_b128 a[28:31], v23 offset:16640
v_max3_f32 v76, v76, v47, v84
v_mfma_f32_16x16x32_bf16 v[56:59], a[56:59], v[160:163], v[56:59]
ds_read_b128 a[32:35], v20 offset:24576
v_mov_b32 v72, v76
v_mfma_f32_16x16x32_bf16 v[56:59], a[60:63], v[172:175], v[56:59]
ds_read_b128 a[36:39], v21 offset:24576
v_max3_f32 v77, v48, v49, v50
v_mfma_f32_16x16x32_bf16 v[60:63], a[56:59], v[164:167], v[60:63]
v_permlane32_swap_b32 v76, v72
v_mfma_f32_16x16x32_bf16 v[60:63], a[60:63], v[176:179], v[60:63]
ds_read_b128 a[40:43], v22 offset:24576
v_max3_f32 v77, v77, v51, v85
v_mfma_f32_16x16x32_bf16 v[64:67], a[56:59], v[168:171], v[64:67]
ds_read_b128 a[44:47], v23 offset:24576
v_mov_b32 v73, v77
v_mfma_f32_16x16x32_bf16 v[64:67], a[60:63], v[180:183], v[64:67]
s_waitcnt lgkmcnt(5)
ds_read_b128 a[48:51], v20 offset:24832
v_max_f32 v76, v76, v72
v_mfma_f32_16x16x32_bf16 v[232:235], a[0:3], v[88:91], 0
ds_read_b128 a[52:55], v21 offset:24832
v_mov_b32 v72, v76
v_mfma_f32_16x16x32_bf16 v[232:235], a[4:7], v[100:103], v[232:235]
v_permlane32_swap_b32 v77, v73
v_mfma_f32_16x16x32_bf16 v[232:235], a[8:11], v[112:115], v[232:235]
ds_read_b128 a[56:59], v22 offset:24832
v_max3_f32 v78, v52, v53, v54
v_mfma_f32_16x16x32_bf16 v[232:235], a[12:15], v[124:127], v[232:235]
ds_read_b128 a[60:63], v23 offset:24832
v_max3_f32 v78, v78, v55, v86
v_mfma_f32_16x16x32_bf16 v[232:235], a[16:19], v[136:139], v[232:235]
v_max_f32 v77, v77, v73
v_mov_b32 v74, v78
v_mfma_f32_16x16x32_bf16 v[232:235], a[20:23], v[148:151], v[232:235]
v_permlane16_swap_b32 v76, v72
v_mfma_f32_16x16x32_bf16 v[232:235], a[24:27], v[160:163], v[232:235]
s_waitcnt lgkmcnt(3)
v_max_f32 v76, v76, v72
v_mov_b32 v73, v77
v_mfma_f32_16x16x32_bf16 v[232:235], a[28:31], v[172:175], v[232:235]
v_sub_f32 v32, 0, v76
v_sub_f32 v33, 0, v76
v_mfma_f32_16x16x32_bf16 v[236:239], a[0:3], v[92:95], 0
v_permlane32_swap_b32 v78, v74
v_mfma_f32_16x16x32_bf16 v[236:239], a[4:7], v[104:107], v[236:239]
s_waitcnt lgkmcnt(0)
s_barrier
v_max_f32 v78, v78, v74
v_mfma_f32_16x16x32_bf16 v[236:239], a[8:11], v[116:119], v[236:239]
v_permlane16_swap_b32 v77, v73
v_mfma_f32_16x16x32_bf16 v[236:239], a[12:15], v[128:131], v[236:239]
v_max_f32 v77, v77, v73
v_mov_b32 v74, v78
v_mfma_f32_16x16x32_bf16 v[236:239], a[16:19], v[140:143], v[236:239]
v_sub_f32 v34, 0, v76
v_sub_f32 v36, 0, v77
v_mfma_f32_16x16x32_bf16 v[236:239], a[20:23], v[152:155], v[236:239]
v_permlane16_swap_b32 v78, v74
v_mfma_f32_16x16x32_bf16 v[236:239], a[24:27], v[164:167], v[236:239]
v_max_f32 v78, v78, v74
v_sub_f32 v40, 0, v78
v_mfma_f32_16x16x32_bf16 v[236:239], a[28:31], v[176:179], v[236:239]
v_sub_f32 v35, 0, v76
v_sub_f32 v37, 0, v77
v_mfma_f32_16x16x32_bf16 v[240:243], a[0:3], v[96:99], 0
v_sub_f32 v38, 0, v77
v_sub_f32 v39, 0, v77
v_mfma_f32_16x16x32_bf16 v[240:243], a[4:7], v[108:111], v[240:243]
buffer_load_dwordx4 v7, s[12:15], s63 offen nt lds
v_mfma_f32_16x16x32_bf16 v[240:243], a[8:11], v[120:123], v[240:243]
s_add_u32 m0, s61, 49152
v_sub_f32 v41, 0, v78
v_sub_f32 v42, 0, v78
v_mfma_f32_16x16x32_bf16 v[240:243], a[12:15], v[132:135], v[240:243]
s_mov_b32 s63, 151552
v_add_u32 v20, 0xffff8000, v20
v_sub_f32 v43, 0, v78
v_mfma_f32_16x16x32_bf16 v[240:243], a[16:19], v[144:147], v[240:243]
ds_read_b128 a[0:3], v20 offset:0
v_add_u32 v21, 0xffff8000, v21
v_mfma_f32_16x16x32_bf16 v[240:243], a[20:23], v[156:159], v[240:243]
ds_read_b128 a[4:7], v21 offset:0
v_add_u32 v22, 0xffff8000, v22
v_mfma_f32_16x16x32_bf16 v[240:243], a[24:27], v[168:171], v[240:243]
ds_read_b128 a[8:11], v22 offset:0
v_add_u32 v23, 0xffff8000, v23
v_mfma_f32_16x16x32_bf16 v[240:243], a[28:31], v[180:183], v[240:243]
buffer_load_dwordx4 v6, s[12:15], s62 offen nt lds
v_mfma_f32_16x16x32_bf16 v[244:247], a[32:35], v[88:91], v[32:35]
ds_read_b128 a[12:15], v23 offset:0
v_add_f32 v44, v44, v32
v_mfma_f32_16x16x32_bf16 v[244:247], a[36:39], v[100:103], v[244:247]
ds_read_b128 a[16:19], v20 offset:256
v_add_f32 v45, v45, v32
v_mfma_f32_16x16x32_bf16 v[244:247], a[40:43], v[112:115], v[244:247]
ds_read_b128 a[20:23], v21 offset:256
v_add_f32 v46, v46, v32
v_mfma_f32_16x16x32_bf16 v[244:247], a[44:47], v[124:127], v[244:247]
ds_read_b128 a[24:27], v22 offset:256
v_add_f32 v47, v47, v32
v_mfma_f32_16x16x32_bf16 v[244:247], a[48:51], v[136:139], v[244:247]
ds_read_b128 a[28:31], v23 offset:256
v_add_f32 v48, v48, v36
v_mfma_f32_16x16x32_bf16 v[244:247], a[52:55], v[148:151], v[244:247]
v_exp_f32 v44, v44
v_mfma_f32_16x16x32_bf16 v[244:247], a[56:59], v[160:163], v[244:247]
v_exp_f32 v45, v45
v_mfma_f32_16x16x32_bf16 v[244:247], a[60:63], v[172:175], v[244:247]
s_add_u32 m0, s61, 53248
v_exp_f32 v46, v46
v_mfma_f32_16x16x32_bf16 v[248:251], a[32:35], v[92:95], v[36:39]
s_mov_b32 s62, 155648
buffer_load_dwordx4 v7, s[12:15], s63 offen nt lds
v_mfma_f32_16x16x32_bf16 v[248:251], a[36:39], v[104:107], v[248:251]
s_add_u32 m0, s61, 57344
v_exp_f32 v47, v47
v_mfma_f32_16x16x32_bf16 v[248:251], a[40:43], v[116:119], v[248:251]
s_mov_b32 s63, 159744
v_exp_f32 v48, v48
v_mfma_f32_16x16x32_bf16 v[248:251], a[44:47], v[128:131], v[248:251]
v_exp_f32 v244, v244
v_mfma_f32_16x16x32_bf16 v[248:251], a[48:51], v[140:143], v[248:251]
v_exp_f32 v245, v245
v_mfma_f32_16x16x32_bf16 v[248:251], a[52:55], v[152:155], v[248:251]
v_exp_f32 v246, v246
v_mfma_f32_16x16x32_bf16 v[248:251], a[56:59], v[164:167], v[248:251]
v_exp_f32 v247, v247
v_mfma_f32_16x16x32_bf16 v[248:251], a[60:63], v[176:179], v[248:251]
v_cvt_pk_bf16_f32 v184, v44, v45
v_cvt_pk_bf16_f32 v185, v46, v47
v_mfma_f32_16x16x32_bf16 v[252:255], a[32:35], v[96:99], v[40:43]
ds_read_b128 a[32:35], v20 offset:8192
v_add_f32 v49, v49, v36
v_mfma_f32_16x16x32_bf16 v[252:255], a[36:39], v[108:111], v[252:255]
v_exp_f32 v49, v49
v_mfma_f32_16x16x32_bf16 v[252:255], a[40:43], v[120:123], v[252:255]
ds_read_b128 a[36:39], v21 offset:8192
v_add_f32 v50, v50, v36
v_mfma_f32_16x16x32_bf16 v[252:255], a[44:47], v[132:135], v[252:255]
v_exp_f32 v50, v50
v_mfma_f32_16x16x32_bf16 v[252:255], a[48:51], v[144:147], v[252:255]
ds_read_b128 a[40:43], v22 offset:8192
v_add_f32 v51, v51, v36
v_mfma_f32_16x16x32_bf16 v[252:255], a[52:55], v[156:159], v[252:255]
v_exp_f32 v51, v51
v_mfma_f32_16x16x32_bf16 v[252:255], a[56:59], v[168:171], v[252:255]
buffer_load_dwordx4 v6, s[12:15], s62 offen nt lds
v_mfma_f32_16x16x32_bf16 v[252:255], a[60:63], v[180:183], v[252:255]
s_waitcnt lgkmcnt(2)
ds_read_b128 a[44:47], v23 offset:8192
v_cvt_pk_bf16_f32 v188, v48, v49
v_mfma_f32_16x16x32_bf16 v[44:47], a[0:3], v[88:91], v[32:35]
ds_read_b128 a[48:51], v20 offset:8448
v_cvt_pk_bf16_f32 v189, v50, v51
v_mfma_f32_16x16x32_bf16 v[44:47], a[4:7], v[100:103], v[44:47]
ds_read_b128 a[52:55], v21 offset:8448
v_add_f32 v52, v52, v40
v_mfma_f32_16x16x32_bf16 v[44:47], a[8:11], v[112:115], v[44:47]
v_exp_f32 v52, v52
v_mfma_f32_16x16x32_bf16 v[44:47], a[12:15], v[124:127], v[44:47]
ds_read_b128 a[56:59], v22 offset:8448
v_add_f32 v53, v53, v40
v_mfma_f32_16x16x32_bf16 v[44:47], a[16:19], v[136:139], v[44:47]
v_exp_f32 v53, v53
v_mfma_f32_16x16x32_bf16 v[44:47], a[20:23], v[148:151], v[44:47]
ds_read_b128 a[60:63], v23 offset:8448
v_add_f32 v54, v54, v40
v_mfma_f32_16x16x32_bf16 v[44:47], a[24:27], v[160:163], v[44:47]
v_exp_f32 v54, v54
v_mfma_f32_16x16x32_bf16 v[44:47], a[28:31], v[172:175], v[44:47]
s_add_u32 m0, s61, 61440
v_exp_f32 v248, v248
v_mfma_f32_16x16x32_bf16 v[48:51], a[0:3], v[92:95], v[36:39]
s_mov_b32 s62, 163840
v_exp_f32 v249, v249
v_mfma_f32_16x16x32_bf16 v[48:51], a[4:7], v[104:107], v[48:51]
v_exp_f32 v250, v250
v_mfma_f32_16x16x32_bf16 v[48:51], a[8:11], v[116:119], v[48:51]
v_exp_f32 v251, v251
v_mfma_f32_16x16x32_bf16 v[48:51], a[12:15], v[128:131], v[48:51]
v_exp_f32 v252, v252
v_mfma_f32_16x16x32_bf16 v[48:51], a[16:19], v[140:143], v[48:51]
v_cvt_pk_bf16_f32 v192, v52, v53
v_add_f32 v55, v55, v40
v_mfma_f32_16x16x32_bf16 v[48:51], a[20:23], v[152:155], v[48:51]
buffer_load_dwordx4 v7, s[12:15], s63 offen nt lds
v_mfma_f32_16x16x32_bf16 v[48:51], a[24:27], v[164:167], v[48:51]
s_add_u32 m0, s61, 131072
v_exp_f32 v55, v55
v_mfma_f32_16x16x32_bf16 v[48:51], a[28:31], v[176:179], v[48:51]
s_mov_b32 s63, 167936
v_cvt_pk_bf16_f32 v193, v54, v55
v_add_f32 v56, v56, v32
v_mfma_f32_16x16x32_bf16 v[52:55], a[0:3], v[96:99], v[40:43]
v_exp_f32 v56, v56
v_mfma_f32_16x16x32_bf16 v[52:55], a[4:7], v[108:111], v[52:55]
ds_read_b128 a[0:3], v20 offset:16384
v_add_f32 v57, v57, v32
v_mfma_f32_16x16x32_bf16 v[52:55], a[8:11], v[120:123], v[52:55]
v_exp_f32 v57, v57
v_mfma_f32_16x16x32_bf16 v[52:55], a[12:15], v[132:135], v[52:55]
ds_read_b128 a[4:7], v21 offset:16384
v_add_f32 v58, v58, v32
v_mfma_f32_16x16x32_bf16 v[52:55], a[16:19], v[144:147], v[52:55]
ds_read_b128 a[8:11], v22 offset:16384
v_add_f32 v59, v59, v32
v_mfma_f32_16x16x32_bf16 v[52:55], a[20:23], v[156:159], v[52:55]
v_exp_f32 v58, v58
v_mfma_f32_16x16x32_bf16 v[52:55], a[24:27], v[168:171], v[52:55]
v_exp_f32 v59, v59
v_mfma_f32_16x16x32_bf16 v[52:55], a[28:31], v[180:183], v[52:55]
v_cvt_pk_bf16_f32 v186, v56, v57
v_cvt_pk_bf16_f32 v187, v58, v59
v_mfma_f32_16x16x32_bf16 v[56:59], a[32:35], v[88:91], v[32:35]
s_waitcnt lgkmcnt(2)
ds_read_b128 a[12:15], v23 offset:16384
v_add_f32 v60, v60, v36
v_mfma_f32_16x16x32_bf16 v[56:59], a[36:39], v[100:103], v[56:59]
v_exp_f32 v60, v60
v_mfma_f32_16x16x32_bf16 v[56:59], a[40:43], v[112:115], v[56:59]
ds_read_b128 a[16:19], v20 offset:16640
v_add_f32 v61, v61, v36
v_mfma_f32_16x16x32_bf16 v[56:59], a[44:47], v[124:127], v[56:59]
buffer_load_dwordx4 v6, s[12:15], s62 offen nt lds
v_mfma_f32_16x16x32_bf16 v[56:59], a[48:51], v[136:139], v[56:59]
ds_read_b128 a[20:23], v21 offset:16640
v_add_f32 v62, v62, v36
v_mfma_f32_16x16x32_bf16 v[56:59], a[52:55], v[148:151], v[56:59]
ds_read_b128 a[24:27], v22 offset:16640
v_add_f32 v63, v63, v36
v_mfma_f32_16x16x32_bf16 v[56:59], a[56:59], v[160:163], v[56:59]
v_exp_f32 v61, v61
v_exp_f32 v62, v62
v_exp_f32 v63, v63
v_mfma_f32_16x16x32_bf16 v[56:59], a[60:63], v[172:175], v[56:59]
s_add_u32 m0, s61, 135168
v_cvt_pk_bf16_f32 v190, v60, v61
v_cvt_pk_bf16_f32 v191, v62, v63
v_mfma_f32_16x16x32_bf16 v[60:63], a[32:35], v[92:95], v[36:39]
s_mov_b32 s62, 172032
ds_read_b128 a[28:31], v23 offset:16640
v_lshlrev_b32 v1, 3, v2
v_mfma_f32_16x16x32_bf16 v[60:63], a[36:39], v[104:107], v[60:63]
v_exp_f32 v253, v253
v_mfma_f32_16x16x32_bf16 v[60:63], a[40:43], v[116:119], v[60:63]
buffer_load_dwordx2 v[76:77], v1, s[36:39], 0 offen sc1
v_mfma_f32_16x16x32_bf16 v[60:63], a[44:47], v[128:131], v[60:63]
v_exp_f32 v254, v254
v_mfma_f32_16x16x32_bf16 v[60:63], a[48:51], v[140:143], v[60:63]
v_add_f32 v64, v64, v40
v_add_f32 v65, v65, v40
v_mfma_f32_16x16x32_bf16 v[60:63], a[52:55], v[152:155], v[60:63]
v_add_f32 v66, v66, v40
v_add_f32 v67, v67, v40
v_mfma_f32_16x16x32_bf16 v[60:63], a[56:59], v[164:167], v[60:63]
v_exp_f32 v64, v64
v_exp_f32 v65, v65
v_exp_f32 v66, v66
v_exp_f32 v67, v67
v_mfma_f32_16x16x32_bf16 v[60:63], a[60:63], v[176:179], v[60:63]
v_cvt_pk_bf16_f32 v194, v64, v65
v_cvt_pk_bf16_f32 v195, v66, v67
v_mfma_f32_16x16x32_bf16 v[64:67], a[32:35], v[96:99], v[40:43]
ds_read_b128 a[32:35], v20 offset:24576
v_add_f32 v232, v232, v32
v_mfma_f32_16x16x32_bf16 v[64:67], a[36:39], v[108:111], v[64:67]
buffer_load_dwordx4 v7, s[12:15], s63 offen nt lds
v_mfma_f32_16x16x32_bf16 v[64:67], a[40:43], v[120:123], v[64:67]
s_add_u32 m0, s61, 139264
v_exp_f32 v232, v232
v_mfma_f32_16x16x32_bf16 v[64:67], a[44:47], v[132:135], v[64:67]
s_mov_b32 s63, 176128
ds_read_b128 a[36:39], v21 offset:24576
v_add_f32 v233, v233, v32
v_mfma_f32_16x16x32_bf16 v[64:67], a[48:51], v[144:147], v[64:67]
ds_read_b128 a[40:43], v22 offset:24576
v_add_f32 v234, v234, v32
v_mfma_f32_16x16x32_bf16 v[64:67], a[52:55], v[156:159], v[64:67]
ds_read_b128 a[44:47], v23 offset:24576
v_add_f32 v235, v235, v32
v_mfma_f32_16x16x32_bf16 v[64:67], a[56:59], v[168:171], v[64:67]
v_exp_f32 v233, v233
v_exp_f32 v234, v234
v_exp_f32 v235, v235
v_mfma_f32_16x16x32_bf16 v[64:67], a[60:63], v[180:183], v[64:67]
v_cvt_pk_bf16_f32 v196, v232, v233
v_cvt_pk_bf16_f32 v197, v234, v235
v_mfma_f32_16x16x32_bf16 v[232:235], a[0:3], v[88:91], v[32:35]
s_waitcnt lgkmcnt(3)
ds_read_b128 a[48:51], v20 offset:24832
v_add_f32 v236, v236, v36
v_mfma_f32_16x16x32_bf16 v[232:235], a[4:7], v[100:103], v[232:235]
v_exp_f32 v236, v236
v_mfma_f32_16x16x32_bf16 v[232:235], a[8:11], v[112:115], v[232:235]
ds_read_b128 a[52:55], v21 offset:24832
v_add_f32 v237, v237, v36
v_mfma_f32_16x16x32_bf16 v[232:235], a[12:15], v[124:127], v[232:235]
v_exp_f32 v237, v237
v_mfma_f32_16x16x32_bf16 v[232:235], a[16:19], v[136:139], v[232:235]
ds_read_b128 a[56:59], v22 offset:24832
v_add_f32 v238, v238, v36
v_mfma_f32_16x16x32_bf16 v[232:235], a[20:23], v[148:151], v[232:235]
ds_read_b128 a[60:63], v23 offset:24832
v_add_f32 v239, v239, v36
v_mfma_f32_16x16x32_bf16 v[232:235], a[24:27], v[160:163], v[232:235]
v_exp_f32 v238, v238
v_exp_f32 v239, v239
v_mfma_f32_16x16x32_bf16 v[232:235], a[28:31], v[172:175], v[232:235]
v_cvt_pk_bf16_f32 v200, v236, v237
v_cvt_pk_bf16_f32 v201, v238, v239
v_mfma_f32_16x16x32_bf16 v[236:239], a[0:3], v[92:95], v[36:39]
buffer_load_dwordx4 v6, s[12:15], s62 offen nt lds
v_mfma_f32_16x16x32_bf16 v[236:239], a[4:7], v[104:107], v[236:239]
s_add_u32 m0, s61, 143360
v_add_u32 v20, 0xfffe8000, v20
v_add_u32 v21, 0xfffe8000, v21
v_mfma_f32_16x16x32_bf16 v[236:239], a[8:11], v[116:119], v[236:239]
s_mov_b32 s62, 180224
v_add_u32 v22, 0xfffe8000, v22
v_add_u32 v23, 0xfffe8000, v23
v_mfma_f32_16x16x32_bf16 v[236:239], a[12:15], v[128:131], v[236:239]
s_waitcnt vmcnt(20) lgkmcnt(0)
s_barrier
v_add_f32 v240, v240, v40
v_mfma_f32_16x16x32_bf16 v[236:239], a[16:19], v[140:143], v[236:239]
v_add_f32 v241, v241, v40
v_add_f32 v242, v242, v40
v_mfma_f32_16x16x32_bf16 v[236:239], a[20:23], v[152:155], v[236:239]
v_add_f32 v243, v243, v40
v_cvt_pk_bf16_f32 v198, v244, v245
v_mfma_f32_16x16x32_bf16 v[236:239], a[24:27], v[164:167], v[236:239]
v_exp_f32 v240, v240
v_exp_f32 v241, v241
v_exp_f32 v242, v242
v_exp_f32 v243, v243
v_mfma_f32_16x16x32_bf16 v[236:239], a[28:31], v[176:179], v[236:239]
v_cvt_pk_bf16_f32 v204, v240, v241
v_cvt_pk_bf16_f32 v205, v242, v243
v_mfma_f32_16x16x32_bf16 v[240:243], a[0:3], v[96:99], v[40:43]
ds_read_b128 a[0:3], v20 offset:0
v_cvt_pk_bf16_f32 v199, v246, v247
v_mfma_f32_16x16x32_bf16 v[240:243], a[4:7], v[108:111], v[240:243]
v_exp_f32 v255, v255
v_mfma_f32_16x16x32_bf16 v[240:243], a[8:11], v[120:123], v[240:243]
ds_read_b128 a[4:7], v21 offset:0
v_cvt_pk_bf16_f32 v202, v248, v249
v_mfma_f32_16x16x32_bf16 v[240:243], a[12:15], v[132:135], v[240:243]
ds_read_b128 a[8:11], v22 offset:0
v_cvt_pk_bf16_f32 v203, v250, v251
v_mfma_f32_16x16x32_bf16 v[240:243], a[16:19], v[144:147], v[240:243]
ds_read_b128 a[12:15], v23 offset:0
v_cvt_pk_bf16_f32 v206, v252, v253
v_mfma_f32_16x16x32_bf16 v[240:243], a[20:23], v[156:159], v[240:243]
ds_read_b128 a[16:19], v20 offset:256
v_cvt_pk_bf16_f32 v207, v254, v255
v_mfma_f32_16x16x32_bf16 v[240:243], a[24:27], v[168:171], v[240:243]
buffer_load_dwordx4 v7, s[12:15], s63 offen nt lds
v_mfma_f32_16x16x32_bf16 v[240:243], a[28:31], v[180:183], v[240:243]
ds_read_b128 a[20:23], v21 offset:256
v_mfma_f32_16x16x32_bf16 v[244:247], a[32:35], v[88:91], v[32:35]
ds_read_b128 a[24:27], v22 offset:256
v_mfma_f32_16x16x32_bf16 v[244:247], a[36:39], v[100:103], v[244:247]
ds_read_b128 a[28:31], v23 offset:256
v_mfma_f32_16x16x32_bf16 v[244:247], a[40:43], v[112:115], v[244:247]
v_exp_f32 v44, v44
v_mfma_f32_16x16x32_bf16 v[244:247], a[44:47], v[124:127], v[244:247]
v_exp_f32 v45, v45
v_mfma_f32_16x16x32_bf16 v[244:247], a[48:51], v[136:139], v[244:247]
v_exp_f32 v46, v46
v_mfma_f32_16x16x32_bf16 v[244:247], a[52:55], v[148:151], v[244:247]
v_exp_f32 v47, v47
v_mfma_f32_16x16x32_bf16 v[244:247], a[56:59], v[160:163], v[244:247]
v_exp_f32 v48, v48
v_mfma_f32_16x16x32_bf16 v[244:247], a[60:63], v[172:175], v[244:247]
s_add_u32 m0, s61, 147456
v_exp_f32 v49, v49
v_mfma_f32_16x16x32_bf16 v[248:251], a[32:35], v[92:95], v[36:39]
s_mov_b32 s63, 184320
v_exp_f32 v50, v50
v_mfma_f32_16x16x32_bf16 v[248:251], a[36:39], v[104:107], v[248:251]
v_exp_f32 v51, v51
v_mfma_f32_16x16x32_bf16 v[248:251], a[40:43], v[116:119], v[248:251]
v_exp_f32 v52, v52
v_mfma_f32_16x16x32_bf16 v[248:251], a[44:47], v[128:131], v[248:251]
v_exp_f32 v53, v53
v_mfma_f32_16x16x32_bf16 v[248:251], a[48:51], v[140:143], v[248:251]
buffer_load_dwordx4 v6, s[12:15], s62 offen nt lds
v_mfma_f32_16x16x32_bf16 v[248:251], a[52:55], v[152:155], v[248:251]
s_add_u32 m0, s61, 151552
v_exp_f32 v54, v54
v_mfma_f32_16x16x32_bf16 v[248:251], a[56:59], v[164:167], v[248:251]
s_mov_b32 s62, 188416
v_exp_f32 v55, v55
v_mfma_f32_16x16x32_bf16 v[248:251], a[60:63], v[176:179], v[248:251]
v_exp_f32 v56, v56
v_mfma_f32_16x16x32_bf16 v[252:255], a[32:35], v[96:99], v[40:43]
ds_read_b128 a[32:35], v20 offset:8192
v_cvt_pk_bf16_f32 v68, v44, v45
v_mfma_f32_16x16x32_bf16 v[252:255], a[36:39], v[108:111], v[252:255]
ds_read_b128 a[36:39], v21 offset:8192
v_cvt_pk_bf16_f32 v69, v46, v47
v_mfma_f32_16x16x32_bf16 v[252:255], a[40:43], v[120:123], v[252:255]
ds_read_b128 a[40:43], v22 offset:8192
v_accvgpr_write_b32 a64, v68
v_mfma_f32_16x16x32_bf16 v[252:255], a[44:47], v[132:135], v[252:255]
ds_read_b128 a[44:47], v23 offset:8192
v_accvgpr_write_b32 a65, v69
v_mfma_f32_16x16x32_bf16 v[252:255], a[48:51], v[144:147], v[252:255]
ds_read_b128 a[48:51], v20 offset:8448
v_cvt_pk_bf16_f32 v70, v48, v49
v_mfma_f32_16x16x32_bf16 v[252:255], a[52:55], v[156:159], v[252:255]
ds_read_b128 a[52:55], v21 offset:8448
v_cvt_pk_bf16_f32 v71, v50, v51
v_mfma_f32_16x16x32_bf16 v[252:255], a[56:59], v[168:171], v[252:255]
ds_read_b128 a[56:59], v22 offset:8448
v_accvgpr_write_b32 a68, v70
v_mfma_f32_16x16x32_bf16 v[252:255], a[60:63], v[180:183], v[252:255]
s_waitcnt lgkmcnt(6)
ds_read_b128 a[60:63], v23 offset:8448
v_accvgpr_write_b32 a69, v71
v_mfma_f32_16x16x32_bf16 v[44:47], a[0:3], v[88:91], v[32:35]
v_exp_f32 v57, v57
v_mfma_f32_16x16x32_bf16 v[44:47], a[4:7], v[100:103], v[44:47]
v_exp_f32 v58, v58
v_mfma_f32_16x16x32_bf16 v[44:47], a[8:11], v[112:115], v[44:47]
buffer_load_dwordx4 v7, s[12:15], s63 offen nt lds
v_mfma_f32_16x16x32_bf16 v[44:47], a[12:15], v[124:127], v[44:47]
v_exp_f32 v59, v59
v_mfma_f32_16x16x32_bf16 v[44:47], a[16:19], v[136:139], v[44:47]
v_exp_f32 v60, v60
v_mfma_f32_16x16x32_bf16 v[44:47], a[20:23], v[148:151], v[44:47]
v_exp_f32 v61, v61
v_mfma_f32_16x16x32_bf16 v[44:47], a[24:27], v[160:163], v[44:47]
v_exp_f32 v62, v62
v_mfma_f32_16x16x32_bf16 v[44:47], a[28:31], v[172:175], v[44:47]
s_add_u32 m0, s61, 155648
v_exp_f32 v63, v63
v_mfma_f32_16x16x32_bf16 v[48:51], a[0:3], v[92:95], v[36:39]
s_mov_b32 s63, 192512
v_exp_f32 v64, v64
v_mfma_f32_16x16x32_bf16 v[48:51], a[4:7], v[104:107], v[48:51]
v_exp_f32 v65, v65
v_mfma_f32_16x16x32_bf16 v[48:51], a[8:11], v[116:119], v[48:51]
v_exp_f32 v66, v66
v_mfma_f32_16x16x32_bf16 v[48:51], a[12:15], v[128:131], v[48:51]
v_exp_f32 v67, v67
v_mfma_f32_16x16x32_bf16 v[48:51], a[16:19], v[140:143], v[48:51]
v_exp_f32 v232, v232
v_mfma_f32_16x16x32_bf16 v[48:51], a[20:23], v[152:155], v[48:51]
v_exp_f32 v233, v233
v_mfma_f32_16x16x32_bf16 v[48:51], a[24:27], v[164:167], v[48:51]
v_cvt_pk_bf16_f32 v68, v52, v53
v_cvt_pk_bf16_f32 v69, v54, v55
v_mfma_f32_16x16x32_bf16 v[48:51], a[28:31], v[176:179], v[48:51]
v_exp_f32 v234, v234
v_mfma_f32_16x16x32_bf16 v[52:55], a[0:3], v[96:99], v[40:43]
buffer_load_dwordx4 v6, s[12:15], s62 offen nt lds
v_mfma_f32_16x16x32_bf16 v[52:55], a[4:7], v[108:111], v[52:55]
s_add_u32 m0, s61, 159744
ds_read_b128 a[0:3], v20 offset:16384
v_accvgpr_write_b32 a72, v68
v_mfma_f32_16x16x32_bf16 v[52:55], a[8:11], v[120:123], v[52:55]
s_mov_b32 s62, 196608
ds_read_b128 a[4:7], v21 offset:16384
v_accvgpr_write_b32 a73, v69
v_mfma_f32_16x16x32_bf16 v[52:55], a[12:15], v[132:135], v[52:55]
ds_read_b128 a[8:11], v22 offset:16384
v_cvt_pk_bf16_f32 v70, v56, v57
v_mfma_f32_16x16x32_bf16 v[52:55], a[16:19], v[144:147], v[52:55]
ds_read_b128 a[12:15], v23 offset:16384
v_cvt_pk_bf16_f32 v71, v58, v59
v_mfma_f32_16x16x32_bf16 v[52:55], a[20:23], v[156:159], v[52:55]
ds_read_b128 a[16:19], v20 offset:16640
v_accvgpr_write_b32 a66, v70
v_mfma_f32_16x16x32_bf16 v[52:55], a[24:27], v[168:171], v[52:55]
ds_read_b128 a[20:23], v21 offset:16640
v_accvgpr_write_b32 a67, v71
v_mfma_f32_16x16x32_bf16 v[52:55], a[28:31], v[180:183], v[52:55]
ds_read_b128 a[24:27], v22 offset:16640
v_cvt_pk_bf16_f32 v68, v60, v61
v_mfma_f32_16x16x32_bf16 v[56:59], a[32:35], v[88:91], v[32:35]
s_waitcnt lgkmcnt(6)
ds_read_b128 a[28:31], v23 offset:16640
v_cvt_pk_bf16_f32 v69, v62, v63
v_mfma_f32_16x16x32_bf16 v[56:59], a[36:39], v[100:103], v[56:59]
v_exp_f32 v235, v235
v_mfma_f32_16x16x32_bf16 v[56:59], a[40:43], v[112:115], v[56:59]
v_exp_f32 v236, v236
v_mfma_f32_16x16x32_bf16 v[56:59], a[44:47], v[124:127], v[56:59]
v_exp_f32 v237, v237
v_mfma_f32_16x16x32_bf16 v[56:59], a[48:51], v[136:139], v[56:59]
v_exp_f32 v238, v238
v_mfma_f32_16x16x32_bf16 v[56:59], a[52:55], v[148:151], v[56:59]
v_exp_f32 v239, v239
v_mfma_f32_16x16x32_bf16 v[56:59], a[56:59], v[160:163], v[56:59]
v_exp_f32 v240, v240
v_mfma_f32_16x16x32_bf16 v[56:59], a[60:63], v[172:175], v[56:59]
buffer_load_dwordx4 v7, s[12:15], s63 offen nt lds
v_mfma_f32_16x16x32_bf16 v[60:63], a[32:35], v[92:95], v[36:39]
s_add_u32 m0, s61, 98304
v_accvgpr_write_b32 a70, v68
v_accvgpr_write_b32 a71, v69
v_mfma_f32_16x16x32_bf16 v[60:63], a[36:39], v[104:107], v[60:63]
s_mov_b32 s63, 200704
v_exp_f32 v241, v241
v_mfma_f32_16x16x32_bf16 v[60:63], a[40:43], v[116:119], v[60:63]
v_exp_f32 v242, v242
v_mfma_f32_16x16x32_bf16 v[60:63], a[44:47], v[128:131], v[60:63]
v_exp_f32 v243, v243
v_mfma_f32_16x16x32_bf16 v[60:63], a[48:51], v[140:143], v[60:63]
v_exp_f32 v244, v244
v_mfma_f32_16x16x32_bf16 v[60:63], a[52:55], v[152:155], v[60:63]
v_exp_f32 v245, v245
v_mfma_f32_16x16x32_bf16 v[60:63], a[56:59], v[164:167], v[60:63]
v_cvt_pk_bf16_f32 v70, v64, v65
v_cvt_pk_bf16_f32 v71, v66, v67
v_mfma_f32_16x16x32_bf16 v[60:63], a[60:63], v[176:179], v[60:63]
v_exp_f32 v246, v246
v_mfma_f32_16x16x32_bf16 v[64:67], a[32:35], v[96:99], v[40:43]
ds_read_b128 a[32:35], v20 offset:24576
v_accvgpr_write_b32 a74, v70
v_mfma_f32_16x16x32_bf16 v[64:67], a[36:39], v[108:111], v[64:67]
ds_read_b128 a[36:39], v21 offset:24576
v_accvgpr_write_b32 a75, v71
v_mfma_f32_16x16x32_bf16 v[64:67], a[40:43], v[120:123], v[64:67]
ds_read_b128 a[40:43], v22 offset:24576
v_cvt_pk_bf16_f32 v68, v232, v233
v_mfma_f32_16x16x32_bf16 v[64:67], a[44:47], v[132:135], v[64:67]
ds_read_b128 a[44:47], v23 offset:24576
v_cvt_pk_bf16_f32 v69, v234, v235
v_mfma_f32_16x16x32_bf16 v[64:67], a[48:51], v[144:147], v[64:67]
ds_read_b128 a[48:51], v20 offset:24832
v_accvgpr_write_b32 a76, v68
v_mfma_f32_16x16x32_bf16 v[64:67], a[52:55], v[156:159], v[64:67]
buffer_load_dwordx4 v6, s[12:15], s62 offen nt lds
v_mfma_f32_16x16x32_bf16 v[64:67], a[56:59], v[168:171], v[64:67]
s_add_u32 m0, s61, 102400
ds_read_b128 a[52:55], v21 offset:24832
v_accvgpr_write_b32 a77, v69
v_mfma_f32_16x16x32_bf16 v[64:67], a[60:63], v[180:183], v[64:67]
ds_read_b128 a[56:59], v22 offset:24832
v_cvt_pk_bf16_f32 v70, v236, v237
v_mfma_f32_16x16x32_bf16 v[232:235], a[0:3], v[88:91], v[32:35]
s_waitcnt lgkmcnt(5)
ds_read_b128 a[60:63], v23 offset:24832
v_cvt_pk_bf16_f32 v71, v238, v239
v_mfma_f32_16x16x32_bf16 v[232:235], a[4:7], v[100:103], v[232:235]
v_exp_f32 v247, v247
v_mfma_f32_16x16x32_bf16 v[232:235], a[8:11], v[112:115], v[232:235]
v_exp_f32 v248, v248
v_mfma_f32_16x16x32_bf16 v[232:235], a[12:15], v[124:127], v[232:235]
v_exp_f32 v249, v249
v_mfma_f32_16x16x32_bf16 v[232:235], a[16:19], v[136:139], v[232:235]
v_exp_f32 v250, v250
v_mfma_f32_16x16x32_bf16 v[232:235], a[20:23], v[148:151], v[232:235]
v_exp_f32 v251, v251
v_mfma_f32_16x16x32_bf16 v[232:235], a[24:27], v[160:163], v[232:235]
s_waitcnt vmcnt(18) lgkmcnt(0)
s_barrier
v_mfma_f32_16x16x32_bf16 v[232:235], a[28:31], v[172:175], v[232:235]
s_mov_b32 s62, 204800
v_add_u32 v20, 0x10000, v20
v_add_u32 v21, 0x10000, v21
v_mfma_f32_16x16x32_bf16 v[236:239], a[0:3], v[92:95], v[36:39]
v_add_u32 v22, 0x10000, v22
v_add_u32 v23, 0x10000, v23
v_mfma_f32_16x16x32_bf16 v[236:239], a[4:7], v[104:107], v[236:239]
v_accvgpr_write_b32 a80, v70
v_accvgpr_write_b32 a81, v71
v_mfma_f32_16x16x32_bf16 v[236:239], a[8:11], v[116:119], v[236:239]
v_exp_f32 v252, v252
v_mfma_f32_16x16x32_bf16 v[236:239], a[12:15], v[128:131], v[236:239]
buffer_load_dwordx4 v7, s[12:15], s63 offen nt lds
v_mfma_f32_16x16x32_bf16 v[236:239], a[16:19], v[140:143], v[236:239]
s_add_u32 m0, s61, 106496
v_exp_f32 v253, v253
v_mfma_f32_16x16x32_bf16 v[236:239], a[20:23], v[152:155], v[236:239]
s_mov_b32 s63, 208896
v_exp_f32 v254, v254
v_mfma_f32_16x16x32_bf16 v[236:239], a[24:27], v[164:167], v[236:239]
v_cvt_pk_bf16_f32 v68, v240, v241
v_cvt_pk_bf16_f32 v69, v242, v243
v_mfma_f32_16x16x32_bf16 v[236:239], a[28:31], v[176:179], v[236:239]
v_exp_f32 v255, v255
v_mfma_f32_16x16x32_bf16 v[240:243], a[0:3], v[96:99], v[40:43]
ds_read_b128 a[0:3], v20 offset:0
v_accvgpr_write_b32 a84, v68
v_mfma_f32_16x16x32_bf16 v[240:243], a[4:7], v[108:111], v[240:243]
ds_read_b128 a[4:7], v21 offset:0
v_accvgpr_write_b32 a85, v69
v_mfma_f32_16x16x32_bf16 v[240:243], a[8:11], v[120:123], v[240:243]
ds_read_b128 a[8:11], v22 offset:0
v_cvt_pk_bf16_f32 v70, v244, v245
v_mfma_f32_16x16x32_bf16 v[240:243], a[12:15], v[132:135], v[240:243]
ds_read_b128 a[12:15], v23 offset:0
v_cvt_pk_bf16_f32 v71, v246, v247
v_mfma_f32_16x16x32_bf16 v[240:243], a[16:19], v[144:147], v[240:243]
ds_read_b128 a[16:19], v20 offset:256
v_accvgpr_write_b32 a78, v70
v_mfma_f32_16x16x32_bf16 v[240:243], a[20:23], v[156:159], v[240:243]
ds_read_b128 a[20:23], v21 offset:256
v_accvgpr_write_b32 a79, v71
v_mfma_f32_16x16x32_bf16 v[240:243], a[24:27], v[168:171], v[240:243]
ds_read_b128 a[24:27], v22 offset:256
v_cvt_pk_bf16_f32 v68, v248, v249
v_mfma_f32_16x16x32_bf16 v[240:243], a[28:31], v[180:183], v[240:243]
ds_read_b128 a[28:31], v23 offset:256
v_cvt_pk_bf16_f32 v69, v250, v251
v_mfma_f32_16x16x32_bf16 v[244:247], a[32:35], v[88:91], v[32:35]
v_exp_f32 v44, v44
v_mfma_f32_16x16x32_bf16 v[244:247], a[36:39], v[100:103], v[244:247]
buffer_load_dwordx4 v6, s[12:15], s62 offen nt lds
v_mfma_f32_16x16x32_bf16 v[244:247], a[40:43], v[112:115], v[244:247]
v_exp_f32 v45, v45
v_mfma_f32_16x16x32_bf16 v[244:247], a[44:47], v[124:127], v[244:247]
v_exp_f32 v46, v46
v_mfma_f32_16x16x32_bf16 v[244:247], a[48:51], v[136:139], v[244:247]
v_exp_f32 v47, v47
v_mfma_f32_16x16x32_bf16 v[244:247], a[52:55], v[148:151], v[244:247]
v_exp_f32 v48, v48
v_mfma_f32_16x16x32_bf16 v[244:247], a[56:59], v[160:163], v[244:247]
v_exp_f32 v49, v49
v_mfma_f32_16x16x32_bf16 v[244:247], a[60:63], v[172:175], v[244:247]
s_add_u32 m0, s61, 110592
v_exp_f32 v50, v50
v_mfma_f32_16x16x32_bf16 v[248:251], a[32:35], v[92:95], v[36:39]
s_mov_b32 s62, 212992
v_accvgpr_write_b32 a82, v68
v_accvgpr_write_b32 a83, v69
v_mfma_f32_16x16x32_bf16 v[248:251], a[36:39], v[104:107], v[248:251]
v_exp_f32 v51, v51
v_mfma_f32_16x16x32_bf16 v[248:251], a[40:43], v[116:119], v[248:251]
v_exp_f32 v52, v52
v_mfma_f32_16x16x32_bf16 v[248:251], a[44:47], v[128:131], v[248:251]
v_exp_f32 v53, v53
v_mfma_f32_16x16x32_bf16 v[248:251], a[48:51], v[140:143], v[248:251]
v_exp_f32 v54, v54
v_mfma_f32_16x16x32_bf16 v[248:251], a[52:55], v[152:155], v[248:251]
v_exp_f32 v55, v55
v_mfma_f32_16x16x32_bf16 v[248:251], a[56:59], v[164:167], v[248:251]
v_cvt_pk_bf16_f32 v70, v252, v253
v_cvt_pk_bf16_f32 v71, v254, v255
v_mfma_f32_16x16x32_bf16 v[248:251], a[60:63], v[176:179], v[248:251]
v_exp_f32 v56, v56
v_mfma_f32_16x16x32_bf16 v[252:255], a[32:35], v[96:99], v[40:43]
buffer_load_dwordx4 v7, s[12:15], s63 offen nt lds
v_mfma_f32_16x16x32_bf16 v[252:255], a[36:39], v[108:111], v[252:255]
s_add_u32 m0, s61, 114688
ds_read_b128 a[32:35], v20 offset:8192
v_accvgpr_write_b32 a86, v70
v_mfma_f32_16x16x32_bf16 v[252:255], a[40:43], v[120:123], v[252:255]
s_mov_b32 s63, 217088
ds_read_b128 a[36:39], v21 offset:8192
v_accvgpr_write_b32 a87, v71
v_mfma_f32_16x16x32_bf16 v[252:255], a[44:47], v[132:135], v[252:255]
ds_read_b128 a[40:43], v22 offset:8192
v_cvt_pk_bf16_f32 v68, v44, v45
v_mfma_f32_16x16x32_bf16 v[252:255], a[48:51], v[144:147], v[252:255]
ds_read_b128 a[44:47], v23 offset:8192
v_cvt_pk_bf16_f32 v69, v46, v47
v_mfma_f32_16x16x32_bf16 v[252:255], a[52:55], v[156:159], v[252:255]
ds_read_b128 a[48:51], v20 offset:8448
v_accvgpr_write_b32 a88, v68
v_mfma_f32_16x16x32_bf16 v[252:255], a[56:59], v[168:171], v[252:255]
ds_read_b128 a[52:55], v21 offset:8448
v_accvgpr_write_b32 a89, v69
v_mfma_f32_16x16x32_bf16 v[252:255], a[60:63], v[180:183], v[252:255]
s_waitcnt lgkmcnt(6)
ds_read_b128 a[56:59], v22 offset:8448
v_cvt_pk_bf16_f32 v70, v48, v49
v_mfma_f32_16x16x32_bf16 v[44:47], a[0:3], v[88:91], v[32:35]
ds_read_b128 a[60:63], v23 offset:8448
v_cvt_pk_bf16_f32 v71, v50, v51
v_mfma_f32_16x16x32_bf16 v[44:47], a[4:7], v[100:103], v[44:47]
v_exp_f32 v57, v57
v_mfma_f32_16x16x32_bf16 v[44:47], a[8:11], v[112:115], v[44:47]
v_exp_f32 v58, v58
v_mfma_f32_16x16x32_bf16 v[44:47], a[12:15], v[124:127], v[44:47]
v_exp_f32 v59, v59
v_mfma_f32_16x16x32_bf16 v[44:47], a[16:19], v[136:139], v[44:47]
v_exp_f32 v60, v60
v_mfma_f32_16x16x32_bf16 v[44:47], a[20:23], v[148:151], v[44:47]
v_exp_f32 v61, v61
v_mfma_f32_16x16x32_bf16 v[44:47], a[24:27], v[160:163], v[44:47]
buffer_load_dwordx4 v6, s[12:15], s62 offen nt lds
v_mfma_f32_16x16x32_bf16 v[44:47], a[28:31], v[172:175], v[44:47]
s_add_u32 m0, s61, 118784
v_exp_f32 v62, v62
v_mfma_f32_16x16x32_bf16 v[48:51], a[0:3], v[92:95], v[36:39]
s_mov_b32 s62, 221184
v_accvgpr_write_b32 a92, v70
v_accvgpr_write_b32 a93, v71
v_mfma_f32_16x16x32_bf16 v[48:51], a[4:7], v[104:107], v[48:51]
v_exp_f32 v63, v63
v_mfma_f32_16x16x32_bf16 v[48:51], a[8:11], v[116:119], v[48:51]
v_exp_f32 v64, v64
v_mfma_f32_16x16x32_bf16 v[48:51], a[12:15], v[128:131], v[48:51]
v_exp_f32 v65, v65
v_mfma_f32_16x16x32_bf16 v[48:51], a[16:19], v[140:143], v[48:51]
v_exp_f32 v66, v66
v_mfma_f32_16x16x32_bf16 v[48:51], a[20:23], v[152:155], v[48:51]
v_exp_f32 v67, v67
v_mfma_f32_16x16x32_bf16 v[48:51], a[24:27], v[164:167], v[48:51]
v_cvt_pk_bf16_f32 v68, v52, v53
v_cvt_pk_bf16_f32 v69, v54, v55
v_mfma_f32_16x16x32_bf16 v[48:51], a[28:31], v[176:179], v[48:51]
v_exp_f32 v232, v232
v_mfma_f32_16x16x32_bf16 v[52:55], a[0:3], v[96:99], v[40:43]
ds_read_b128 a[0:3], v20 offset:16384
v_accvgpr_write_b32 a96, v68
v_mfma_f32_16x16x32_bf16 v[52:55], a[4:7], v[108:111], v[52:55]
ds_read_b128 a[4:7], v21 offset:16384
v_accvgpr_write_b32 a97, v69
v_mfma_f32_16x16x32_bf16 v[52:55], a[8:11], v[120:123], v[52:55]
ds_read_b128 a[8:11], v22 offset:16384
v_cvt_pk_bf16_f32 v70, v56, v57
v_mfma_f32_16x16x32_bf16 v[52:55], a[12:15], v[132:135], v[52:55]
ds_read_b128 a[12:15], v23 offset:16384
v_cvt_pk_bf16_f32 v71, v58, v59
v_mfma_f32_16x16x32_bf16 v[52:55], a[16:19], v[144:147], v[52:55]
buffer_load_dwordx4 v7, s[12:15], s63 offen nt lds
v_mfma_f32_16x16x32_bf16 v[52:55], a[20:23], v[156:159], v[52:55]
s_add_u32 m0, s61, 122880
ds_read_b128 a[16:19], v20 offset:16640
v_accvgpr_write_b32 a90, v70
v_mfma_f32_16x16x32_bf16 v[52:55], a[24:27], v[168:171], v[52:55]
s_mov_b32 s63, 225280
ds_read_b128 a[20:23], v21 offset:16640
v_accvgpr_write_b32 a91, v71
v_mfma_f32_16x16x32_bf16 v[52:55], a[28:31], v[180:183], v[52:55]
s_waitcnt lgkmcnt(5)
ds_read_b128 a[24:27], v22 offset:16640
v_cvt_pk_bf16_f32 v68, v60, v61
v_mfma_f32_16x16x32_bf16 v[56:59], a[32:35], v[88:91], v[32:35]
ds_read_b128 a[28:31], v23 offset:16640
v_cvt_pk_bf16_f32 v69, v62, v63
v_mfma_f32_16x16x32_bf16 v[56:59], a[36:39], v[100:103], v[56:59]
v_exp_f32 v233, v233
v_mfma_f32_16x16x32_bf16 v[56:59], a[40:43], v[112:115], v[56:59]
v_exp_f32 v234, v234
v_mfma_f32_16x16x32_bf16 v[56:59], a[44:47], v[124:127], v[56:59]
v_exp_f32 v235, v235
v_mfma_f32_16x16x32_bf16 v[56:59], a[48:51], v[136:139], v[56:59]
v_exp_f32 v236, v236
v_mfma_f32_16x16x32_bf16 v[56:59], a[52:55], v[148:151], v[56:59]
v_exp_f32 v237, v237
v_mfma_f32_16x16x32_bf16 v[56:59], a[56:59], v[160:163], v[56:59]
v_exp_f32 v238, v238
v_mfma_f32_16x16x32_bf16 v[56:59], a[60:63], v[172:175], v[56:59]
v_exp_f32 v239, v239
v_mfma_f32_16x16x32_bf16 v[60:63], a[32:35], v[92:95], v[36:39]
v_accvgpr_write_b32 a94, v68
v_accvgpr_write_b32 a95, v69
v_mfma_f32_16x16x32_bf16 v[60:63], a[36:39], v[104:107], v[60:63]
v_exp_f32 v240, v240
v_mfma_f32_16x16x32_bf16 v[60:63], a[40:43], v[116:119], v[60:63]
buffer_load_dwordx4 v6, s[12:15], s62 offen nt lds
v_mfma_f32_16x16x32_bf16 v[60:63], a[44:47], v[128:131], v[60:63]
s_add_u32 m0, s61, 126976
v_exp_f32 v241, v241
v_mfma_f32_16x16x32_bf16 v[60:63], a[48:51], v[140:143], v[60:63]
s_mov_b32 s62, 229376
v_exp_f32 v242, v242
v_mfma_f32_16x16x32_bf16 v[60:63], a[52:55], v[152:155], v[60:63]
v_exp_f32 v243, v243
v_mfma_f32_16x16x32_bf16 v[60:63], a[56:59], v[164:167], v[60:63]
v_cvt_pk_bf16_f32 v70, v64, v65
v_cvt_pk_bf16_f32 v71, v66, v67
v_mfma_f32_16x16x32_bf16 v[60:63], a[60:63], v[176:179], v[60:63]
v_exp_f32 v244, v244
v_mfma_f32_16x16x32_bf16 v[64:67], a[32:35], v[96:99], v[40:43]
ds_read_b128 a[32:35], v20 offset:24576
v_accvgpr_write_b32 a98, v70
v_mfma_f32_16x16x32_bf16 v[64:67], a[36:39], v[108:111], v[64:67]
ds_read_b128 a[36:39], v21 offset:24576
v_accvgpr_write_b32 a99, v71
v_mfma_f32_16x16x32_bf16 v[64:67], a[40:43], v[120:123], v[64:67]
ds_read_b128 a[40:43], v22 offset:24576
v_cvt_pk_bf16_f32 v68, v232, v233
v_mfma_f32_16x16x32_bf16 v[64:67], a[44:47], v[132:135], v[64:67]
ds_read_b128 a[44:47], v23 offset:24576
v_cvt_pk_bf16_f32 v69, v234, v235
v_mfma_f32_16x16x32_bf16 v[64:67], a[48:51], v[144:147], v[64:67]
ds_read_b128 a[48:51], v20 offset:24832
v_accvgpr_write_b32 a100, v68
v_mfma_f32_16x16x32_bf16 v[64:67], a[52:55], v[156:159], v[64:67]
ds_read_b128 a[52:55], v21 offset:24832
v_accvgpr_write_b32 a101, v69
v_mfma_f32_16x16x32_bf16 v[64:67], a[56:59], v[168:171], v[64:67]
ds_read_b128 a[56:59], v22 offset:24832
v_cvt_pk_bf16_f32 v70, v236, v237
v_mfma_f32_16x16x32_bf16 v[64:67], a[60:63], v[180:183], v[64:67]
ds_read_b128 a[60:63], v23 offset:24832
v_cvt_pk_bf16_f32 v71, v238, v239
v_mfma_f32_16x16x32_bf16 v[232:235], a[0:3], v[88:91], v[32:35]
s_waitcnt lgkmcnt(6)
v_exp_f32 v245, v245
v_mfma_f32_16x16x32_bf16 v[232:235], a[4:7], v[100:103], v[232:235]
buffer_load_dwordx4 v7, s[12:15], s63 offen nt lds
v_mfma_f32_16x16x32_bf16 v[232:235], a[8:11], v[112:115], v[232:235]
v_exp_f32 v246, v246
v_mfma_f32_16x16x32_bf16 v[232:235], a[12:15], v[124:127], v[232:235]
v_exp_f32 v247, v247
v_mfma_f32_16x16x32_bf16 v[232:235], a[16:19], v[136:139], v[232:235]
v_exp_f32 v248, v248
v_mfma_f32_16x16x32_bf16 v[232:235], a[20:23], v[148:151], v[232:235]
s_waitcnt vmcnt(17) lgkmcnt(0)
s_barrier
v_mfma_f32_16x16x32_bf16 v[232:235], a[24:27], v[160:163], v[232:235]
v_exp_f32 v249, v249
v_mfma_f32_16x16x32_bf16 v[232:235], a[28:31], v[172:175], v[232:235]
s_add_u32 m0, s61, 0
v_add_u32 v20, 0xffff8000, v20
v_add_u32 v21, 0xffff8000, v21
v_mfma_f32_16x16x32_bf16 v[236:239], a[0:3], v[92:95], v[36:39]
s_mov_b32 s63, 233472
v_add_u32 v22, 0xffff8000, v22
v_add_u32 v23, 0xffff8000, v23
v_mfma_f32_16x16x32_bf16 v[236:239], a[4:7], v[104:107], v[236:239]
v_accvgpr_write_b32 a104, v70
v_accvgpr_write_b32 a105, v71
v_mfma_f32_16x16x32_bf16 v[236:239], a[8:11], v[116:119], v[236:239]
v_exp_f32 v250, v250
v_mfma_f32_16x16x32_bf16 v[236:239], a[12:15], v[128:131], v[236:239]
v_exp_f32 v251, v251
v_mfma_f32_16x16x32_bf16 v[236:239], a[16:19], v[140:143], v[236:239]
v_exp_f32 v252, v252
v_mfma_f32_16x16x32_bf16 v[236:239], a[20:23], v[152:155], v[236:239]
v_exp_f32 v253, v253
v_mfma_f32_16x16x32_bf16 v[236:239], a[24:27], v[164:167], v[236:239]
v_cvt_pk_bf16_f32 v68, v240, v241
v_cvt_pk_bf16_f32 v69, v242, v243
v_mfma_f32_16x16x32_bf16 v[236:239], a[28:31], v[176:179], v[236:239]
buffer_load_dwordx4 v6, s[12:15], s62 offen nt lds
v_mfma_f32_16x16x32_bf16 v[240:243], a[0:3], v[96:99], v[40:43]
s_add_u32 m0, s61, 4096
ds_read_b128 a[0:3], v20 offset:0
v_accvgpr_write_b32 a108, v68
v_mfma_f32_16x16x32_bf16 v[240:243], a[4:7], v[108:111], v[240:243]
s_mov_b32 s62, 237568
ds_read_b128 a[4:7], v21 offset:0
v_accvgpr_write_b32 a109, v69
v_mfma_f32_16x16x32_bf16 v[240:243], a[8:11], v[120:123], v[240:243]
v_exp_f32 v254, v254
v_mfma_f32_16x16x32_bf16 v[240:243], a[12:15], v[132:135], v[240:243]
v_exp_f32 v255, v255
v_mfma_f32_16x16x32_bf16 v[240:243], a[16:19], v[144:147], v[240:243]
ds_read_b128 a[8:11], v22 offset:0
v_cvt_pk_bf16_f32 v70, v244, v245
v_mfma_f32_16x16x32_bf16 v[240:243], a[20:23], v[156:159], v[240:243]
ds_read_b128 a[12:15], v23 offset:0
v_cvt_pk_bf16_f32 v71, v246, v247
v_mfma_f32_16x16x32_bf16 v[240:243], a[24:27], v[168:171], v[240:243]
ds_read_b128 a[16:19], v20 offset:256
v_accvgpr_write_b32 a102, v70
v_mfma_f32_16x16x32_bf16 v[240:243], a[28:31], v[180:183], v[240:243]
ds_read_b128 a[20:23], v21 offset:256
v_accvgpr_write_b32 a103, v71
v_mfma_f32_16x16x32_bf16 v[244:247], a[32:35], v[88:91], v[32:35]
ds_read_b128 a[24:27], v22 offset:256
v_cvt_pk_bf16_f32 v68, v248, v249
v_mfma_f32_16x16x32_bf16 v[244:247], a[36:39], v[100:103], v[244:247]
ds_read_b128 a[28:31], v23 offset:256
v_cvt_pk_bf16_f32 v69, v250, v251
v_mfma_f32_16x16x32_bf16 v[244:247], a[40:43], v[112:115], v[244:247]
v_exp_f32 v44, v44
v_mfma_f32_16x16x32_bf16 v[244:247], a[44:47], v[124:127], v[244:247]
v_exp_f32 v45, v45
v_mfma_f32_16x16x32_bf16 v[244:247], a[48:51], v[136:139], v[244:247]
v_exp_f32 v46, v46
v_mfma_f32_16x16x32_bf16 v[244:247], a[52:55], v[148:151], v[244:247]
buffer_load_dwordx4 v7, s[12:15], s63 offen nt lds
v_mfma_f32_16x16x32_bf16 v[244:247], a[56:59], v[160:163], v[244:247]
v_exp_f32 v47, v47
v_mfma_f32_16x16x32_bf16 v[244:247], a[60:63], v[172:175], v[244:247]
s_add_u32 m0, s61, 8192
v_exp_f32 v48, v48
v_mfma_f32_16x16x32_bf16 v[248:251], a[32:35], v[92:95], v[36:39]
s_mov_b32 s63, 241664
v_accvgpr_write_b32 a106, v68
v_accvgpr_write_b32 a107, v69
v_mfma_f32_16x16x32_bf16 v[248:251], a[36:39], v[104:107], v[248:251]
v_exp_f32 v49, v49
v_mfma_f32_16x16x32_bf16 v[248:251], a[40:43], v[116:119], v[248:251]
v_exp_f32 v50, v50
v_mfma_f32_16x16x32_bf16 v[248:251], a[44:47], v[128:131], v[248:251]
v_exp_f32 v51, v51
v_mfma_f32_16x16x32_bf16 v[248:251], a[48:51], v[140:143], v[248:251]
v_exp_f32 v52, v52
v_mfma_f32_16x16x32_bf16 v[248:251], a[52:55], v[152:155], v[248:251]
v_exp_f32 v53, v53
v_mfma_f32_16x16x32_bf16 v[248:251], a[56:59], v[164:167], v[248:251]
v_cvt_pk_bf16_f32 v70, v252, v253
v_cvt_pk_bf16_f32 v71, v254, v255
v_mfma_f32_16x16x32_bf16 v[248:251], a[60:63], v[176:179], v[248:251]
v_exp_f32 v54, v54
v_mfma_f32_16x16x32_bf16 v[252:255], a[32:35], v[96:99], v[40:43]
ds_read_b128 a[32:35], v20 offset:8192
v_accvgpr_write_b32 a110, v70
v_mfma_f32_16x16x32_bf16 v[252:255], a[36:39], v[108:111], v[252:255]
ds_read_b128 a[36:39], v21 offset:8192
v_accvgpr_write_b32 a111, v71
v_mfma_f32_16x16x32_bf16 v[252:255], a[40:43], v[120:123], v[252:255]
v_exp_f32 v55, v55
v_mfma_f32_16x16x32_bf16 v[252:255], a[44:47], v[132:135], v[252:255]
buffer_load_dwordx4 v6, s[12:15], s62 offen nt lds
v_mfma_f32_16x16x32_bf16 v[252:255], a[48:51], v[144:147], v[252:255]
s_add_u32 m0, s61, 12288
ds_read_b128 a[40:43], v22 offset:8192
v_cvt_pk_bf16_f32 v208, v44, v45
v_mfma_f32_16x16x32_bf16 v[252:255], a[52:55], v[156:159], v[252:255]
s_mov_b32 s62, 245760
ds_read_b128 a[44:47], v23 offset:8192
v_cvt_pk_bf16_f32 v209, v46, v47
v_mfma_f32_16x16x32_bf16 v[252:255], a[56:59], v[168:171], v[252:255]
ds_read_b128 a[48:51], v20 offset:8448
v_cvt_pk_bf16_f32 v212, v48, v49
v_mfma_f32_16x16x32_bf16 v[252:255], a[60:63], v[180:183], v[252:255]
s_waitcnt lgkmcnt(4)
ds_read_b128 a[52:55], v21 offset:8448
v_cvt_pk_bf16_f32 v213, v50, v51
v_mfma_f32_16x16x32_bf16 v[44:47], a[0:3], v[88:91], v[32:35]
ds_read_b128 a[56:59], v22 offset:8448
v_cvt_pk_bf16_f32 v216, v52, v53
v_mfma_f32_16x16x32_bf16 v[44:47], a[4:7], v[100:103], v[44:47]
ds_read_b128 a[60:63], v23 offset:8448
v_cvt_pk_bf16_f32 v217, v54, v55
v_mfma_f32_16x16x32_bf16 v[44:47], a[8:11], v[112:115], v[44:47]
v_exp_f32 v56, v56
v_mfma_f32_16x16x32_bf16 v[44:47], a[12:15], v[124:127], v[44:47]
v_exp_f32 v57, v57
v_mfma_f32_16x16x32_bf16 v[44:47], a[16:19], v[136:139], v[44:47]
v_exp_f32 v58, v58
v_mfma_f32_16x16x32_bf16 v[44:47], a[20:23], v[148:151], v[44:47]
v_exp_f32 v59, v59
v_mfma_f32_16x16x32_bf16 v[44:47], a[24:27], v[160:163], v[44:47]
v_exp_f32 v60, v60
v_mfma_f32_16x16x32_bf16 v[44:47], a[28:31], v[172:175], v[44:47]
v_exp_f32 v61, v61
v_mfma_f32_16x16x32_bf16 v[48:51], a[0:3], v[92:95], v[36:39]
v_exp_f32 v62, v62
v_mfma_f32_16x16x32_bf16 v[48:51], a[4:7], v[104:107], v[48:51]
v_exp_f32 v63, v63
v_mfma_f32_16x16x32_bf16 v[48:51], a[8:11], v[116:119], v[48:51]
buffer_load_dwordx4 v7, s[12:15], s63 offen nt lds
v_mfma_f32_16x16x32_bf16 v[48:51], a[12:15], v[128:131], v[48:51]
s_add_u32 m0, s61, 16384
v_exp_f32 v64, v64
v_mfma_f32_16x16x32_bf16 v[48:51], a[16:19], v[140:143], v[48:51]
s_mov_b32 s63, 249856
v_exp_f32 v65, v65
v_mfma_f32_16x16x32_bf16 v[48:51], a[20:23], v[152:155], v[48:51]
v_exp_f32 v66, v66
v_mfma_f32_16x16x32_bf16 v[48:51], a[24:27], v[164:167], v[48:51]
v_exp_f32 v67, v67
v_mfma_f32_16x16x32_bf16 v[48:51], a[28:31], v[176:179], v[48:51]
v_exp_f32 v232, v232
v_mfma_f32_16x16x32_bf16 v[52:55], a[0:3], v[96:99], v[40:43]
ds_read_b128 a[0:3], v20 offset:16384
v_cvt_pk_bf16_f32 v210, v56, v57
v_mfma_f32_16x16x32_bf16 v[52:55], a[4:7], v[108:111], v[52:55]
ds_read_b128 a[4:7], v21 offset:16384
v_cvt_pk_bf16_f32 v211, v58, v59
v_mfma_f32_16x16x32_bf16 v[52:55], a[8:11], v[120:123], v[52:55]
ds_read_b128 a[8:11], v22 offset:16384
v_cvt_pk_bf16_f32 v214, v60, v61
v_mfma_f32_16x16x32_bf16 v[52:55], a[12:15], v[132:135], v[52:55]
ds_read_b128 a[12:15], v23 offset:16384
v_cvt_pk_bf16_f32 v215, v62, v63
v_mfma_f32_16x16x32_bf16 v[52:55], a[16:19], v[144:147], v[52:55]
ds_read_b128 a[16:19], v20 offset:16640
v_cvt_pk_bf16_f32 v218, v64, v65
v_mfma_f32_16x16x32_bf16 v[52:55], a[20:23], v[156:159], v[52:55]
ds_read_b128 a[20:23], v21 offset:16640
v_cvt_pk_bf16_f32 v219, v66, v67
v_mfma_f32_16x16x32_bf16 v[52:55], a[24:27], v[168:171], v[52:55]
ds_read_b128 a[24:27], v22 offset:16640
v_mfma_f32_16x16x32_bf16 v[52:55], a[28:31], v[180:183], v[52:55]
ds_read_b128 a[28:31], v23 offset:16640
v_mfma_f32_16x16x32_bf16 v[56:59], a[32:35], v[88:91], v[32:35]
s_waitcnt lgkmcnt(6)
buffer_load_dwordx4 v6, s[12:15], s62 offen nt lds
v_mfma_f32_16x16x32_bf16 v[56:59], a[36:39], v[100:103], v[56:59]
v_exp_f32 v233, v233
v_mfma_f32_16x16x32_bf16 v[56:59], a[40:43], v[112:115], v[56:59]
v_exp_f32 v234, v234
v_mfma_f32_16x16x32_bf16 v[56:59], a[44:47], v[124:127], v[56:59]
v_exp_f32 v235, v235
v_mfma_f32_16x16x32_bf16 v[56:59], a[48:51], v[136:139], v[56:59]
v_exp_f32 v236, v236
v_mfma_f32_16x16x32_bf16 v[56:59], a[52:55], v[148:151], v[56:59]
v_exp_f32 v237, v237
v_mfma_f32_16x16x32_bf16 v[56:59], a[56:59], v[160:163], v[56:59]
v_exp_f32 v238, v238
v_mfma_f32_16x16x32_bf16 v[56:59], a[60:63], v[172:175], v[56:59]
s_add_u32 m0, s61, 20480
v_exp_f32 v239, v239
v_mfma_f32_16x16x32_bf16 v[60:63], a[32:35], v[92:95], v[36:39]
s_mov_b32 s62, 253952
v_exp_f32 v240, v240
v_mfma_f32_16x16x32_bf16 v[60:63], a[36:39], v[104:107], v[60:63]
v_exp_f32 v241, v241
v_mfma_f32_16x16x32_bf16 v[60:63], a[40:43], v[116:119], v[60:63]
v_exp_f32 v242, v242
v_mfma_f32_16x16x32_bf16 v[60:63], a[44:47], v[128:131], v[60:63]
v_exp_f32 v243, v243
v_mfma_f32_16x16x32_bf16 v[60:63], a[48:51], v[140:143], v[60:63]
v_exp_f32 v244, v244
v_mfma_f32_16x16x32_bf16 v[60:63], a[52:55], v[152:155], v[60:63]
v_exp_f32 v245, v245
v_mfma_f32_16x16x32_bf16 v[60:63], a[56:59], v[164:167], v[60:63]
buffer_load_dwordx4 v7, s[12:15], s63 offen nt lds
v_mfma_f32_16x16x32_bf16 v[60:63], a[60:63], v[176:179], v[60:63]
s_add_u32 m0, s61, 24576
v_exp_f32 v246, v246
v_mfma_f32_16x16x32_bf16 v[64:67], a[32:35], v[96:99], v[40:43]
s_mov_b32 s63, 258048
ds_read_b128 a[32:35], v20 offset:24576
v_cvt_pk_bf16_f32 v68, v232, v233
v_mfma_f32_16x16x32_bf16 v[64:67], a[36:39], v[108:111], v[64:67]
ds_read_b128 a[36:39], v21 offset:24576
v_cvt_pk_bf16_f32 v69, v234, v235
v_mfma_f32_16x16x32_bf16 v[64:67], a[40:43], v[120:123], v[64:67]
ds_read_b128 a[40:43], v22 offset:24576
v_accvgpr_write_b32 a112, v68
v_mfma_f32_16x16x32_bf16 v[64:67], a[44:47], v[132:135], v[64:67]
ds_read_b128 a[44:47], v23 offset:24576
v_accvgpr_write_b32 a113, v69
v_mfma_f32_16x16x32_bf16 v[64:67], a[48:51], v[144:147], v[64:67]
ds_read_b128 a[48:51], v20 offset:24832
v_cvt_pk_bf16_f32 v70, v236, v237
v_mfma_f32_16x16x32_bf16 v[64:67], a[52:55], v[156:159], v[64:67]
ds_read_b128 a[52:55], v21 offset:24832
v_cvt_pk_bf16_f32 v71, v238, v239
v_mfma_f32_16x16x32_bf16 v[64:67], a[56:59], v[168:171], v[64:67]
ds_read_b128 a[56:59], v22 offset:24832
v_accvgpr_write_b32 a116, v70
v_mfma_f32_16x16x32_bf16 v[64:67], a[60:63], v[180:183], v[64:67]
ds_read_b128 a[60:63], v23 offset:24832
v_add_u32 v20, 0x18000, v20
v_mfma_f32_16x16x32_bf16 v[232:235], a[0:3], v[88:91], v[32:35]
v_exp_f32 v247, v247
v_mfma_f32_16x16x32_bf16 v[232:235], a[4:7], v[100:103], v[232:235]
s_waitcnt lgkmcnt(5)
v_exp_f32 v248, v248
v_mfma_f32_16x16x32_bf16 v[232:235], a[8:11], v[112:115], v[232:235]
v_exp_f32 v249, v249
v_mfma_f32_16x16x32_bf16 v[232:235], a[12:15], v[124:127], v[232:235]
v_exp_f32 v250, v250
v_mfma_f32_16x16x32_bf16 v[232:235], a[16:19], v[136:139], v[232:235]
buffer_load_dwordx4 v6, s[12:15], s62 offen nt lds
v_mfma_f32_16x16x32_bf16 v[232:235], a[20:23], v[148:151], v[232:235]
s_waitcnt vmcnt(15) lgkmcnt(0)
s_barrier
v_mfma_f32_16x16x32_bf16 v[232:235], a[24:27], v[160:163], v[232:235]
v_exp_f32 v251, v251
v_mfma_f32_16x16x32_bf16 v[232:235], a[28:31], v[172:175], v[232:235]
s_add_u32 m0, s61, 28672
v_add_u32 v21, 0x18000, v21
v_add_u32 v22, 0x18000, v22
v_mfma_f32_16x16x32_bf16 v[236:239], a[0:3], v[92:95], v[36:39]
s_mov_b32 s62, 0
v_add_u32 v23, 0x18000, v23
v_accvgpr_write_b32 a117, v71
v_mfma_f32_16x16x32_bf16 v[236:239], a[4:7], v[104:107], v[236:239]
v_exp_f32 v252, v252
v_mfma_f32_16x16x32_bf16 v[236:239], a[8:11], v[116:119], v[236:239]
v_exp_f32 v253, v253
v_mfma_f32_16x16x32_bf16 v[236:239], a[12:15], v[128:131], v[236:239]
v_exp_f32 v254, v254
v_mfma_f32_16x16x32_bf16 v[236:239], a[16:19], v[140:143], v[236:239]
v_exp_f32 v255, v255
v_mfma_f32_16x16x32_bf16 v[236:239], a[20:23], v[152:155], v[236:239]
v_exp_f32 v44, v44
v_mfma_f32_16x16x32_bf16 v[236:239], a[24:27], v[164:167], v[236:239]
v_cvt_pk_bf16_f32 v68, v240, v241
v_cvt_pk_bf16_f32 v69, v242, v243
v_mfma_f32_16x16x32_bf16 v[236:239], a[28:31], v[176:179], v[236:239]
v_exp_f32 v45, v45
v_mfma_f32_16x16x32_bf16 v[240:243], a[0:3], v[96:99], v[40:43]
ds_read_b128 a[0:3], v20 offset:0
v_accvgpr_write_b32 a120, v68
v_mfma_f32_16x16x32_bf16 v[240:243], a[4:7], v[108:111], v[240:243]
ds_read_b128 a[4:7], v21 offset:0
v_accvgpr_write_b32 a121, v69
v_mfma_f32_16x16x32_bf16 v[240:243], a[8:11], v[120:123], v[240:243]
ds_read_b128 a[8:11], v22 offset:0
v_cvt_pk_bf16_f32 v70, v244, v245
v_mfma_f32_16x16x32_bf16 v[240:243], a[12:15], v[132:135], v[240:243]
buffer_load_dwordx4 v7, s[12:15], s63 offen nt lds
v_mfma_f32_16x16x32_bf16 v[240:243], a[16:19], v[144:147], v[240:243]
s_add_u32 m0, s61, 65536
ds_read_b128 a[12:15], v23 offset:0
v_cvt_pk_bf16_f32 v71, v246, v247
v_mfma_f32_16x16x32_bf16 v[240:243], a[20:23], v[156:159], v[240:243]
s_mov_b32 s63, 16384
ds_read_b128 a[16:19], v20 offset:256
v_accvgpr_write_b32 a114, v70
v_mfma_f32_16x16x32_bf16 v[240:243], a[24:27], v[168:171], v[240:243]
ds_read_b128 a[20:23], v21 offset:256
v_accvgpr_write_b32 a115, v71
v_mfma_f32_16x16x32_bf16 v[240:243], a[28:31], v[180:183], v[240:243]
ds_read_b128 a[24:27], v22 offset:256
v_cvt_pk_bf16_f32 v68, v248, v249
v_mfma_f32_16x16x32_bf16 v[244:247], a[32:35], v[88:91], v[32:35]
ds_read_b128 a[28:31], v23 offset:256
v_cvt_pk_bf16_f32 v69, v250, v251
v_mfma_f32_16x16x32_bf16 v[244:247], a[36:39], v[100:103], v[244:247]
v_exp_f32 v46, v46
v_mfma_f32_16x16x32_bf16 v[244:247], a[40:43], v[112:115], v[244:247]
v_exp_f32 v47, v47
v_mfma_f32_16x16x32_bf16 v[244:247], a[44:47], v[124:127], v[244:247]
v_exp_f32 v48, v48
v_mfma_f32_16x16x32_bf16 v[244:247], a[48:51], v[136:139], v[244:247]
v_lshrrev_b64 v[76:77], v2, v[76:77]
v_mfma_f32_16x16x32_bf16 v[244:247], a[52:55], v[148:151], v[244:247]
v_and_b32 v76, 1, v76
v_cmp_eq_u32 vcc, 0, v76
v_mfma_f32_16x16x32_bf16 v[244:247], a[56:59], v[160:163], v[244:247]
v_mov_b32 v78, 0
v_mov_b32 v79, 0
v_mfma_f32_16x16x32_bf16 v[244:247], a[60:63], v[172:175], v[244:247]
s_lshl_b32 s96, s59, 3
v_exp_f32 v49, v49
v_mfma_f32_16x16x32_bf16 v[248:251], a[32:35], v[92:95], v[36:39]
s_or_b32 s84, vcc_lo, 1
v_accvgpr_write_b32 a118, v68
v_accvgpr_write_b32 a119, v69
v_mfma_f32_16x16x32_bf16 v[248:251], a[36:39], v[104:107], v[248:251]
s_mov_b32 s85, vcc_hi
v_cvt_pk_bf16_f32 v70, v252, v253
v_mov_b32 v76, s84
v_mfma_f32_16x16x32_bf16 v[248:251], a[40:43], v[116:119], v[248:251]
v_cvt_pk_bf16_f32 v71, v254, v255
v_mov_b32 v77, s85
v_mfma_f32_16x16x32_bf16 v[248:251], a[44:47], v[128:131], v[248:251]
buffer_atomic_cmpswap_x2 v[76:79], v13, s[32:35], s96 offen sc0 sc1
v_mfma_f32_16x16x32_bf16 v[248:251], a[48:51], v[140:143], v[248:251]
buffer_load_dwordx4 v8, s[16:19], s62 offen nt lds
v_mfma_f32_16x16x32_bf16 v[248:251], a[52:55], v[152:155], v[248:251]
s_add_u32 m0, s61, 69632
v_exp_f32 v50, v50
v_mfma_f32_16x16x32_bf16 v[248:251], a[56:59], v[164:167], v[248:251]
s_mov_b32 s62, 32768
v_exp_f32 v51, v51
v_mfma_f32_16x16x32_bf16 v[248:251], a[60:63], v[176:179], v[248:251]
v_exp_f32 v52, v52
v_mfma_f32_16x16x32_bf16 v[252:255], a[32:35], v[96:99], v[40:43]
ds_read_b128 a[32:35], v20 offset:8192
v_accvgpr_write_b32 a122, v70
v_mfma_f32_16x16x32_bf16 v[252:255], a[36:39], v[108:111], v[252:255]
ds_read_b128 a[36:39], v21 offset:8192
v_accvgpr_write_b32 a123, v71
v_mfma_f32_16x16x32_bf16 v[252:255], a[40:43], v[120:123], v[252:255]
v_exp_f32 v53, v53
v_mfma_f32_16x16x32_bf16 v[252:255], a[44:47], v[132:135], v[252:255]
v_exp_f32 v54, v54
v_mfma_f32_16x16x32_bf16 v[252:255], a[48:51], v[144:147], v[252:255]
v_exp_f32 v55, v55
v_mfma_f32_16x16x32_bf16 v[252:255], a[52:55], v[156:159], v[252:255]
ds_read_b128 a[40:43], v22 offset:8192
v_cvt_pk_bf16_f32 v68, v44, v45
v_mfma_f32_16x16x32_bf16 v[252:255], a[56:59], v[168:171], v[252:255]
ds_read_b128 a[44:47], v23 offset:8192
v_cvt_pk_bf16_f32 v69, v46, v47
v_mfma_f32_16x16x32_bf16 v[252:255], a[60:63], v[180:183], v[252:255]
s_waitcnt lgkmcnt(3)
buffer_load_dwordx4 v8, s[16:19], s63 offen nt lds
v_mfma_f32_16x16x32_bf16 v[44:47], a[0:3], v[88:91], v[32:35]
ds_read_b128 a[48:51], v20 offset:8448
v_accvgpr_write_b32 a124, v68
v_mfma_f32_16x16x32_bf16 v[44:47], a[4:7], v[100:103], v[44:47]
ds_read_b128 a[52:55], v21 offset:8448
v_accvgpr_write_b32 a125, v69
v_mfma_f32_16x16x32_bf16 v[44:47], a[8:11], v[112:115], v[44:47]
ds_read_b128 a[56:59], v22 offset:8448
v_cvt_pk_bf16_f32 v70, v48, v49
v_mfma_f32_16x16x32_bf16 v[44:47], a[12:15], v[124:127], v[44:47]
ds_read_b128 a[60:63], v23 offset:8448
v_cvt_pk_bf16_f32 v71, v50, v51
v_mfma_f32_16x16x32_bf16 v[44:47], a[16:19], v[136:139], v[44:47]
v_exp_f32 v56, v56
v_mfma_f32_16x16x32_bf16 v[44:47], a[20:23], v[148:151], v[44:47]
v_exp_f32 v57, v57
v_mfma_f32_16x16x32_bf16 v[44:47], a[24:27], v[160:163], v[44:47]
v_exp_f32 v58, v58
v_mfma_f32_16x16x32_bf16 v[44:47], a[28:31], v[172:175], v[44:47]
s_add_u32 m0, s61, 73728
v_exp_f32 v59, v59
v_mfma_f32_16x16x32_bf16 v[48:51], a[0:3], v[92:95], v[36:39]
s_mov_b32 s63, 49152
v_accvgpr_write_b32 a128, v70
v_accvgpr_write_b32 a129, v71
v_mfma_f32_16x16x32_bf16 v[48:51], a[4:7], v[104:107], v[48:51]
v_exp_f32 v60, v60
v_mfma_f32_16x16x32_bf16 v[48:51], a[8:11], v[116:119], v[48:51]
v_exp_f32 v61, v61
v_mfma_f32_16x16x32_bf16 v[48:51], a[12:15], v[128:131], v[48:51]
v_exp_f32 v62, v62
v_mfma_f32_16x16x32_bf16 v[48:51], a[16:19], v[140:143], v[48:51]
v_exp_f32 v63, v63
v_mfma_f32_16x16x32_bf16 v[48:51], a[20:23], v[152:155], v[48:51]
buffer_load_dwordx4 v8, s[16:19], s62 offen nt lds
v_mfma_f32_16x16x32_bf16 v[48:51], a[24:27], v[164:167], v[48:51]
s_add_u32 m0, s61, 77824
v_cvt_pk_bf16_f32 v68, v52, v53
v_cvt_pk_bf16_f32 v69, v54, v55
v_mfma_f32_16x16x32_bf16 v[48:51], a[28:31], v[176:179], v[48:51]
s_mov_b32 s62, 65536
v_exp_f32 v64, v64
v_mfma_f32_16x16x32_bf16 v[52:55], a[0:3], v[96:99], v[40:43]
ds_read_b128 a[0:3], v20 offset:16384
v_accvgpr_write_b32 a132, v68
v_mfma_f32_16x16x32_bf16 v[52:55], a[4:7], v[108:111], v[52:55]
ds_read_b128 a[4:7], v21 offset:16384
v_accvgpr_write_b32 a133, v69
v_mfma_f32_16x16x32_bf16 v[52:55], a[8:11], v[120:123], v[52:55]
v_exp_f32 v65, v65
v_mfma_f32_16x16x32_bf16 v[52:55], a[12:15], v[132:135], v[52:55]
v_exp_f32 v66, v66
v_mfma_f32_16x16x32_bf16 v[52:55], a[16:19], v[144:147], v[52:55]
v_exp_f32 v67, v67
v_mfma_f32_16x16x32_bf16 v[52:55], a[20:23], v[156:159], v[52:55]
ds_read_b128 a[8:11], v22 offset:16384
v_cvt_pk_bf16_f32 v70, v56, v57
v_mfma_f32_16x16x32_bf16 v[52:55], a[24:27], v[168:171], v[52:55]
ds_read_b128 a[12:15], v23 offset:16384
v_cvt_pk_bf16_f32 v71, v58, v59
v_mfma_f32_16x16x32_bf16 v[52:55], a[28:31], v[180:183], v[52:55]
ds_read_b128 a[16:19], v20 offset:16640
v_accvgpr_write_b32 a126, v70
v_mfma_f32_16x16x32_bf16 v[56:59], a[32:35], v[88:91], v[32:35]
s_waitcnt lgkmcnt(3)
ds_read_b128 a[20:23], v21 offset:16640
v_accvgpr_write_b32 a127, v71
v_mfma_f32_16x16x32_bf16 v[56:59], a[36:39], v[100:103], v[56:59]
ds_read_b128 a[24:27], v22 offset:16640
v_cvt_pk_bf16_f32 v68, v60, v61
v_mfma_f32_16x16x32_bf16 v[56:59], a[40:43], v[112:115], v[56:59]
ds_read_b128 a[28:31], v23 offset:16640
v_cvt_pk_bf16_f32 v69, v62, v63
v_mfma_f32_16x16x32_bf16 v[56:59], a[44:47], v[124:127], v[56:59]
v_exp_f32 v232, v232
v_mfma_f32_16x16x32_bf16 v[56:59], a[48:51], v[136:139], v[56:59]
buffer_load_dwordx4 v8, s[16:19], s63 offen nt lds
v_mfma_f32_16x16x32_bf16 v[56:59], a[52:55], v[148:151], v[56:59]
v_exp_f32 v233, v233
v_mfma_f32_16x16x32_bf16 v[56:59], a[56:59], v[160:163], v[56:59]
v_exp_f32 v234, v234
v_mfma_f32_16x16x32_bf16 v[56:59], a[60:63], v[172:175], v[56:59]
s_add_u32 m0, s61, 81920
v_exp_f32 v235, v235
v_mfma_f32_16x16x32_bf16 v[60:63], a[32:35], v[92:95], v[36:39]
s_mov_b32 s63, 81920
v_accvgpr_write_b32 a130, v68
v_accvgpr_write_b32 a131, v69
v_mfma_f32_16x16x32_bf16 v[60:63], a[36:39], v[104:107], v[60:63]
v_exp_f32 v236, v236
v_mfma_f32_16x16x32_bf16 v[60:63], a[40:43], v[116:119], v[60:63]
v_exp_f32 v237, v237
v_mfma_f32_16x16x32_bf16 v[60:63], a[44:47], v[128:131], v[60:63]
v_exp_f32 v238, v238
v_mfma_f32_16x16x32_bf16 v[60:63], a[48:51], v[140:143], v[60:63]
v_exp_f32 v239, v239
v_mfma_f32_16x16x32_bf16 v[60:63], a[52:55], v[152:155], v[60:63]
v_exp_f32 v240, v240
v_mfma_f32_16x16x32_bf16 v[60:63], a[56:59], v[164:167], v[60:63]
v_cvt_pk_bf16_f32 v70, v64, v65
v_cvt_pk_bf16_f32 v71, v66, v67
v_mfma_f32_16x16x32_bf16 v[60:63], a[60:63], v[176:179], v[60:63]
v_exp_f32 v241, v241
v_mfma_f32_16x16x32_bf16 v[64:67], a[32:35], v[96:99], v[40:43]
ds_read_b128 a[32:35], v20 offset:24576
v_accvgpr_write_b32 a134, v70
v_mfma_f32_16x16x32_bf16 v[64:67], a[36:39], v[108:111], v[64:67]
ds_read_b128 a[36:39], v21 offset:24576
v_accvgpr_write_b32 a135, v71
v_mfma_f32_16x16x32_bf16 v[64:67], a[40:43], v[120:123], v[64:67]
buffer_load_dwordx4 v8, s[16:19], s62 offen nt lds
v_mfma_f32_16x16x32_bf16 v[64:67], a[44:47], v[132:135], v[64:67]
s_add_u32 m0, s61, 86016
ds_read_b128 a[40:43], v22 offset:24576
v_cvt_pk_bf16_f32 v68, v232, v233
v_mfma_f32_16x16x32_bf16 v[64:67], a[48:51], v[144:147], v[64:67]
s_mov_b32 s62, 98304
ds_read_b128 a[44:47], v23 offset:24576
v_cvt_pk_bf16_f32 v69, v234, v235
v_mfma_f32_16x16x32_bf16 v[64:67], a[52:55], v[156:159], v[64:67]
ds_read_b128 a[48:51], v20 offset:24832
v_accvgpr_write_b32 a136, v68
v_mfma_f32_16x16x32_bf16 v[64:67], a[56:59], v[168:171], v[64:67]
ds_read_b128 a[52:55], v21 offset:24832
v_accvgpr_write_b32 a137, v69
v_mfma_f32_16x16x32_bf16 v[64:67], a[60:63], v[180:183], v[64:67]
ds_read_b128 a[56:59], v22 offset:24832
v_cvt_pk_bf16_f32 v70, v236, v237
v_mfma_f32_16x16x32_bf16 v[232:235], a[0:3], v[88:91], v[32:35]
ds_read_b128 a[60:63], v23 offset:24832
v_cvt_pk_bf16_f32 v71, v238, v239
v_mfma_f32_16x16x32_bf16 v[232:235], a[4:7], v[100:103], v[232:235]
s_waitcnt lgkmcnt(6)
v_exp_f32 v242, v242
v_mfma_f32_16x16x32_bf16 v[232:235], a[8:11], v[112:115], v[232:235]
v_exp_f32 v243, v243
v_mfma_f32_16x16x32_bf16 v[232:235], a[12:15], v[124:127], v[232:235]
v_exp_f32 v244, v244
v_mfma_f32_16x16x32_bf16 v[232:235], a[16:19], v[136:139], v[232:235]
v_exp_f32 v245, v245
v_mfma_f32_16x16x32_bf16 v[232:235], a[20:23], v[148:151], v[232:235]
v_exp_f32 v246, v246
v_mfma_f32_16x16x32_bf16 v[232:235], a[24:27], v[160:163], v[232:235]
s_waitcnt vmcnt(14) lgkmcnt(0)
s_barrier
v_mfma_f32_16x16x32_bf16 v[232:235], a[28:31], v[172:175], v[232:235]
v_add_u32 v20, 0xffff8000, v20
v_add_u32 v21, 0xffff8000, v21
v_mfma_f32_16x16x32_bf16 v[236:239], a[0:3], v[92:95], v[36:39]
v_add_u32 v22, 0xffff8000, v22
v_add_u32 v23, 0xffff8000, v23
v_mfma_f32_16x16x32_bf16 v[236:239], a[4:7], v[104:107], v[236:239]
buffer_load_dwordx4 v8, s[16:19], s63 offen nt lds
v_mfma_f32_16x16x32_bf16 v[236:239], a[8:11], v[116:119], v[236:239]
s_add_u32 m0, s61, 90112
v_accvgpr_write_b32 a140, v70
v_accvgpr_write_b32 a141, v71
v_mfma_f32_16x16x32_bf16 v[236:239], a[12:15], v[128:131], v[236:239]
s_mov_b32 s63, 114688
v_exp_f32 v247, v247
v_mfma_f32_16x16x32_bf16 v[236:239], a[16:19], v[140:143], v[236:239]
v_exp_f32 v248, v248
v_mfma_f32_16x16x32_bf16 v[236:239], a[20:23], v[152:155], v[236:239]
v_exp_f32 v249, v249
v_mfma_f32_16x16x32_bf16 v[236:239], a[24:27], v[164:167], v[236:239]
v_cvt_pk_bf16_f32 v68, v240, v241
v_cvt_pk_bf16_f32 v69, v242, v243
v_mfma_f32_16x16x32_bf16 v[236:239], a[28:31], v[176:179], v[236:239]
v_exp_f32 v250, v250
v_mfma_f32_16x16x32_bf16 v[240:243], a[0:3], v[96:99], v[40:43]
ds_read_b128 a[0:3], v20 offset:0
v_accvgpr_write_b32 a144, v68
v_mfma_f32_16x16x32_bf16 v[240:243], a[4:7], v[108:111], v[240:243]
ds_read_b128 a[4:7], v21 offset:0
v_accvgpr_write_b32 a145, v69
v_mfma_f32_16x16x32_bf16 v[240:243], a[8:11], v[120:123], v[240:243]
v_exp_f32 v251, v251
v_mfma_f32_16x16x32_bf16 v[240:243], a[12:15], v[132:135], v[240:243]
v_exp_f32 v252, v252
v_mfma_f32_16x16x32_bf16 v[240:243], a[16:19], v[144:147], v[240:243]
v_exp_f32 v253, v253
v_mfma_f32_16x16x32_bf16 v[240:243], a[20:23], v[156:159], v[240:243]
v_exp_f32 v254, v254
v_mfma_f32_16x16x32_bf16 v[240:243], a[24:27], v[168:171], v[240:243]
buffer_load_dwordx4 v8, s[16:19], s62 offen nt lds
v_mfma_f32_16x16x32_bf16 v[240:243], a[28:31], v[180:183], v[240:243]
v_cvt_pk_bf16_f32 v70, v244, v245
v_cvt_pk_bf16_f32 v71, v246, v247
v_mfma_f32_16x16x32_bf16 v[244:247], a[32:35], v[88:91], v[32:35]
ds_read_b128 a[8:11], v22 offset:0
v_accvgpr_write_b32 a138, v70
v_mfma_f32_16x16x32_bf16 v[244:247], a[36:39], v[100:103], v[244:247]
ds_read_b128 a[12:15], v23 offset:0
v_accvgpr_write_b32 a139, v71
v_mfma_f32_16x16x32_bf16 v[244:247], a[40:43], v[112:115], v[244:247]
v_exp_f32 v255, v255
v_mfma_f32_16x16x32_bf16 v[244:247], a[44:47], v[124:127], v[244:247]
ds_read_b128 a[16:19], v20 offset:256
v_cvt_pk_bf16_f32 v68, v248, v249
v_mfma_f32_16x16x32_bf16 v[244:247], a[48:51], v[136:139], v[244:247]
ds_read_b128 a[20:23], v21 offset:256
v_cvt_pk_bf16_f32 v69, v250, v251
v_mfma_f32_16x16x32_bf16 v[244:247], a[52:55], v[148:151], v[244:247]
ds_read_b128 a[24:27], v22 offset:256
v_accvgpr_write_b32 a142, v68
v_mfma_f32_16x16x32_bf16 v[244:247], a[56:59], v[160:163], v[244:247]
ds_read_b128 a[28:31], v23 offset:256
v_accvgpr_write_b32 a143, v69
v_mfma_f32_16x16x32_bf16 v[244:247], a[60:63], v[172:175], v[244:247]
s_add_u32 m0, s61, 94208
v_exp_f32 v44, v44
v_mfma_f32_16x16x32_bf16 v[248:251], a[32:35], v[92:95], v[36:39]
s_mov_b32 s62, 131072
v_exp_f32 v45, v45
v_mfma_f32_16x16x32_bf16 v[248:251], a[36:39], v[104:107], v[248:251]
v_exp_f32 v46, v46
v_mfma_f32_16x16x32_bf16 v[248:251], a[40:43], v[116:119], v[248:251]
v_exp_f32 v47, v47
v_mfma_f32_16x16x32_bf16 v[248:251], a[44:47], v[128:131], v[248:251]
v_exp_f32 v48, v48
v_mfma_f32_16x16x32_bf16 v[248:251], a[48:51], v[140:143], v[248:251]
v_exp_f32 v49, v49
v_mfma_f32_16x16x32_bf16 v[248:251], a[52:55], v[152:155], v[248:251]
buffer_load_dwordx4 v8, s[16:19], s63 offen nt lds
v_mfma_f32_16x16x32_bf16 v[248:251], a[56:59], v[164:167], v[248:251]
s_add_u32 m0, s61, 32768
v_cvt_pk_bf16_f32 v70, v252, v253
v_cvt_pk_bf16_f32 v71, v254, v255
v_mfma_f32_16x16x32_bf16 v[248:251], a[60:63], v[176:179], v[248:251]
s_mov_b32 s63, 147456
v_exp_f32 v50, v50
v_mfma_f32_16x16x32_bf16 v[252:255], a[32:35], v[96:99], v[40:43]
ds_read_b128 a[32:35], v20 offset:8192
v_accvgpr_write_b32 a146, v70
v_mfma_f32_16x16x32_bf16 v[252:255], a[36:39], v[108:111], v[252:255]
ds_read_b128 a[36:39], v21 offset:8192
v_accvgpr_write_b32 a147, v71
v_mfma_f32_16x16x32_bf16 v[252:255], a[40:43], v[120:123], v[252:255]
v_exp_f32 v51, v51
v_mfma_f32_16x16x32_bf16 v[252:255], a[44:47], v[132:135], v[252:255]
v_exp_f32 v52, v52
v_mfma_f32_16x16x32_bf16 v[252:255], a[48:51], v[144:147], v[252:255]
v_exp_f32 v53, v53
v_mfma_f32_16x16x32_bf16 v[252:255], a[52:55], v[156:159], v[252:255]
v_exp_f32 v54, v54
v_mfma_f32_16x16x32_bf16 v[252:255], a[56:59], v[168:171], v[252:255]
ds_read_b128 a[40:43], v22 offset:8192
v_cvt_pk_bf16_f32 v68, v44, v45
v_mfma_f32_16x16x32_bf16 v[252:255], a[60:63], v[180:183], v[252:255]
s_waitcnt lgkmcnt(2)
ds_read_b128 a[44:47], v23 offset:8192
v_cvt_pk_bf16_f32 v69, v46, v47
v_mfma_f32_16x16x32_bf16 v[44:47], a[0:3], v[88:91], v[32:35]
ds_read_b128 a[48:51], v20 offset:8448
v_accvgpr_write_b32 a148, v68
v_mfma_f32_16x16x32_bf16 v[44:47], a[4:7], v[100:103], v[44:47]
ds_read_b128 a[52:55], v21 offset:8448
v_accvgpr_write_b32 a149, v69
v_mfma_f32_16x16x32_bf16 v[44:47], a[8:11], v[112:115], v[44:47]
v_exp_f32 v55, v55
v_mfma_f32_16x16x32_bf16 v[44:47], a[12:15], v[124:127], v[44:47]
buffer_load_dwordx4 v8, s[16:19], s62 offen nt lds
v_mfma_f32_16x16x32_bf16 v[44:47], a[16:19], v[136:139], v[44:47]
ds_read_b128 a[56:59], v22 offset:8448
v_cvt_pk_bf16_f32 v70, v48, v49
v_mfma_f32_16x16x32_bf16 v[44:47], a[20:23], v[148:151], v[44:47]
ds_read_b128 a[60:63], v23 offset:8448
v_cvt_pk_bf16_f32 v71, v50, v51
v_mfma_f32_16x16x32_bf16 v[44:47], a[24:27], v[160:163], v[44:47]
v_exp_f32 v56, v56
v_mfma_f32_16x16x32_bf16 v[44:47], a[28:31], v[172:175], v[44:47]
s_add_u32 m0, s61, 36864
v_exp_f32 v57, v57
v_mfma_f32_16x16x32_bf16 v[48:51], a[0:3], v[92:95], v[36:39]
s_mov_b32 s62, 163840
v_accvgpr_write_b32 a152, v70
v_accvgpr_write_b32 a153, v71
v_mfma_f32_16x16x32_bf16 v[48:51], a[4:7], v[104:107], v[48:51]
v_exp_f32 v58, v58
v_mfma_f32_16x16x32_bf16 v[48:51], a[8:11], v[116:119], v[48:51]
v_exp_f32 v59, v59
v_mfma_f32_16x16x32_bf16 v[48:51], a[12:15], v[128:131], v[48:51]
v_exp_f32 v60, v60
v_mfma_f32_16x16x32_bf16 v[48:51], a[16:19], v[140:143], v[48:51]
v_exp_f32 v61, v61
v_mfma_f32_16x16x32_bf16 v[48:51], a[20:23], v[152:155], v[48:51]
v_exp_f32 v62, v62
v_mfma_f32_16x16x32_bf16 v[48:51], a[24:27], v[164:167], v[48:51]
v_cvt_pk_bf16_f32 v68, v52, v53
v_cvt_pk_bf16_f32 v69, v54, v55
v_mfma_f32_16x16x32_bf16 v[48:51], a[28:31], v[176:179], v[48:51]
v_exp_f32 v63, v63
v_mfma_f32_16x16x32_bf16 v[52:55], a[0:3], v[96:99], v[40:43]
ds_read_b128 a[0:3], v20 offset:16384
v_accvgpr_write_b32 a156, v68
v_mfma_f32_16x16x32_bf16 v[52:55], a[4:7], v[108:111], v[52:55]
buffer_load_dwordx4 v8, s[16:19], s63 offen nt lds
v_mfma_f32_16x16x32_bf16 v[52:55], a[8:11], v[120:123], v[52:55]
s_add_u32 m0, s61, 40960
ds_read_b128 a[4:7], v21 offset:16384
v_accvgpr_write_b32 a157, v69
v_mfma_f32_16x16x32_bf16 v[52:55], a[12:15], v[132:135], v[52:55]
s_mov_b32 s63, 180224
v_exp_f32 v64, v64
v_mfma_f32_16x16x32_bf16 v[52:55], a[16:19], v[144:147], v[52:55]
v_exp_f32 v65, v65
v_mfma_f32_16x16x32_bf16 v[52:55], a[20:23], v[156:159], v[52:55]
v_exp_f32 v66, v66
v_mfma_f32_16x16x32_bf16 v[52:55], a[24:27], v[168:171], v[52:55]
ds_read_b128 a[8:11], v22 offset:16384
v_cvt_pk_bf16_f32 v70, v56, v57
v_mfma_f32_16x16x32_bf16 v[52:55], a[28:31], v[180:183], v[52:55]
ds_read_b128 a[12:15], v23 offset:16384
v_cvt_pk_bf16_f32 v71, v58, v59
v_mfma_f32_16x16x32_bf16 v[56:59], a[32:35], v[88:91], v[32:35]
s_waitcnt lgkmcnt(3)
ds_read_b128 a[16:19], v20 offset:16640
v_accvgpr_write_b32 a150, v70
v_mfma_f32_16x16x32_bf16 v[56:59], a[36:39], v[100:103], v[56:59]
ds_read_b128 a[20:23], v21 offset:16640
v_accvgpr_write_b32 a151, v71
v_mfma_f32_16x16x32_bf16 v[56:59], a[40:43], v[112:115], v[56:59]
v_exp_f32 v67, v67
v_mfma_f32_16x16x32_bf16 v[56:59], a[44:47], v[124:127], v[56:59]
ds_read_b128 a[24:27], v22 offset:16640
v_cvt_pk_bf16_f32 v68, v60, v61
v_mfma_f32_16x16x32_bf16 v[56:59], a[48:51], v[136:139], v[56:59]
ds_read_b128 a[28:31], v23 offset:16640
v_cvt_pk_bf16_f32 v69, v62, v63
v_mfma_f32_16x16x32_bf16 v[56:59], a[52:55], v[148:151], v[56:59]
v_exp_f32 v232, v232
v_mfma_f32_16x16x32_bf16 v[56:59], a[56:59], v[160:163], v[56:59]
v_exp_f32 v233, v233
v_mfma_f32_16x16x32_bf16 v[56:59], a[60:63], v[172:175], v[56:59]
buffer_load_dwordx4 v8, s[16:19], s62 offen nt lds
v_mfma_f32_16x16x32_bf16 v[60:63], a[32:35], v[92:95], v[36:39]
s_add_u32 m0, s61, 45056
v_accvgpr_write_b32 a154, v68
v_accvgpr_write_b32 a155, v69
v_mfma_f32_16x16x32_bf16 v[60:63], a[36:39], v[104:107], v[60:63]
s_mov_b32 s62, 196608
v_exp_f32 v234, v234
v_mfma_f32_16x16x32_bf16 v[60:63], a[40:43], v[116:119], v[60:63]
v_exp_f32 v235, v235
v_mfma_f32_16x16x32_bf16 v[60:63], a[44:47], v[128:131], v[60:63]
v_exp_f32 v44, v44
v_mfma_f32_16x16x32_bf16 v[60:63], a[48:51], v[140:143], v[60:63]
v_exp_f32 v45, v45
v_mfma_f32_16x16x32_bf16 v[60:63], a[52:55], v[152:155], v[60:63]
v_exp_f32 v46, v46
v_mfma_f32_16x16x32_bf16 v[60:63], a[56:59], v[164:167], v[60:63]
v_cvt_pk_bf16_f32 v70, v64, v65
v_cvt_pk_bf16_f32 v71, v66, v67
v_mfma_f32_16x16x32_bf16 v[60:63], a[60:63], v[176:179], v[60:63]
v_exp_f32 v47, v47
v_mfma_f32_16x16x32_bf16 v[64:67], a[32:35], v[96:99], v[40:43]
ds_read_b128 a[32:35], v20 offset:24576
v_accvgpr_write_b32 a158, v70
v_mfma_f32_16x16x32_bf16 v[64:67], a[36:39], v[108:111], v[64:67]
ds_read_b128 a[36:39], v21 offset:24576
v_accvgpr_write_b32 a159, v71
v_mfma_f32_16x16x32_bf16 v[64:67], a[40:43], v[120:123], v[64:67]
v_exp_f32 v236, v236
v_mfma_f32_16x16x32_bf16 v[64:67], a[44:47], v[132:135], v[64:67]
v_exp_f32 v237, v237
v_mfma_f32_16x16x32_bf16 v[64:67], a[48:51], v[144:147], v[64:67]
v_exp_f32 v238, v238
v_mfma_f32_16x16x32_bf16 v[64:67], a[52:55], v[156:159], v[64:67]
v_exp_f32 v239, v239
v_mfma_f32_16x16x32_bf16 v[64:67], a[56:59], v[168:171], v[64:67]
buffer_load_dwordx4 v8, s[16:19], s63 offen nt lds
v_mfma_f32_16x16x32_bf16 v[64:67], a[60:63], v[180:183], v[64:67]
v_cvt_pk_bf16_f32 v220, v232, v233
v_cvt_pk_bf16_f32 v221, v234, v235
v_cvt_pk_bf16_f32 v68, v44, v45
v_cvt_pk_bf16_f32 v69, v46, v47
v_mfma_f32_16x16x32_bf16 v[44:47], a[0:3], v[88:91], v[32:35]
s_waitcnt lgkmcnt(0)
ds_read_b128 a[40:43], v22 offset:24576
v_accvgpr_write_b32 a160, v68
v_mfma_f32_16x16x32_bf16 v[44:47], a[4:7], v[100:103], v[44:47]
ds_read_b128 a[44:47], v23 offset:24576
v_accvgpr_write_b32 a161, v69
v_mfma_f32_16x16x32_bf16 v[44:47], a[8:11], v[112:115], v[44:47]
v_exp_f32 v48, v48
v_mfma_f32_16x16x32_bf16 v[44:47], a[12:15], v[124:127], v[44:47]
v_exp_f32 v49, v49
v_mfma_f32_16x16x32_bf16 v[44:47], a[16:19], v[136:139], v[44:47]
v_exp_f32 v50, v50
v_mfma_f32_16x16x32_bf16 v[44:47], a[20:23], v[148:151], v[44:47]
v_exp_f32 v51, v51
v_mfma_f32_16x16x32_bf16 v[44:47], a[24:27], v[160:163], v[44:47]
ds_read_b128 a[48:51], v20 offset:24832
v_cvt_pk_bf16_f32 v224, v236, v237
v_mfma_f32_16x16x32_bf16 v[44:47], a[28:31], v[172:175], v[44:47]
s_add_u32 m0, s61, 49152
v_cvt_pk_bf16_f32 v225, v238, v239
v_cvt_pk_bf16_f32 v70, v48, v49
v_cvt_pk_bf16_f32 v71, v50, v51
v_mfma_f32_16x16x32_bf16 v[48:51], a[0:3], v[92:95], v[36:39]
s_mov_b32 s63, 212992
ds_read_b128 a[52:55], v21 offset:24832
v_accvgpr_write_b32 a164, v70
v_mfma_f32_16x16x32_bf16 v[48:51], a[4:7], v[104:107], v[48:51]
ds_read_b128 a[56:59], v22 offset:24832
v_accvgpr_write_b32 a165, v71
v_mfma_f32_16x16x32_bf16 v[48:51], a[8:11], v[116:119], v[48:51]
ds_read_b128 a[60:63], v23 offset:24832
v_add_u32 v20, 0xfffe8000, v20
v_mfma_f32_16x16x32_bf16 v[48:51], a[12:15], v[128:131], v[48:51]
v_add_u32 v21, 0xfffe8000, v21
v_add_u32 v22, 0xfffe8000, v22
v_mfma_f32_16x16x32_bf16 v[48:51], a[16:19], v[140:143], v[48:51]
v_add_u32 v23, 0xfffe8000, v23
v_mfma_f32_16x16x32_bf16 v[48:51], a[20:23], v[152:155], v[48:51]
buffer_load_dwordx4 v8, s[16:19], s62 offen nt lds
v_mfma_f32_16x16x32_bf16 v[48:51], a[24:27], v[164:167], v[48:51]
s_add_u32 m0, s61, 53248
v_exp_f32 v240, v240
v_exp_f32 v241, v241
v_exp_f32 v242, v242
v_exp_f32 v243, v243
v_exp_f32 v52, v52
v_exp_f32 v53, v53
v_exp_f32 v54, v54
v_exp_f32 v55, v55
v_mfma_f32_16x16x32_bf16 v[48:51], a[28:31], v[176:179], v[48:51]
s_mov_b32 s62, 229376
v_cvt_pk_bf16_f32 v228, v240, v241
v_cvt_pk_bf16_f32 v229, v242, v243
v_cvt_pk_bf16_f32 v68, v52, v53
v_cvt_pk_bf16_f32 v69, v54, v55
v_mfma_f32_16x16x32_bf16 v[52:55], a[0:3], v[96:99], v[40:43]
s_waitcnt vmcnt(14) lgkmcnt(0)
s_barrier
ds_read_b128 a[0:3], v20 offset:0
v_mfma_f32_16x16x32_bf16 v[52:55], a[4:7], v[108:111], v[52:55]
ds_read_b128 a[4:7], v21 offset:0
v_accvgpr_write_b32 a168, v68
v_mfma_f32_16x16x32_bf16 v[52:55], a[8:11], v[120:123], v[52:55]
ds_read_b128 a[8:11], v22 offset:0
v_accvgpr_write_b32 a169, v69
v_mfma_f32_16x16x32_bf16 v[52:55], a[12:15], v[132:135], v[52:55]
v_exp_f32 v244, v244
v_mfma_f32_16x16x32_bf16 v[52:55], a[16:19], v[144:147], v[52:55]
v_exp_f32 v245, v245
v_mfma_f32_16x16x32_bf16 v[52:55], a[20:23], v[156:159], v[52:55]
v_exp_f32 v246, v246
v_mfma_f32_16x16x32_bf16 v[52:55], a[24:27], v[168:171], v[52:55]
v_exp_f32 v247, v247
v_exp_f32 v56, v56
v_exp_f32 v57, v57
v_exp_f32 v58, v58
v_exp_f32 v59, v59
v_mfma_f32_16x16x32_bf16 v[52:55], a[28:31], v[180:183], v[52:55]
v_cvt_pk_bf16_f32 v222, v244, v245
v_cvt_pk_bf16_f32 v223, v246, v247
v_cvt_pk_bf16_f32 v70, v56, v57
v_cvt_pk_bf16_f32 v71, v58, v59
v_mfma_f32_16x16x32_bf16 v[56:59], a[32:35], v[88:91], v[32:35]
ds_read_b128 a[12:15], v23 offset:0
v_accvgpr_write_b32 a162, v70
v_mfma_f32_16x16x32_bf16 v[56:59], a[36:39], v[100:103], v[56:59]
ds_read_b128 a[16:19], v20 offset:256
v_accvgpr_write_b32 a163, v71
v_mfma_f32_16x16x32_bf16 v[56:59], a[40:43], v[112:115], v[56:59]
buffer_load_dwordx4 v8, s[16:19], s63 offen nt lds
v_mfma_f32_16x16x32_bf16 v[56:59], a[44:47], v[124:127], v[56:59]
v_exp_f32 v248, v248
v_mfma_f32_16x16x32_bf16 v[56:59], a[48:51], v[136:139], v[56:59]
v_exp_f32 v249, v249
v_mfma_f32_16x16x32_bf16 v[56:59], a[52:55], v[148:151], v[56:59]
v_exp_f32 v250, v250
v_mfma_f32_16x16x32_bf16 v[56:59], a[56:59], v[160:163], v[56:59]
v_exp_f32 v251, v251
v_exp_f32 v60, v60
v_exp_f32 v61, v61
v_exp_f32 v62, v62
v_exp_f32 v63, v63
v_mfma_f32_16x16x32_bf16 v[56:59], a[60:63], v[172:175], v[56:59]
s_add_u32 m0, s61, 57344
v_cvt_pk_bf16_f32 v226, v248, v249
v_cvt_pk_bf16_f32 v227, v250, v251
v_cvt_pk_bf16_f32 v68, v60, v61
v_cvt_pk_bf16_f32 v69, v62, v63
v_mfma_f32_16x16x32_bf16 v[60:63], a[32:35], v[92:95], v[36:39]
s_mov_b32 s63, 245760
ds_read_b128 a[20:23], v21 offset:256
v_accvgpr_write_b32 a166, v68
v_mfma_f32_16x16x32_bf16 v[60:63], a[36:39], v[104:107], v[60:63]
ds_read_b128 a[24:27], v22 offset:256
v_accvgpr_write_b32 a167, v69
v_mfma_f32_16x16x32_bf16 v[60:63], a[40:43], v[116:119], v[60:63]
v_exp_f32 v252, v252
v_mfma_f32_16x16x32_bf16 v[60:63], a[44:47], v[128:131], v[60:63]
v_exp_f32 v253, v253
v_mfma_f32_16x16x32_bf16 v[60:63], a[48:51], v[140:143], v[60:63]
v_exp_f32 v254, v254
v_mfma_f32_16x16x32_bf16 v[60:63], a[52:55], v[152:155], v[60:63]
v_exp_f32 v255, v255
v_mfma_f32_16x16x32_bf16 v[60:63], a[56:59], v[164:167], v[60:63]
v_exp_f32 v64, v64
v_exp_f32 v65, v65
v_exp_f32 v66, v66
v_exp_f32 v67, v67
v_mfma_f32_16x16x32_bf16 v[60:63], a[60:63], v[176:179], v[60:63]
v_cvt_pk_bf16_f32 v230, v252, v253
v_cvt_pk_bf16_f32 v231, v254, v255
v_cvt_pk_bf16_f32 v70, v64, v65
v_cvt_pk_bf16_f32 v71, v66, v67
v_mfma_f32_16x16x32_bf16 v[64:67], a[32:35], v[96:99], v[40:43]
buffer_load_dwordx4 v8, s[16:19], s62 offen nt lds
v_mfma_f32_16x16x32_bf16 v[64:67], a[36:39], v[108:111], v[64:67]
s_add_u32 m0, s61, 61440
ds_read_b128 a[28:31], v23 offset:256
v_accvgpr_write_b32 a170, v70
v_mfma_f32_16x16x32_bf16 v[64:67], a[40:43], v[120:123], v[64:67]
s_mov_b32 s62, 128
ds_read_b128 a[32:35], v20 offset:8192
v_accvgpr_write_b32 a171, v71
v_mfma_f32_16x16x32_bf16 v[64:67], a[44:47], v[132:135], v[64:67]
v_exp_f32 v44, v44
v_mfma_f32_16x16x32_bf16 v[64:67], a[48:51], v[144:147], v[64:67]
v_exp_f32 v45, v45
v_mfma_f32_16x16x32_bf16 v[64:67], a[52:55], v[156:159], v[64:67]
v_exp_f32 v46, v46
v_mfma_f32_16x16x32_bf16 v[64:67], a[56:59], v[168:171], v[64:67]
v_exp_f32 v47, v47
v_mfma_f32_16x16x32_bf16 v[64:67], a[60:63], v[180:183], v[64:67]
s_waitcnt lgkmcnt(2)
v_cvt_pk_bf16_f32 v68, v44, v45
v_cvt_pk_bf16_f32 v69, v46, v47
v_mfma_f32_16x16x32_bf16 v[44:47], a[0:3], v[88:91], v[32:35]
ds_read_b128 a[36:39], v21 offset:8192
v_accvgpr_write_b32 a172, v68
v_mfma_f32_16x16x32_bf16 v[44:47], a[4:7], v[100:103], v[44:47]
ds_read_b128 a[40:43], v22 offset:8192
v_accvgpr_write_b32 a173, v69
v_mfma_f32_16x16x32_bf16 v[44:47], a[8:11], v[112:115], v[44:47]
v_exp_f32 v48, v48
v_mfma_f32_16x16x32_bf16 v[44:47], a[12:15], v[124:127], v[44:47]
v_exp_f32 v49, v49
v_mfma_f32_16x16x32_bf16 v[44:47], a[16:19], v[136:139], v[44:47]
v_exp_f32 v50, v50
v_mfma_f32_16x16x32_bf16 v[44:47], a[20:23], v[148:151], v[44:47]
v_exp_f32 v51, v51
v_mfma_f32_16x16x32_bf16 v[44:47], a[24:27], v[160:163], v[44:47]
s_waitcnt lgkmcnt(2)
ds_read_b128 a[44:47], v23 offset:8192
v_cvt_pk_bf16_f32 v70, v48, v49
v_mfma_f32_16x16x32_bf16 v[44:47], a[28:31], v[172:175], v[44:47]
ds_read_b128 a[48:51], v20 offset:8448
v_cvt_pk_bf16_f32 v71, v50, v51
v_mfma_f32_16x16x32_bf16 v[48:51], a[0:3], v[92:95], v[36:39]
buffer_load_dwordx4 v8, s[16:19], s63 offen nt lds
v_mfma_f32_16x16x32_bf16 v[48:51], a[4:7], v[104:107], v[48:51]
s_add_u32 m0, s61, 131072
ds_read_b128 a[52:55], v21 offset:8448
v_accvgpr_write_b32 a176, v70
v_mfma_f32_16x16x32_bf16 v[48:51], a[8:11], v[116:119], v[48:51]
s_mov_b32 s63, 16512
ds_read_b128 a[56:59], v22 offset:8448
v_accvgpr_write_b32 a177, v71
v_mfma_f32_16x16x32_bf16 v[48:51], a[12:15], v[128:131], v[48:51]
v_exp_f32 v52, v52
v_mfma_f32_16x16x32_bf16 v[48:51], a[16:19], v[140:143], v[48:51]
v_exp_f32 v53, v53
v_mfma_f32_16x16x32_bf16 v[48:51], a[20:23], v[152:155], v[48:51]
v_exp_f32 v54, v54
v_mfma_f32_16x16x32_bf16 v[48:51], a[24:27], v[164:167], v[48:51]
v_exp_f32 v55, v55
v_mfma_f32_16x16x32_bf16 v[48:51], a[28:31], v[176:179], v[48:51]
v_cvt_pk_bf16_f32 v68, v52, v53
v_cvt_pk_bf16_f32 v69, v54, v55
v_mfma_f32_16x16x32_bf16 v[52:55], a[0:3], v[96:99], v[40:43]
ds_read_b128 a[60:63], v23 offset:8448
v_accvgpr_write_b32 a180, v68
v_mfma_f32_16x16x32_bf16 v[52:55], a[4:7], v[108:111], v[52:55]
ds_read_b128 a[0:3], v20 offset:16384
v_accvgpr_write_b32 a181, v69
v_mfma_f32_16x16x32_bf16 v[52:55], a[8:11], v[120:123], v[52:55]
v_exp_f32 v56, v56
v_mfma_f32_16x16x32_bf16 v[52:55], a[12:15], v[132:135], v[52:55]
v_exp_f32 v57, v57
v_mfma_f32_16x16x32_bf16 v[52:55], a[16:19], v[144:147], v[52:55]
v_exp_f32 v58, v58
v_mfma_f32_16x16x32_bf16 v[52:55], a[20:23], v[156:159], v[52:55]
buffer_load_dwordx4 v8, s[16:19], s62 offen nt lds
v_mfma_f32_16x16x32_bf16 v[52:55], a[24:27], v[168:171], v[52:55]
s_add_u32 m0, s61, 135168
v_exp_f32 v59, v59
v_mfma_f32_16x16x32_bf16 v[52:55], a[28:31], v[180:183], v[52:55]
v_cvt_pk_bf16_f32 v70, v56, v57
v_cvt_pk_bf16_f32 v71, v58, v59
v_mfma_f32_16x16x32_bf16 v[56:59], a[32:35], v[88:91], v[32:35]
s_waitcnt lgkmcnt(0)
ds_read_b128 a[4:7], v21 offset:16384
v_accvgpr_write_b32 a174, v70
v_mfma_f32_16x16x32_bf16 v[56:59], a[36:39], v[100:103], v[56:59]
ds_read_b128 a[8:11], v22 offset:16384
v_accvgpr_write_b32 a175, v71
v_mfma_f32_16x16x32_bf16 v[56:59], a[40:43], v[112:115], v[56:59]
v_exp_f32 v60, v60
v_mfma_f32_16x16x32_bf16 v[56:59], a[44:47], v[124:127], v[56:59]
v_exp_f32 v61, v61
v_mfma_f32_16x16x32_bf16 v[56:59], a[48:51], v[136:139], v[56:59]
v_exp_f32 v62, v62
v_mfma_f32_16x16x32_bf16 v[56:59], a[52:55], v[148:151], v[56:59]
v_exp_f32 v63, v63
v_mfma_f32_16x16x32_bf16 v[56:59], a[56:59], v[160:163], v[56:59]
ds_read_b128 a[12:15], v23 offset:16384
v_cvt_pk_bf16_f32 v68, v60, v61
v_mfma_f32_16x16x32_bf16 v[56:59], a[60:63], v[172:175], v[56:59]
s_mov_b32 s62, 32896
ds_read_b128 a[16:19], v20 offset:16640
v_cvt_pk_bf16_f32 v69, v62, v63
v_mfma_f32_16x16x32_bf16 v[60:63], a[32:35], v[92:95], v[36:39]
ds_read_b128 a[20:23], v21 offset:16640
v_accvgpr_write_b32 a178, v68
v_mfma_f32_16x16x32_bf16 v[60:63], a[36:39], v[104:107], v[60:63]
ds_read_b128 a[24:27], v22 offset:16640
v_accvgpr_write_b32 a179, v69
v_mfma_f32_16x16x32_bf16 v[60:63], a[40:43], v[116:119], v[60:63]
v_exp_f32 v64, v64
v_mfma_f32_16x16x32_bf16 v[60:63], a[44:47], v[128:131], v[60:63]
buffer_load_dwordx4 v8, s[16:19], s63 offen nt lds
v_mfma_f32_16x16x32_bf16 v[60:63], a[48:51], v[140:143], v[60:63]
s_add_u32 m0, s61, 139264
v_exp_f32 v65, v65
v_mfma_f32_16x16x32_bf16 v[60:63], a[52:55], v[152:155], v[60:63]
s_mov_b32 s63, 49280
v_exp_f32 v66, v66
v_mfma_f32_16x16x32_bf16 v[60:63], a[56:59], v[164:167], v[60:63]
v_exp_f32 v67, v67
v_mfma_f32_16x16x32_bf16 v[60:63], a[60:63], v[176:179], v[60:63]
v_cvt_pk_bf16_f32 v70, v64, v65
v_cvt_pk_bf16_f32 v71, v66, v67
v_mfma_f32_16x16x32_bf16 v[64:67], a[32:35], v[96:99], v[40:43]
ds_read_b128 a[28:31], v23 offset:16640
v_accvgpr_write_b32 a182, v70
v_mfma_f32_16x16x32_bf16 v[64:67], a[36:39], v[108:111], v[64:67]
ds_read_b128 a[32:35], v20 offset:24576
v_accvgpr_write_b32 a183, v71
v_mfma_f32_16x16x32_bf16 v[64:67], a[40:43], v[120:123], v[64:67]
v_exp_f32 v44, v44
v_mfma_f32_16x16x32_bf16 v[64:67], a[44:47], v[132:135], v[64:67]
v_exp_f32 v45, v45
v_mfma_f32_16x16x32_bf16 v[64:67], a[48:51], v[144:147], v[64:67]
v_exp_f32 v46, v46
v_mfma_f32_16x16x32_bf16 v[64:67], a[52:55], v[156:159], v[64:67]
v_exp_f32 v47, v47
v_mfma_f32_16x16x32_bf16 v[64:67], a[56:59], v[168:171], v[64:67]
ds_read_b128 a[36:39], v21 offset:24576
v_cvt_pk_bf16_f32 v232, v44, v45
v_mfma_f32_16x16x32_bf16 v[64:67], a[60:63], v[180:183], v[64:67]
ds_read_b128 a[40:43], v22 offset:24576
v_cvt_pk_bf16_f32 v233, v46, v47
v_mfma_f32_16x16x32_bf16 v[44:47], a[0:3], v[88:91], v[32:35]
s_waitcnt lgkmcnt(2)
v_exp_f32 v48, v48
v_mfma_f32_16x16x32_bf16 v[44:47], a[4:7], v[100:103], v[44:47]
buffer_load_dwordx4 v8, s[16:19], s62 offen nt lds
v_mfma_f32_16x16x32_bf16 v[44:47], a[8:11], v[112:115], v[44:47]
v_exp_f32 v49, v49
v_mfma_f32_16x16x32_bf16 v[44:47], a[12:15], v[124:127], v[44:47]
v_exp_f32 v50, v50
v_mfma_f32_16x16x32_bf16 v[44:47], a[16:19], v[136:139], v[44:47]
v_exp_f32 v51, v51
v_mfma_f32_16x16x32_bf16 v[44:47], a[20:23], v[148:151], v[44:47]
v_exp_f32 v52, v52
v_mfma_f32_16x16x32_bf16 v[44:47], a[24:27], v[160:163], v[44:47]
ds_read_b128 a[44:47], v23 offset:24576
v_cvt_pk_bf16_f32 v236, v48, v49
v_mfma_f32_16x16x32_bf16 v[44:47], a[28:31], v[172:175], v[44:47]
s_add_u32 m0, s61, 143360
ds_read_b128 a[48:51], v20 offset:24832
v_cvt_pk_bf16_f32 v237, v50, v51
v_mfma_f32_16x16x32_bf16 v[48:51], a[0:3], v[92:95], v[36:39]
s_mov_b32 s62, 65664
v_exp_f32 v53, v53
v_mfma_f32_16x16x32_bf16 v[48:51], a[4:7], v[104:107], v[48:51]
v_exp_f32 v54, v54
v_mfma_f32_16x16x32_bf16 v[48:51], a[8:11], v[116:119], v[48:51]
v_exp_f32 v55, v55
v_mfma_f32_16x16x32_bf16 v[48:51], a[12:15], v[128:131], v[48:51]
ds_read_b128 a[52:55], v21 offset:24832
v_cvt_pk_bf16_f32 v240, v52, v53
v_mfma_f32_16x16x32_bf16 v[48:51], a[16:19], v[140:143], v[48:51]
ds_read_b128 a[56:59], v22 offset:24832
v_cvt_pk_bf16_f32 v241, v54, v55
v_mfma_f32_16x16x32_bf16 v[48:51], a[20:23], v[152:155], v[48:51]
ds_read_b128 a[60:63], v23 offset:24832
v_mfma_f32_16x16x32_bf16 v[48:51], a[24:27], v[164:167], v[48:51]
v_exp_f32 v56, v56
v_mfma_f32_16x16x32_bf16 v[48:51], a[28:31], v[176:179], v[48:51]
v_exp_f32 v57, v57
v_mfma_f32_16x16x32_bf16 v[52:55], a[0:3], v[96:99], v[40:43]
buffer_load_dwordx4 v8, s[16:19], s63 offen nt lds
v_mfma_f32_16x16x32_bf16 v[52:55], a[4:7], v[108:111], v[52:55]
s_add_u32 m0, s61, 147456
v_exp_f32 v58, v58
v_mfma_f32_16x16x32_bf16 v[52:55], a[8:11], v[120:123], v[52:55]
s_mov_b32 s63, 82048
v_exp_f32 v59, v59
v_mfma_f32_16x16x32_bf16 v[52:55], a[12:15], v[132:135], v[52:55]
s_waitcnt vmcnt(12) lgkmcnt(0)
s_barrier
ds_read_b64_tr_b16 a[0:1], v24 offset:0
v_mfma_f32_16x16x32_bf16 v[52:55], a[16:19], v[144:147], v[52:55]
v_exp_f32 v60, v60
v_mfma_f32_16x16x32_bf16 v[52:55], a[20:23], v[156:159], v[52:55]
v_exp_f32 v61, v61
v_mfma_f32_16x16x32_bf16 v[52:55], a[24:27], v[168:171], v[52:55]
ds_read_b64_tr_b16 a[2:3], v24 offset:2048
v_cvt_pk_bf16_f32 v234, v56, v57
v_mfma_f32_16x16x32_bf16 v[52:55], a[28:31], v[180:183], v[52:55]
ds_read_b64_tr_b16 a[4:5], v24 offset:4096
v_cvt_pk_bf16_f32 v235, v58, v59
v_mfma_f32_16x16x32_bf16 v[56:59], a[32:35], v[88:91], v[32:35]
v_exp_f32 v62, v62
v_mfma_f32_16x16x32_bf16 v[56:59], a[36:39], v[100:103], v[56:59]
v_exp_f32 v63, v63
v_mfma_f32_16x16x32_bf16 v[56:59], a[40:43], v[112:115], v[56:59]
v_exp_f32 v64, v64
v_mfma_f32_16x16x32_bf16 v[56:59], a[44:47], v[124:127], v[56:59]
v_exp_f32 v65, v65
v_mfma_f32_16x16x32_bf16 v[56:59], a[48:51], v[136:139], v[56:59]
v_exp_f32 v66, v66
v_mfma_f32_16x16x32_bf16 v[56:59], a[52:55], v[148:151], v[56:59]
v_exp_f32 v67, v67
v_mfma_f32_16x16x32_bf16 v[56:59], a[56:59], v[160:163], v[56:59]
ds_read_b64_tr_b16 a[6:7], v24 offset:6144
v_readfirstlane_b32 s94, v76
v_mfma_f32_16x16x32_bf16 v[56:59], a[60:63], v[172:175], v[56:59]
v_cvt_pk_bf16_f32 v238, v60, v61
v_cvt_pk_bf16_f32 v239, v62, v63
v_mfma_f32_16x16x32_bf16 v[60:63], a[32:35], v[92:95], v[36:39]
ds_read_b64_tr_b16 a[8:9], v24 offset:8192
v_readfirstlane_b32 s95, v77
v_mfma_f32_16x16x32_bf16 v[60:63], a[36:39], v[104:107], v[60:63]
buffer_load_dwordx4 v8, s[16:19], s62 offen nt lds
v_mfma_f32_16x16x32_bf16 v[60:63], a[40:43], v[116:119], v[60:63]
s_add_u32 m0, s61, 151552
v_exp_f32 v44, v44
v_mfma_f32_16x16x32_bf16 v[60:63], a[44:47], v[128:131], v[60:63]
s_or_b32 s96, s94, s95
s_cselect_b32 s84, s94, s84
s_cselect_b32 s85, s95, s85
v_exp_f32 v45, v45
v_mfma_f32_16x16x32_bf16 v[60:63], a[48:51], v[140:143], v[60:63]
s_mov_b32 s62, 98432
ds_read_b64_tr_b16 a[10:11], v24 offset:10240
v_mov_b32 v14, s84
v_mfma_f32_16x16x32_bf16 v[60:63], a[52:55], v[152:155], v[60:63]
ds_read_b64_tr_b16 a[12:13], v24 offset:12288
v_mov_b32 v15, s85
v_mfma_f32_16x16x32_bf16 v[60:63], a[56:59], v[164:167], v[60:63]
ds_read_b64_tr_b16 a[14:15], v24 offset:14336
v_cvt_pk_bf16_f32 v242, v64, v65
v_mfma_f32_16x16x32_bf16 v[60:63], a[60:63], v[176:179], v[60:63]
ds_read_b64_tr_b16 a[16:17], v24 offset:16384
v_cvt_pk_bf16_f32 v243, v66, v67
v_mfma_f32_16x16x32_bf16 v[64:67], a[32:35], v[96:99], v[40:43]
v_exp_f32 v46, v46
v_mfma_f32_16x16x32_bf16 v[64:67], a[36:39], v[108:111], v[64:67]
v_exp_f32 v47, v47
v_mfma_f32_16x16x32_bf16 v[64:67], a[40:43], v[120:123], v[64:67]
v_exp_f32 v56, v56
v_mfma_f32_16x16x32_bf16 v[64:67], a[44:47], v[132:135], v[64:67]
v_exp_f32 v57, v57
v_mfma_f32_16x16x32_bf16 v[64:67], a[48:51], v[144:147], v[64:67]
buffer_load_dwordx4 v8, s[16:19], s63 offen nt lds
v_mfma_f32_16x16x32_bf16 v[64:67], a[52:55], v[156:159], v[64:67]
s_add_u32 m0, s61, 155648
v_exp_f32 v58, v58
v_mfma_f32_16x16x32_bf16 v[64:67], a[56:59], v[168:171], v[64:67]
s_mov_b32 s63, 114816
v_exp_f32 v59, v59
v_mfma_f32_16x16x32_bf16 v[64:67], a[60:63], v[180:183], v[64:67]
v_exp_f32 v48, v48
v_mfma_f32_16x16x32_bf16 v[32:35], a[248:251], v[184:187], 0
v_exp_f32 v49, v49
v_mfma_f32_16x16x32_bf16 v[32:35], a[248:251], v[196:199], v[32:35]
v_exp_f32 v50, v50
v_mfma_f32_16x16x32_bf16 v[32:35], a[248:251], a[64:67], v[32:35]
v_exp_f32 v51, v51
v_mfma_f32_16x16x32_bf16 v[32:35], a[248:251], a[76:79], v[32:35]
v_exp_f32 v60, v60
v_mfma_f32_16x16x32_bf16 v[32:35], a[248:251], a[88:91], v[32:35]
v_exp_f32 v61, v61
v_mfma_f32_16x16x32_bf16 v[32:35], a[248:251], a[100:103], v[32:35]
v_exp_f32 v62, v62
v_mfma_f32_16x16x32_bf16 v[32:35], a[248:251], v[208:211], v[32:35]
v_exp_f32 v63, v63
v_mfma_f32_16x16x32_bf16 v[32:35], a[248:251], a[112:115], v[32:35]
ds_read_b64_tr_b16 a[18:19], v24 offset:18432
v_cvt_pk_bf16_f32 v244, v44, v45
v_mfma_f32_16x16x32_bf16 v[32:35], a[248:251], a[124:127], v[32:35]
ds_read_b64_tr_b16 a[20:21], v24 offset:20480
v_cvt_pk_bf16_f32 v245, v46, v47
v_mfma_f32_16x16x32_bf16 v[32:35], a[248:251], a[136:139], v[32:35]
ds_read_b64_tr_b16 a[22:23], v24 offset:22528
v_cvt_pk_bf16_f32 v246, v56, v57
v_mfma_f32_16x16x32_bf16 v[32:35], a[248:251], a[148:151], v[32:35]
buffer_load_dwordx4 v8, s[16:19], s62 offen nt lds
v_mfma_f32_16x16x32_bf16 v[32:35], a[248:251], v[220:223], v[32:35]
s_add_u32 m0, s61, 159744
ds_read_b64_tr_b16 a[24:25], v24 offset:24576
v_cvt_pk_bf16_f32 v247, v58, v59
v_mfma_f32_16x16x32_bf16 v[32:35], a[248:251], a[160:163], v[32:35]
s_mov_b32 s62, 131200
ds_read_b64_tr_b16 a[26:27], v24 offset:26624
v_cvt_pk_bf16_f32 v248, v48, v49
v_mfma_f32_16x16x32_bf16 v[32:35], a[248:251], a[172:175], v[32:35]
v_exp_f32 v52, v52
v_mfma_f32_16x16x32_bf16 v[32:35], a[248:251], v[232:235], v[32:35]
v_exp_f32 v53, v53
v_mfma_f32_16x16x32_bf16 v[32:35], a[248:251], v[244:247], v[32:35]
v_exp_f32 v54, v54
v_mfma_f32_16x16x32_bf16 v[36:39], a[248:251], v[188:191], 0
v_exp_f32 v55, v55
v_mfma_f32_16x16x32_bf16 v[36:39], a[248:251], v[200:203], v[36:39]
v_exp_f32 v64, v64
v_mfma_f32_16x16x32_bf16 v[36:39], a[248:251], a[68:71], v[36:39]
v_rcp_f32 v80, v32
v_mfma_f32_16x16x32_bf16 v[36:39], a[248:251], a[80:83], v[36:39]
ds_read_b64_tr_b16 a[28:29], v24 offset:28672
v_cmp_nge_f32 vcc, s67, v32
v_mfma_f32_16x16x32_bf16 v[36:39], a[248:251], a[92:95], v[36:39]
v_exp_f32 v65, v65
v_mfma_f32_16x16x32_bf16 v[36:39], a[248:251], a[104:107], v[36:39]
v_exp_f32 v66, v66
v_mfma_f32_16x16x32_bf16 v[36:39], a[248:251], v[212:215], v[36:39]
s_or_b32 s97, vcc_lo, vcc_hi
s_or_b32 s69, s69, s97
v_exp_f32 v67, v67
v_mfma_f32_16x16x32_bf16 v[36:39], a[248:251], a[116:119], v[36:39]
ds_read_b64_tr_b16 a[30:31], v24 offset:30720
v_cvt_pk_bf16_f32 v249, v50, v51
v_mfma_f32_16x16x32_bf16 v[36:39], a[248:251], a[128:131], v[36:39]
ds_read_b64_tr_b16 a[32:33], v25 offset:0
v_cvt_pk_bf16_f32 v250, v60, v61
v_mfma_f32_16x16x32_bf16 v[36:39], a[248:251], a[140:143], v[36:39]
buffer_load_dwordx4 v8, s[16:19], s63 offen nt lds
v_mfma_f32_16x16x32_bf16 v[36:39], a[248:251], a[152:155], v[36:39]
s_add_u32 m0, s61, 98304
ds_read_b64_tr_b16 a[34:35], v25 offset:2048
v_cvt_pk_bf16_f32 v251, v62, v63
v_mfma_f32_16x16x32_bf16 v[36:39], a[248:251], v[224:227], v[36:39]
s_mov_b32 s63, 147584
ds_read_b64_tr_b16 a[36:37], v25 offset:4096
v_cvt_pk_bf16_f32 v252, v52, v53
v_mfma_f32_16x16x32_bf16 v[36:39], a[248:251], a[164:167], v[36:39]
ds_read_b64_tr_b16 a[38:39], v25 offset:6144
v_cvt_pk_bf16_f32 v253, v54, v55
v_mfma_f32_16x16x32_bf16 v[36:39], a[248:251], a[176:179], v[36:39]
ds_read_b64_tr_b16 a[40:41], v25 offset:8192
v_cvt_pk_bf16_f32 v254, v64, v65
v_mfma_f32_16x16x32_bf16 v[36:39], a[248:251], v[236:239], v[36:39]
ds_read_b64_tr_b16 a[42:43], v25 offset:10240
v_cvt_pk_bf16_f32 v255, v66, v67
v_mfma_f32_16x16x32_bf16 v[36:39], a[248:251], v[248:251], v[36:39]
ds_read_b64_tr_b16 a[44:45], v25 offset:12288
v_mfma_f32_16x16x32_bf16 v[40:43], a[248:251], v[192:195], 0
ds_read_b64_tr_b16 a[46:47], v25 offset:14336
v_mfma_f32_16x16x32_bf16 v[40:43], a[248:251], v[204:207], v[40:43]
ds_read_b64_tr_b16 a[48:49], v25 offset:16384
v_mfma_f32_16x16x32_bf16 v[40:43], a[248:251], a[72:75], v[40:43]
v_rcp_f32 v81, v36
v_mfma_f32_16x16x32_bf16 v[40:43], a[248:251], a[84:87], v[40:43]
ds_read_b64_tr_b16 a[50:51], v25 offset:18432
v_cmp_nge_f32 vcc, s67, v36
v_mfma_f32_16x16x32_bf16 v[40:43], a[248:251], a[96:99], v[40:43]
ds_read_b64_tr_b16 a[52:53], v25 offset:20480
v_mfma_f32_16x16x32_bf16 v[40:43], a[248:251], a[108:111], v[40:43]
ds_read_b64_tr_b16 a[54:55], v25 offset:22528
v_mfma_f32_16x16x32_bf16 v[40:43], a[248:251], v[216:219], v[40:43]
s_or_b32 s97, vcc_lo, vcc_hi
s_or_b32 s69, s69, s97
ds_read_b64_tr_b16 a[56:57], v25 offset:24576
v_mfma_f32_16x16x32_bf16 v[40:43], a[248:251], a[120:123], v[40:43]
buffer_load_dwordx4 v8, s[16:19], s62 offen nt lds
v_mfma_f32_16x16x32_bf16 v[40:43], a[248:251], a[132:135], v[40:43]
s_add_u32 m0, s61, 102400
ds_read_b64_tr_b16 a[58:59], v25 offset:26624
v_mfma_f32_16x16x32_bf16 v[40:43], a[248:251], a[144:147], v[40:43]
s_mov_b32 s62, 163968
ds_read_b64_tr_b16 a[60:61], v25 offset:28672
v_mfma_f32_16x16x32_bf16 v[40:43], a[248:251], a[156:159], v[40:43]
ds_read_b64_tr_b16 a[62:63], v25 offset:30720
v_mfma_f32_16x16x32_bf16 v[40:43], a[248:251], v[228:231], v[40:43]
v_mfma_f32_16x16x32_bf16 v[40:43], a[248:251], a[168:171], v[40:43]
v_mfma_f32_16x16x32_bf16 v[40:43], a[248:251], a[180:183], v[40:43]
v_mfma_f32_16x16x32_bf16 v[40:43], a[248:251], v[240:243], v[40:43]
v_mfma_f32_16x16x32_bf16 v[40:43], a[248:251], v[252:255], v[40:43]
s_waitcnt lgkmcnt(2)
v_mfma_f32_16x16x32_bf16 v[44:47], a[0:3], v[184:187], 0
v_mfma_f32_16x16x32_bf16 v[44:47], a[4:7], v[196:199], v[44:47]
v_mfma_f32_16x16x32_bf16 v[44:47], a[8:11], a[64:67], v[44:47]
v_rcp_f32 v82, v40
v_mfma_f32_16x16x32_bf16 v[44:47], a[12:15], a[76:79], v[44:47]
v_cmp_nge_f32 vcc, s67, v40
v_mfma_f32_16x16x32_bf16 v[44:47], a[16:19], a[88:91], v[44:47]
v_mfma_f32_16x16x32_bf16 v[44:47], a[20:23], a[100:103], v[44:47]
buffer_load_dwordx4 v8, s[16:19], s63 offen nt lds
v_mfma_f32_16x16x32_bf16 v[44:47], a[24:27], v[208:211], v[44:47]
v_mfma_f32_16x16x32_bf16 v[44:47], a[28:31], a[112:115], v[44:47]
s_or_b32 s97, vcc_lo, vcc_hi
s_or_b32 s69, s69, s97
v_mfma_f32_16x16x32_bf16 v[48:51], a[0:3], v[188:191], 0
s_add_u32 m0, s61, 106496
v_mfma_f32_16x16x32_bf16 v[48:51], a[4:7], v[200:203], v[48:51]
s_mov_b32 s63, 180352
v_mfma_f32_16x16x32_bf16 v[48:51], a[8:11], a[68:71], v[48:51]
v_mfma_f32_16x16x32_bf16 v[48:51], a[12:15], a[80:83], v[48:51]
v_mfma_f32_16x16x32_bf16 v[48:51], a[16:19], a[92:95], v[48:51]
v_mfma_f32_16x16x32_bf16 v[48:51], a[20:23], a[104:107], v[48:51]
v_mfma_f32_16x16x32_bf16 v[48:51], a[24:27], v[212:215], v[48:51]
v_mfma_f32_16x16x32_bf16 v[48:51], a[28:31], a[116:119], v[48:51]
v_mfma_f32_16x16x32_bf16 v[52:55], a[0:3], v[192:195], 0
ds_read_b64_tr_b16 a[0:1], v26 offset:0
v_mfma_f32_16x16x32_bf16 v[52:55], a[4:7], v[204:207], v[52:55]
ds_read_b64_tr_b16 a[2:3], v26 offset:2048
v_mfma_f32_16x16x32_bf16 v[52:55], a[8:11], a[72:75], v[52:55]
ds_read_b64_tr_b16 a[4:5], v26 offset:4096
v_mfma_f32_16x16x32_bf16 v[52:55], a[12:15], a[84:87], v[52:55]
buffer_load_dwordx4 v8, s[16:19], s62 offen nt lds
v_mfma_f32_16x16x32_bf16 v[52:55], a[16:19], a[96:99], v[52:55]
s_add_u32 m0, s61, 110592
ds_read_b64_tr_b16 a[6:7], v26 offset:6144
v_mfma_f32_16x16x32_bf16 v[52:55], a[20:23], a[108:111], v[52:55]
s_mov_b32 s62, 196736
ds_read_b64_tr_b16 a[8:9], v26 offset:8192
v_mfma_f32_16x16x32_bf16 v[52:55], a[24:27], v[216:219], v[52:55]
ds_read_b64_tr_b16 a[10:11], v26 offset:10240
v_mfma_f32_16x16x32_bf16 v[52:55], a[28:31], a[120:123], v[52:55]
ds_read_b64_tr_b16 a[12:13], v26 offset:12288
v_mfma_f32_16x16x32_bf16 v[56:59], a[32:35], v[184:187], 0
ds_read_b64_tr_b16 a[14:15], v26 offset:14336
v_mfma_f32_16x16x32_bf16 v[56:59], a[36:39], v[196:199], v[56:59]
ds_read_b64_tr_b16 a[16:17], v26 offset:16384
v_mfma_f32_16x16x32_bf16 v[56:59], a[40:43], a[64:67], v[56:59]
ds_read_b64_tr_b16 a[18:19], v26 offset:18432
v_mfma_f32_16x16x32_bf16 v[56:59], a[44:47], a[76:79], v[56:59]
ds_read_b64_tr_b16 a[20:21], v26 offset:20480
v_mfma_f32_16x16x32_bf16 v[56:59], a[48:51], a[88:91], v[56:59]
ds_read_b64_tr_b16 a[22:23], v26 offset:22528
v_mfma_f32_16x16x32_bf16 v[56:59], a[52:55], a[100:103], v[56:59]
ds_read_b64_tr_b16 a[24:25], v26 offset:24576
v_mfma_f32_16x16x32_bf16 v[56:59], a[56:59], v[208:211], v[56:59]
s_waitcnt lgkmcnt(6)
ds_read_b64_tr_b16 a[26:27], v26 offset:26624
v_mfma_f32_16x16x32_bf16 v[56:59], a[60:63], a[112:115], v[56:59]
ds_read_b64_tr_b16 a[28:29], v26 offset:28672
v_mfma_f32_16x16x32_bf16 v[60:63], a[32:35], v[188:191], 0
ds_read_b64_tr_b16 a[30:31], v26 offset:30720
v_mfma_f32_16x16x32_bf16 v[60:63], a[36:39], v[200:203], v[60:63]
v_mfma_f32_16x16x32_bf16 v[60:63], a[40:43], a[68:71], v[60:63]
buffer_load_dwordx4 v8, s[16:19], s63 offen nt lds
v_mfma_f32_16x16x32_bf16 v[60:63], a[44:47], a[80:83], v[60:63]
s_add_u32 m0, s61, 114688
v_mfma_f32_16x16x32_bf16 v[60:63], a[48:51], a[92:95], v[60:63]
s_mov_b32 s63, 213120
v_mfma_f32_16x16x32_bf16 v[60:63], a[52:55], a[104:107], v[60:63]
v_mfma_f32_16x16x32_bf16 v[60:63], a[56:59], v[212:215], v[60:63]
v_mfma_f32_16x16x32_bf16 v[60:63], a[60:63], a[116:119], v[60:63]
v_mfma_f32_16x16x32_bf16 v[64:67], a[32:35], v[192:195], 0
ds_read_b64_tr_b16 a[32:33], v27 offset:0
v_mfma_f32_16x16x32_bf16 v[64:67], a[36:39], v[204:207], v[64:67]
ds_read_b64_tr_b16 a[34:35], v27 offset:2048
v_mfma_f32_16x16x32_bf16 v[64:67], a[40:43], a[72:75], v[64:67]
ds_read_b64_tr_b16 a[36:37], v27 offset:4096
v_mfma_f32_16x16x32_bf16 v[64:67], a[44:47], a[84:87], v[64:67]
ds_read_b64_tr_b16 a[38:39], v27 offset:6144
v_mfma_f32_16x16x32_bf16 v[64:67], a[48:51], a[96:99], v[64:67]
ds_read_b64_tr_b16 a[40:41], v27 offset:8192
v_mfma_f32_16x16x32_bf16 v[64:67], a[52:55], a[108:111], v[64:67]
ds_read_b64_tr_b16 a[42:43], v27 offset:10240
v_mfma_f32_16x16x32_bf16 v[64:67], a[56:59], v[216:219], v[64:67]
ds_read_b64_tr_b16 a[44:45], v27 offset:12288
v_mfma_f32_16x16x32_bf16 v[64:67], a[60:63], a[120:123], v[64:67]
ds_read_b64_tr_b16 a[46:47], v27 offset:14336
v_mfma_f32_16x16x32_bf16 v[68:71], a[0:3], v[184:187], 0
buffer_load_dwordx4 v8, s[16:19], s62 offen nt lds
v_mfma_f32_16x16x32_bf16 v[68:71], a[4:7], v[196:199], v[68:71]
ds_read_b64_tr_b16 a[48:49], v27 offset:16384
v_mfma_f32_16x16x32_bf16 v[68:71], a[8:11], a[64:67], v[68:71]
s_waitcnt lgkmcnt(5)
ds_read_b64_tr_b16 a[50:51], v27 offset:18432
v_mfma_f32_16x16x32_bf16 v[68:71], a[12:15], a[76:79], v[68:71]
ds_read_b64_tr_b16 a[52:53], v27 offset:20480
v_mfma_f32_16x16x32_bf16 v[68:71], a[16:19], a[88:91], v[68:71]
ds_read_b64_tr_b16 a[54:55], v27 offset:22528
v_mfma_f32_16x16x32_bf16 v[68:71], a[20:23], a[100:103], v[68:71]
ds_read_b64_tr_b16 a[56:57], v27 offset:24576
v_mfma_f32_16x16x32_bf16 v[68:71], a[24:27], v[208:211], v[68:71]
ds_read_b64_tr_b16 a[58:59], v27 offset:26624
v_mfma_f32_16x16x32_bf16 v[68:71], a[28:31], a[112:115], v[68:71]
s_add_u32 m0, s61, 118784
ds_read_b64_tr_b16 a[60:61], v27 offset:28672
v_mfma_f32_16x16x32_bf16 v[72:75], a[0:3], v[188:191], 0
s_mov_b32 s62, 229504
ds_read_b64_tr_b16 a[62:63], v27 offset:30720
v_add_u32 v24, 0xffff8000, v24
v_mfma_f32_16x16x32_bf16 v[72:75], a[4:7], v[200:203], v[72:75]
s_cmp_eq_u32 s68, 0
s_cselect_b32 s69, s69, 0
v_add_u32 v25, 0xffff8000, v25
v_add_u32 v26, 0xffff8000, v26
v_mfma_f32_16x16x32_bf16 v[72:75], a[8:11], a[68:71], v[72:75]
v_add_u32 v27, 0xffff8000, v27
v_lshrrev_b32 v3, 6, v0
v_mfma_f32_16x16x32_bf16 v[72:75], a[12:15], a[80:83], v[72:75]
v_mov_b32 v1, s69
v_mov_b32 v84, 57344
v_mfma_f32_16x16x32_bf16 v[72:75], a[16:19], a[92:95], v[72:75]
v_lshl_add_u32 v3, v3, 4, v84
v_mfma_f32_16x16x32_bf16 v[72:75], a[20:23], a[104:107], v[72:75]
v_mfma_f32_16x16x32_bf16 v[72:75], a[24:27], v[212:215], v[72:75]
s_waitcnt vmcnt(13) lgkmcnt(0)
s_barrier
v_mfma_f32_16x16x32_bf16 v[72:75], a[28:31], a[116:119], v[72:75]
buffer_load_dwordx4 v8, s[16:19], s63 offen nt lds
v_mfma_f32_16x16x32_bf16 v[76:79], a[0:3], v[192:195], 0
s_add_u32 m0, s61, 122880
ds_read_b64_tr_b16 a[0:1], v24 offset:0
v_mfma_f32_16x16x32_bf16 v[76:79], a[4:7], v[204:207], v[76:79]
s_mov_b32 s63, 245888
ds_read_b64_tr_b16 a[2:3], v24 offset:2048
v_mfma_f32_16x16x32_bf16 v[76:79], a[8:11], a[72:75], v[76:79]
ds_read_b64_tr_b16 a[4:5], v24 offset:4096
v_mfma_f32_16x16x32_bf16 v[76:79], a[12:15], a[84:87], v[76:79]
ds_read_b64_tr_b16 a[6:7], v24 offset:6144
v_mfma_f32_16x16x32_bf16 v[76:79], a[16:19], a[96:99], v[76:79]
ds_read_b64_tr_b16 a[8:9], v24 offset:8192
v_mfma_f32_16x16x32_bf16 v[76:79], a[20:23], a[108:111], v[76:79]
ds_read_b64_tr_b16 a[10:11], v24 offset:10240
v_mfma_f32_16x16x32_bf16 v[76:79], a[24:27], v[216:219], v[76:79]
ds_read_b64_tr_b16 a[12:13], v24 offset:12288
v_mfma_f32_16x16x32_bf16 v[76:79], a[28:31], a[120:123], v[76:79]
ds_read_b64_tr_b16 a[14:15], v24 offset:14336
v_mfma_f32_16x16x32_bf16 v[32:35], a[32:35], v[184:187], 0
ds_read_b64_tr_b16 a[16:17], v24 offset:16384
v_mfma_f32_16x16x32_bf16 v[32:35], a[36:39], v[196:199], v[32:35]
ds_read_b64_tr_b16 a[18:19], v24 offset:18432
v_mfma_f32_16x16x32_bf16 v[32:35], a[40:43], a[64:67], v[32:35]
ds_read_b64_tr_b16 a[20:21], v24 offset:20480
v_mfma_f32_16x16x32_bf16 v[32:35], a[44:47], a[76:79], v[32:35]
ds_read_b64_tr_b16 a[22:23], v24 offset:22528
v_mfma_f32_16x16x32_bf16 v[32:35], a[48:51], a[88:91], v[32:35]
buffer_load_dwordx4 v8, s[16:19], s62 offen nt lds
v_mfma_f32_16x16x32_bf16 v[32:35], a[52:55], a[100:103], v[32:35]
ds_read_b64_tr_b16 a[24:25], v24 offset:24576
v_mfma_f32_16x16x32_bf16 v[32:35], a[56:59], v[208:211], v[32:35]
ds_read_b64_tr_b16 a[26:27], v24 offset:26624
v_mfma_f32_16x16x32_bf16 v[32:35], a[60:63], a[112:115], v[32:35]
s_add_u32 m0, s61, 126976
ds_read_b64_tr_b16 a[28:29], v24 offset:28672
v_mfma_f32_16x16x32_bf16 v[36:39], a[32:35], v[188:191], 0
s_mov_b32 s62, 256
ds_read_b64_tr_b16 a[30:31], v24 offset:30720
v_mfma_f32_16x16x32_bf16 v[36:39], a[36:39], v[200:203], v[36:39]
v_mfma_f32_16x16x32_bf16 v[36:39], a[40:43], a[68:71], v[36:39]
v_mfma_f32_16x16x32_bf16 v[36:39], a[44:47], a[80:83], v[36:39]
v_mfma_f32_16x16x32_bf16 v[36:39], a[48:51], a[92:95], v[36:39]
v_mfma_f32_16x16x32_bf16 v[36:39], a[52:55], a[104:107], v[36:39]
v_mfma_f32_16x16x32_bf16 v[36:39], a[56:59], v[212:215], v[36:39]
v_mfma_f32_16x16x32_bf16 v[36:39], a[60:63], a[116:119], v[36:39]
v_mfma_f32_16x16x32_bf16 v[40:43], a[32:35], v[192:195], 0
ds_read_b64_tr_b16 a[32:33], v25 offset:0
v_mfma_f32_16x16x32_bf16 v[40:43], a[36:39], v[204:207], v[40:43]
ds_read_b64_tr_b16 a[34:35], v25 offset:2048
v_mfma_f32_16x16x32_bf16 v[40:43], a[40:43], a[72:75], v[40:43]
ds_read_b64_tr_b16 a[36:37], v25 offset:4096
v_mfma_f32_16x16x32_bf16 v[40:43], a[44:47], a[84:87], v[40:43]
buffer_load_dwordx4 v8, s[16:19], s63 offen nt lds
v_mfma_f32_16x16x32_bf16 v[40:43], a[48:51], a[96:99], v[40:43]
s_add_u32 m0, s61, 0
ds_read_b64_tr_b16 a[38:39], v25 offset:6144
v_mfma_f32_16x16x32_bf16 v[40:43], a[52:55], a[108:111], v[40:43]
s_mov_b32 s63, 16640
ds_read_b64_tr_b16 a[40:41], v25 offset:8192
v_mfma_f32_16x16x32_bf16 v[40:43], a[56:59], v[216:219], v[40:43]
ds_read_b64_tr_b16 a[42:43], v25 offset:10240
v_mfma_f32_16x16x32_bf16 v[40:43], a[60:63], a[120:123], v[40:43]
s_waitcnt lgkmcnt(5)
ds_read_b64_tr_b16 a[44:45], v25 offset:12288
v_mfma_f32_16x16x32_bf16 v[44:47], a[0:3], a[124:127], v[44:47]
ds_read_b64_tr_b16 a[46:47], v25 offset:14336
v_mfma_f32_16x16x32_bf16 v[44:47], a[4:7], a[136:139], v[44:47]
ds_read_b64_tr_b16 a[48:49], v25 offset:16384
v_mfma_f32_16x16x32_bf16 v[44:47], a[8:11], a[148:151], v[44:47]
ds_read_b64_tr_b16 a[50:51], v25 offset:18432
v_mfma_f32_16x16x32_bf16 v[44:47], a[12:15], v[220:223], v[44:47]
ds_read_b64_tr_b16 a[52:53], v25 offset:20480
v_mfma_f32_16x16x32_bf16 v[44:47], a[16:19], a[160:163], v[44:47]
ds_read_b64_tr_b16 a[54:55], v25 offset:22528
v_mfma_f32_16x16x32_bf16 v[44:47], a[20:23], a[172:175], v[44:47]
ds_read_b64_tr_b16 a[56:57], v25 offset:24576
v_mfma_f32_16x16x32_bf16 v[44:47], a[24:27], v[232:235], v[44:47]
ds_read_b64_tr_b16 a[58:59], v25 offset:26624
v_mfma_f32_16x16x32_bf16 v[44:47], a[28:31], v[244:247], v[44:47]
ds_read_b64_tr_b16 a[60:61], v25 offset:28672
v_mfma_f32_16x16x32_bf16 v[48:51], a[0:3], a[128:131], v[48:51]
ds_read_b64_tr_b16 a[62:63], v25 offset:30720
v_mfma_f32_16x16x32_bf16 v[48:51], a[4:7], a[140:143], v[48:51]
buffer_load_dwordx4 v8, s[16:19], s62 offen nt lds
v_mfma_f32_16x16x32_bf16 v[48:51], a[8:11], a[152:155], v[48:51]
s_add_u32 m0, s61, 4096
v_mul_f32 v44, v80, v44
v_mul_f32 v45, v80, v45
v_mfma_f32_16x16x32_bf16 v[48:51], a[12:15], v[224:227], v[48:51]
s_mov_b32 s62, 33024
v_cvt_pk_bf16_f32 v88, v44, v45
v_mul_f32 v46, v80, v46
v_mfma_f32_16x16x32_bf16 v[48:51], a[16:19], a[164:167], v[48:51]
v_mul_f32 v47, v80, v47
v_cvt_pk_bf16_f32 v89, v46, v47
v_mfma_f32_16x16x32_bf16 v[48:51], a[20:23], a[176:179], v[48:51]
v_mfma_f32_16x16x32_bf16 v[48:51], a[24:27], v[236:239], v[48:51]
v_mfma_f32_16x16x32_bf16 v[48:51], a[28:31], v[248:251], v[48:51]
v_mfma_f32_16x16x32_bf16 v[52:55], a[0:3], a[132:135], v[52:55]
ds_read_b64_tr_b16 a[0:1], v26 offset:0
v_mfma_f32_16x16x32_bf16 v[52:55], a[4:7], a[144:147], v[52:55]
ds_read_b64_tr_b16 a[2:3], v26 offset:2048
v_mfma_f32_16x16x32_bf16 v[52:55], a[8:11], a[156:159], v[52:55]
ds_read_b64_tr_b16 a[4:5], v26 offset:4096
v_mul_f32 v48, v81, v48
v_mfma_f32_16x16x32_bf16 v[52:55], a[12:15], v[228:231], v[52:55]
ds_read_b64_tr_b16 a[6:7], v26 offset:6144
v_mul_f32 v49, v81, v49
v_mfma_f32_16x16x32_bf16 v[52:55], a[16:19], a[168:171], v[52:55]
ds_read_b64_tr_b16 a[8:9], v26 offset:8192
v_cvt_pk_bf16_f32 v92, v48, v49
v_mfma_f32_16x16x32_bf16 v[52:55], a[20:23], a[180:183], v[52:55]
ds_read_b64_tr_b16 a[10:11], v26 offset:10240
v_mul_f32 v50, v81, v50
v_mfma_f32_16x16x32_bf16 v[52:55], a[24:27], v[240:243], v[52:55]
ds_read_b64_tr_b16 a[12:13], v26 offset:12288
v_mul_f32 v51, v81, v51
v_mfma_f32_16x16x32_bf16 v[52:55], a[28:31], v[252:255], v[52:55]
s_waitcnt lgkmcnt(6)
buffer_load_dwordx4 v8, s[16:19], s63 offen nt lds
v_mfma_f32_16x16x32_bf16 v[56:59], a[32:35], a[124:127], v[56:59]
ds_read_b64_tr_b16 a[14:15], v26 offset:14336
v_cvt_pk_bf16_f32 v93, v50, v51
v_mfma_f32_16x16x32_bf16 v[56:59], a[36:39], a[136:139], v[56:59]
ds_read_b64_tr_b16 a[16:17], v26 offset:16384
v_mfma_f32_16x16x32_bf16 v[56:59], a[40:43], a[148:151], v[56:59]
ds_read_b64_tr_b16 a[18:19], v26 offset:18432
v_mul_f32 v52, v82, v52
v_mfma_f32_16x16x32_bf16 v[56:59], a[44:47], v[220:223], v[56:59]
ds_read_b64_tr_b16 a[20:21], v26 offset:20480
v_mul_f32 v53, v82, v53
v_mfma_f32_16x16x32_bf16 v[56:59], a[48:51], a[160:163], v[56:59]
ds_read_b64_tr_b16 a[22:23], v26 offset:22528
v_cvt_pk_bf16_f32 v96, v52, v53
v_mfma_f32_16x16x32_bf16 v[56:59], a[52:55], a[172:175], v[56:59]
ds_read_b64_tr_b16 a[24:25], v26 offset:24576
v_mul_f32 v54, v82, v54
v_mfma_f32_16x16x32_bf16 v[56:59], a[56:59], v[232:235], v[56:59]
ds_read_b64_tr_b16 a[26:27], v26 offset:26624
v_mul_f32 v55, v82, v55
v_mfma_f32_16x16x32_bf16 v[56:59], a[60:63], v[244:247], v[56:59]
s_add_u32 m0, s61, 8192
ds_read_b64_tr_b16 a[28:29], v26 offset:28672
v_cvt_pk_bf16_f32 v97, v54, v55
v_mfma_f32_16x16x32_bf16 v[60:63], a[32:35], a[128:131], v[60:63]
s_mov_b32 s63, 49408
ds_read_b64_tr_b16 a[30:31], v26 offset:30720
v_mfma_f32_16x16x32_bf16 v[60:63], a[36:39], a[140:143], v[60:63]
v_mfma_f32_16x16x32_bf16 v[60:63], a[40:43], a[152:155], v[60:63]
v_mul_f32 v56, v80, v56
v_mul_f32 v57, v80, v57
v_mfma_f32_16x16x32_bf16 v[60:63], a[44:47], v[224:227], v[60:63]
v_cvt_pk_bf16_f32 v90, v56, v57
v_mul_f32 v58, v80, v58
v_mfma_f32_16x16x32_bf16 v[60:63], a[48:51], a[164:167], v[60:63]
v_mul_f32 v59, v80, v59
v_cvt_pk_bf16_f32 v91, v58, v59
v_mfma_f32_16x16x32_bf16 v[60:63], a[52:55], a[176:179], v[60:63]
buffer_load_dwordx4 v8, s[16:19], s62 offen nt lds
v_mfma_f32_16x16x32_bf16 v[60:63], a[56:59], v[236:239], v[60:63]
s_add_u32 m0, s61, 12288
v_mfma_f32_16x16x32_bf16 v[60:63], a[60:63], v[248:251], v[60:63]
s_mov_b32 s62, 65792
v_mfma_f32_16x16x32_bf16 v[64:67], a[32:35], a[132:135], v[64:67]
ds_read_b64_tr_b16 a[32:33], v27 offset:0
v_mfma_f32_16x16x32_bf16 v[64:67], a[36:39], a[144:147], v[64:67]
ds_read_b64_tr_b16 a[34:35], v27 offset:2048
v_mfma_f32_16x16x32_bf16 v[64:67], a[40:43], a[156:159], v[64:67]
ds_read_b64_tr_b16 a[36:37], v27 offset:4096
v_mul_f32 v60, v81, v60
v_mfma_f32_16x16x32_bf16 v[64:67], a[44:47], v[228:231], v[64:67]
ds_read_b64_tr_b16 a[38:39], v27 offset:6144
v_mul_f32 v61, v81, v61
v_mfma_f32_16x16x32_bf16 v[64:67], a[48:51], a[168:171], v[64:67]
ds_read_b64_tr_b16 a[40:41], v27 offset:8192
v_cvt_pk_bf16_f32 v94, v60, v61
v_mfma_f32_16x16x32_bf16 v[64:67], a[52:55], a[180:183], v[64:67]
ds_read_b64_tr_b16 a[42:43], v27 offset:10240
v_mul_f32 v62, v81, v62
v_mfma_f32_16x16x32_bf16 v[64:67], a[56:59], v[240:243], v[64:67]
ds_read_b64_tr_b16 a[44:45], v27 offset:12288
v_mul_f32 v63, v81, v63
v_mfma_f32_16x16x32_bf16 v[64:67], a[60:63], v[252:255], v[64:67]
s_waitcnt lgkmcnt(6)
ds_read_b64_tr_b16 a[46:47], v27 offset:14336
v_cvt_pk_bf16_f32 v95, v62, v63
v_mfma_f32_16x16x32_bf16 v[68:71], a[0:3], a[124:127], v[68:71]
ds_read_b64_tr_b16 a[48:49], v27 offset:16384
v_mfma_f32_16x16x32_bf16 v[68:71], a[4:7], a[136:139], v[68:71]
ds_read_b64_tr_b16 a[50:51], v27 offset:18432
v_mfma_f32_16x16x32_bf16 v[68:71], a[8:11], a[148:151], v[68:71]
ds_read_b64_tr_b16 a[52:53], v27 offset:20480
v_mul_f32 v64, v82, v64
v_mfma_f32_16x16x32_bf16 v[68:71], a[12:15], v[220:223], v[68:71]
ds_read_b64_tr_b16 a[54:55], v27 offset:22528
v_mul_f32 v65, v82, v65
v_mfma_f32_16x16x32_bf16 v[68:71], a[16:19], a[160:163], v[68:71]
buffer_load_dwordx4 v8, s[16:19], s63 offen nt lds
v_mfma_f32_16x16x32_bf16 v[68:71], a[20:23], a[172:175], v[68:71]
ds_read_b64_tr_b16 a[56:57], v27 offset:24576
v_cvt_pk_bf16_f32 v98, v64, v65
v_mfma_f32_16x16x32_bf16 v[68:71], a[24:27], v[232:235], v[68:71]
ds_read_b64_tr_b16 a[58:59], v27 offset:26624
v_mul_f32 v66, v82, v66
v_mfma_f32_16x16x32_bf16 v[68:71], a[28:31], v[244:247], v[68:71]
s_add_u32 m0, s61, 16384
ds_read_b64_tr_b16 a[60:61], v27 offset:28672
v_mul_f32 v67, v82, v67
v_mfma_f32_16x16x32_bf16 v[72:75], a[0:3], a[128:131], v[72:75]
s_mov_b32 s63, 82176
ds_read_b64_tr_b16 a[62:63], v27 offset:30720
v_add_u32 v24, 0x18000, v24
v_mfma_f32_16x16x32_bf16 v[72:75], a[4:7], a[140:143], v[72:75]
v_add_u32 v25, 0x18000, v25
v_add_u32 v26, 0x18000, v26
v_mfma_f32_16x16x32_bf16 v[72:75], a[8:11], a[152:155], v[72:75]
v_add_u32 v27, 0x18000, v27
v_cvt_pk_bf16_f32 v99, v66, v67
v_mfma_f32_16x16x32_bf16 v[72:75], a[12:15], v[224:227], v[72:75]
v_mul_f32 v68, v80, v68
v_mul_f32 v69, v80, v69
v_mfma_f32_16x16x32_bf16 v[72:75], a[16:19], a[164:167], v[72:75]
v_cvt_pk_bf16_f32 v100, v68, v69
v_mul_f32 v70, v80, v70
v_mfma_f32_16x16x32_bf16 v[72:75], a[20:23], a[176:179], v[72:75]
v_mul_f32 v71, v80, v71
v_cvt_pk_bf16_f32 v101, v70, v71
v_mfma_f32_16x16x32_bf16 v[72:75], a[24:27], v[236:239], v[72:75]
s_waitcnt vmcnt(12) lgkmcnt(0)
s_barrier
ds_write_b32 v3, v1
v_mfma_f32_16x16x32_bf16 v[72:75], a[28:31], v[248:251], v[72:75]
ds_write_b64 v3, v[14:15] offset:8
v_mfma_f32_16x16x32_bf16 v[76:79], a[0:3], a[132:135], v[76:79]
ds_read_b64_tr_b16 a[0:1], v24 offset:0
v_mov_b32 v3, 57344
v_mfma_f32_16x16x32_bf16 v[76:79], a[4:7], a[144:147], v[76:79]
ds_read_b64_tr_b16 a[2:3], v24 offset:2048
v_mfma_f32_16x16x32_bf16 v[76:79], a[8:11], a[156:159], v[76:79]
buffer_load_dwordx4 v8, s[16:19], s62 offen nt lds
v_mfma_f32_16x16x32_bf16 v[76:79], a[12:15], v[228:231], v[76:79]
s_add_u32 m0, s61, 20480
ds_read_b64_tr_b16 a[4:5], v24 offset:4096
v_mul_f32 v72, v81, v72
v_mfma_f32_16x16x32_bf16 v[76:79], a[16:19], a[168:171], v[76:79]
s_mov_b32 s62, 98560
ds_read_b64_tr_b16 a[6:7], v24 offset:6144
v_mul_f32 v73, v81, v73
v_mfma_f32_16x16x32_bf16 v[76:79], a[20:23], a[180:183], v[76:79]
ds_read_b64_tr_b16 a[8:9], v24 offset:8192
v_cvt_pk_bf16_f32 v104, v72, v73
v_mfma_f32_16x16x32_bf16 v[76:79], a[24:27], v[240:243], v[76:79]
ds_read_b64_tr_b16 a[10:11], v24 offset:10240
v_mul_f32 v74, v81, v74
v_mfma_f32_16x16x32_bf16 v[76:79], a[28:31], v[252:255], v[76:79]
ds_read_b64_tr_b16 a[12:13], v24 offset:12288
v_mul_f32 v75, v81, v75
v_mfma_f32_16x16x32_bf16 v[32:35], a[32:35], a[124:127], v[32:35]
ds_read_b64_tr_b16 a[14:15], v24 offset:14336
v_cvt_pk_bf16_f32 v105, v74, v75
v_mfma_f32_16x16x32_bf16 v[32:35], a[36:39], a[136:139], v[32:35]
ds_read_b64_tr_b16 a[16:17], v24 offset:16384
v_mfma_f32_16x16x32_bf16 v[32:35], a[40:43], a[148:151], v[32:35]
ds_read_b64_tr_b16 a[18:19], v24 offset:18432
v_mul_f32 v76, v82, v76
v_mfma_f32_16x16x32_bf16 v[32:35], a[44:47], v[220:223], v[32:35]
ds_read_b64_tr_b16 a[20:21], v24 offset:20480
v_mul_f32 v77, v82, v77
v_mfma_f32_16x16x32_bf16 v[32:35], a[48:51], a[160:163], v[32:35]
ds_read_b64_tr_b16 a[22:23], v24 offset:22528
v_cvt_pk_bf16_f32 v108, v76, v77
v_mfma_f32_16x16x32_bf16 v[32:35], a[52:55], a[172:175], v[32:35]
ds_read_b64_tr_b16 a[24:25], v24 offset:24576
v_mul_f32 v78, v82, v78
v_mfma_f32_16x16x32_bf16 v[32:35], a[56:59], v[232:235], v[32:35]
ds_read_b64_tr_b16 a[26:27], v24 offset:26624
v_mul_f32 v79, v82, v79
v_mfma_f32_16x16x32_bf16 v[32:35], a[60:63], v[244:247], v[32:35]
ds_read_b64_tr_b16 a[28:29], v24 offset:28672
v_cvt_pk_bf16_f32 v109, v78, v79
v_mfma_f32_16x16x32_bf16 v[36:39], a[32:35], a[128:131], v[36:39]
buffer_load_dwordx4 v8, s[16:19], s63 offen nt lds
v_mfma_f32_16x16x32_bf16 v[36:39], a[36:39], a[140:143], v[36:39]
s_add_u32 m0, s61, 24576
ds_read_b64_tr_b16 a[30:31], v24 offset:30720
v_mfma_f32_16x16x32_bf16 v[36:39], a[40:43], a[152:155], v[36:39]
s_mov_b32 s63, 114944
ds_write_b64 v10, v[88:89] offset:0
v_mfma_f32_16x16x32_bf16 v[36:39], a[44:47], v[224:227], v[36:39]
ds_write_b64 v10, v[90:91] offset:8
v_mfma_f32_16x16x32_bf16 v[36:39], a[48:51], a[164:167], v[36:39]
ds_write_b64 v10, v[92:93] offset:1024
v_mfma_f32_16x16x32_bf16 v[36:39], a[52:55], a[176:179], v[36:39]
ds_write_b64 v10, v[94:95] offset:1032
v_mfma_f32_16x16x32_bf16 v[36:39], a[56:59], v[236:239], v[36:39]
ds_write_b64 v10, v[96:97] offset:2048
v_mfma_f32_16x16x32_bf16 v[36:39], a[60:63], v[248:251], v[36:39]
ds_write_b64 v10, v[98:99] offset:2056
v_mfma_f32_16x16x32_bf16 v[40:43], a[32:35], a[132:135], v[40:43]
ds_read_b64_tr_b16 a[32:33], v25 offset:0
v_mul_f32 v32, v80, v32
v_mfma_f32_16x16x32_bf16 v[40:43], a[36:39], a[144:147], v[40:43]
ds_read_b64_tr_b16 a[34:35], v25 offset:2048
v_mul_f32 v33, v80, v33
v_mfma_f32_16x16x32_bf16 v[40:43], a[40:43], a[156:159], v[40:43]
ds_read_b64_tr_b16 a[36:37], v25 offset:4096
v_cvt_pk_bf16_f32 v102, v32, v33
v_mfma_f32_16x16x32_bf16 v[40:43], a[44:47], v[228:231], v[40:43]
ds_read_b64_tr_b16 a[38:39], v25 offset:6144
v_mul_f32 v34, v80, v34
v_mfma_f32_16x16x32_bf16 v[40:43], a[48:51], a[168:171], v[40:43]
ds_read_b64_tr_b16 a[40:41], v25 offset:8192
v_mul_f32 v35, v80, v35
v_mfma_f32_16x16x32_bf16 v[40:43], a[52:55], a[180:183], v[40:43]
ds_read_b64_tr_b16 a[42:43], v25 offset:10240
v_cvt_pk_bf16_f32 v103, v34, v35
v_mfma_f32_16x16x32_bf16 v[40:43], a[56:59], v[240:243], v[40:43]
buffer_load_dwordx4 v8, s[16:19], s62 offen nt lds
v_mfma_f32_16x16x32_bf16 v[40:43], a[60:63], v[252:255], v[40:43]
s_waitcnt lgkmcnt(5)
ds_read_b64_tr_b16 a[44:45], v25 offset:12288
v_mul_f32 v36, v81, v36
v_mfma_f32_16x16x32_bf16 v[44:47], a[0:3], v[184:187], 0
ds_read_b64_tr_b16 a[46:47], v25 offset:14336
v_mul_f32 v37, v81, v37
v_mfma_f32_16x16x32_bf16 v[44:47], a[4:7], v[196:199], v[44:47]
ds_read_b64_tr_b16 a[48:49], v25 offset:16384
v_cvt_pk_bf16_f32 v106, v36, v37
v_mfma_f32_16x16x32_bf16 v[44:47], a[8:11], a[64:67], v[44:47]
ds_read_b64_tr_b16 a[50:51], v25 offset:18432
v_mul_f32 v38, v81, v38
v_mfma_f32_16x16x32_bf16 v[44:47], a[12:15], a[76:79], v[44:47]
ds_read_b64_tr_b16 a[52:53], v25 offset:20480
v_mul_f32 v39, v81, v39
v_mfma_f32_16x16x32_bf16 v[44:47], a[16:19], a[88:91], v[44:47]
ds_read_b64_tr_b16 a[54:55], v25 offset:22528
v_cvt_pk_bf16_f32 v107, v38, v39
v_mfma_f32_16x16x32_bf16 v[44:47], a[20:23], a[100:103], v[44:47]
ds_read_b64_tr_b16 a[56:57], v25 offset:24576
v_mul_f32 v40, v82, v40
v_mfma_f32_16x16x32_bf16 v[44:47], a[24:27], v[208:211], v[44:47]
ds_read_b64_tr_b16 a[58:59], v25 offset:26624
v_mul_f32 v41, v82, v41
v_mfma_f32_16x16x32_bf16 v[44:47], a[28:31], a[112:115], v[44:47]
s_add_u32 m0, s61, 28672
ds_read_b64_tr_b16 a[60:61], v25 offset:28672
v_cvt_pk_bf16_f32 v110, v40, v41
v_mfma_f32_16x16x32_bf16 v[48:51], a[0:3], v[188:191], 0
s_mov_b32 s62, 131328
ds_read_b64_tr_b16 a[62:63], v25 offset:30720
v_mul_f32 v42, v82, v42
v_mfma_f32_16x16x32_bf16 v[48:51], a[4:7], v[200:203], v[48:51]
ds_write_b64 v10, v[100:101] offset:3072
v_mfma_f32_16x16x32_bf16 v[48:51], a[8:11], a[68:71], v[48:51]
ds_write_b64 v10, v[102:103] offset:3080
v_mfma_f32_16x16x32_bf16 v[48:51], a[12:15], a[80:83], v[48:51]
ds_write_b64 v10, v[104:105] offset:4096
v_mfma_f32_16x16x32_bf16 v[48:51], a[16:19], a[92:95], v[48:51]
ds_write_b64 v10, v[106:107] offset:4104
v_mfma_f32_16x16x32_bf16 v[48:51], a[20:23], a[104:107], v[48:51]
buffer_load_dwordx4 v8, s[16:19], s63 offen nt lds
v_mfma_f32_16x16x32_bf16 v[48:51], a[24:27], v[212:215], v[48:51]
s_add_u32 m0, s61, 65536
ds_write_b64 v10, v[108:109] offset:5120
v_mfma_f32_16x16x32_bf16 v[48:51], a[28:31], a[116:119], v[48:51]
s_mov_b32 s63, 147712
v_mul_f32 v43, v82, v43
v_cvt_pk_bf16_f32 v111, v42, v43
v_mfma_f32_16x16x32_bf16 v[52:55], a[0:3], v[192:195], 0
ds_read_b64_tr_b16 a[0:1], v26 offset:0
v_mfma_f32_16x16x32_bf16 v[52:55], a[4:7], v[204:207], v[52:55]
ds_read_b64_tr_b16 a[2:3], v26 offset:2048
v_mfma_f32_16x16x32_bf16 v[52:55], a[8:11], a[72:75], v[52:55]
ds_read_b64_tr_b16 a[4:5], v26 offset:4096
v_mfma_f32_16x16x32_bf16 v[52:55], a[12:15], a[84:87], v[52:55]
ds_read_b64_tr_b16 a[6:7], v26 offset:6144
v_mfma_f32_16x16x32_bf16 v[52:55], a[16:19], a[96:99], v[52:55]
ds_read_b64_tr_b16 a[8:9], v26 offset:8192
v_mfma_f32_16x16x32_bf16 v[52:55], a[20:23], a[108:111], v[52:55]
ds_read_b64_tr_b16 a[10:11], v26 offset:10240
v_mfma_f32_16x16x32_bf16 v[52:55], a[24:27], v[216:219], v[52:55]
ds_read_b64_tr_b16 a[12:13], v26 offset:12288
v_mfma_f32_16x16x32_bf16 v[52:55], a[28:31], a[120:123], v[52:55]
s_waitcnt lgkmcnt(6)
ds_read_b64_tr_b16 a[14:15], v26 offset:14336
v_mfma_f32_16x16x32_bf16 v[56:59], a[32:35], v[184:187], 0
ds_read_b64_tr_b16 a[16:17], v26 offset:16384
v_mfma_f32_16x16x32_bf16 v[56:59], a[36:39], v[196:199], v[56:59]
ds_read_b64_tr_b16 a[18:19], v26 offset:18432
v_mfma_f32_16x16x32_bf16 v[56:59], a[40:43], a[64:67], v[56:59]
ds_read_b64_tr_b16 a[20:21], v26 offset:20480
v_mfma_f32_16x16x32_bf16 v[56:59], a[44:47], a[76:79], v[56:59]
buffer_load_dwordx4 v8, s[16:19], s62 offen nt lds
v_mfma_f32_16x16x32_bf16 v[56:59], a[48:51], a[88:91], v[56:59]
ds_read_b64_tr_b16 a[22:23], v26 offset:22528
v_mfma_f32_16x16x32_bf16 v[56:59], a[52:55], a[100:103], v[56:59]
ds_read_b64_tr_b16 a[24:25], v26 offset:24576
v_mfma_f32_16x16x32_bf16 v[56:59], a[56:59], v[208:211], v[56:59]
ds_read_b64_tr_b16 a[26:27], v26 offset:26624
v_mfma_f32_16x16x32_bf16 v[56:59], a[60:63], a[112:115], v[56:59]
s_add_u32 m0, s61, 69632
ds_read_b64_tr_b16 a[28:29], v26 offset:28672
v_mfma_f32_16x16x32_bf16 v[60:63], a[32:35], v[188:191], 0
s_mov_b32 s62, 164096
ds_read_b64_tr_b16 a[30:31], v26 offset:30720
v_mfma_f32_16x16x32_bf16 v[60:63], a[36:39], v[200:203], v[60:63]
ds_write_b64 v10, v[110:111] offset:5128
v_mfma_f32_16x16x32_bf16 v[60:63], a[40:43], a[68:71], v[60:63]
v_mfma_f32_16x16x32_bf16 v[60:63], a[44:47], a[80:83], v[60:63]
v_mfma_f32_16x16x32_bf16 v[60:63], a[48:51], a[92:95], v[60:63]
v_mfma_f32_16x16x32_bf16 v[60:63], a[52:55], a[104:107], v[60:63]
v_mfma_f32_16x16x32_bf16 v[60:63], a[56:59], v[212:215], v[60:63]
v_mfma_f32_16x16x32_bf16 v[60:63], a[60:63], a[116:119], v[60:63]
v_mfma_f32_16x16x32_bf16 v[64:67], a[32:35], v[192:195], 0
ds_read_b64_tr_b16 a[32:33], v27 offset:0
v_mfma_f32_16x16x32_bf16 v[64:67], a[36:39], v[204:207], v[64:67]
buffer_load_dwordx4 v8, s[16:19], s63 offen nt lds
v_mfma_f32_16x16x32_bf16 v[64:67], a[40:43], a[72:75], v[64:67]
s_add_u32 m0, s61, 73728
ds_read_b64_tr_b16 a[34:35], v27 offset:2048
v_mfma_f32_16x16x32_bf16 v[64:67], a[44:47], a[84:87], v[64:67]
s_mov_b32 s63, 180480
ds_read_b64_tr_b16 a[36:37], v27 offset:4096
v_mfma_f32_16x16x32_bf16 v[64:67], a[48:51], a[96:99], v[64:67]
ds_read_b64_tr_b16 a[38:39], v27 offset:6144
v_mfma_f32_16x16x32_bf16 v[64:67], a[52:55], a[108:111], v[64:67]
ds_read_b64_tr_b16 a[40:41], v27 offset:8192
v_mfma_f32_16x16x32_bf16 v[64:67], a[56:59], v[216:219], v[64:67]
ds_read_b64_tr_b16 a[42:43], v27 offset:10240
v_mfma_f32_16x16x32_bf16 v[64:67], a[60:63], a[120:123], v[64:67]
s_waitcnt lgkmcnt(5)
ds_read_b64_tr_b16 a[44:45], v27 offset:12288
v_mfma_f32_16x16x32_bf16 v[68:71], a[0:3], v[184:187], 0
ds_read_b64_tr_b16 a[46:47], v27 offset:14336
v_mfma_f32_16x16x32_bf16 v[68:71], a[4:7], v[196:199], v[68:71]
ds_read_b64_tr_b16 a[48:49], v27 offset:16384
v_mfma_f32_16x16x32_bf16 v[68:71], a[8:11], a[64:67], v[68:71]
ds_read_b64_tr_b16 a[50:51], v27 offset:18432
v_mfma_f32_16x16x32_bf16 v[68:71], a[12:15], a[76:79], v[68:71]
ds_read_b64_tr_b16 a[52:53], v27 offset:20480
v_mfma_f32_16x16x32_bf16 v[68:71], a[16:19], a[88:91], v[68:71]
ds_read_b64_tr_b16 a[54:55], v27 offset:22528
v_mfma_f32_16x16x32_bf16 v[68:71], a[20:23], a[100:103], v[68:71]
ds_read_b64_tr_b16 a[56:57], v27 offset:24576
v_mfma_f32_16x16x32_bf16 v[68:71], a[24:27], v[208:211], v[68:71]
ds_read_b64_tr_b16 a[58:59], v27 offset:26624
v_mfma_f32_16x16x32_bf16 v[68:71], a[28:31], a[112:115], v[68:71]
buffer_load_dwordx4 v8, s[16:19], s62 offen nt lds
v_mfma_f32_16x16x32_bf16 v[72:75], a[0:3], v[188:191], 0
s_add_u32 m0, s61, 77824
ds_read_b64_tr_b16 a[60:61], v27 offset:28672
v_mfma_f32_16x16x32_bf16 v[72:75], a[4:7], v[200:203], v[72:75]
s_mov_b32 s62, 196864
ds_read_b64_tr_b16 a[62:63], v27 offset:30720
v_add_u32 v24, 0xffff8000, v24
v_mfma_f32_16x16x32_bf16 v[72:75], a[8:11], a[68:71], v[72:75]
v_add_u32 v25, 0xffff8000, v25
v_add_u32 v26, 0xffff8000, v26
v_mfma_f32_16x16x32_bf16 v[72:75], a[12:15], a[80:83], v[72:75]
v_add_u32 v27, 0xffff8000, v27
v_mfma_f32_16x16x32_bf16 v[72:75], a[16:19], a[92:95], v[72:75]
v_mfma_f32_16x16x32_bf16 v[72:75], a[20:23], a[104:107], v[72:75]
v_mfma_f32_16x16x32_bf16 v[72:75], a[24:27], v[212:215], v[72:75]
v_mfma_f32_16x16x32_bf16 v[72:75], a[28:31], a[116:119], v[72:75]
s_waitcnt vmcnt(11) lgkmcnt(0)
s_barrier
ds_read2_b32 v[84:85], v3 offset0:0 offset1:4
v_mfma_f32_16x16x32_bf16 v[76:79], a[0:3], v[192:195], 0
ds_read_b64_tr_b16 a[0:1], v24 offset:0
v_mfma_f32_16x16x32_bf16 v[76:79], a[4:7], v[204:207], v[76:79]
ds_read_b64_tr_b16 a[2:3], v24 offset:2048
v_mfma_f32_16x16x32_bf16 v[76:79], a[8:11], a[72:75], v[76:79]
ds_read2_b32 v[86:87], v3 offset0:8 offset1:12
v_mfma_f32_16x16x32_bf16 v[76:79], a[12:15], a[84:87], v[76:79]
ds_read_b64 v[14:15], v3 offset:8
v_mfma_f32_16x16x32_bf16 v[76:79], a[16:19], a[96:99], v[76:79]
ds_read_b64_tr_b16 a[4:5], v24 offset:4096
v_mfma_f32_16x16x32_bf16 v[76:79], a[20:23], a[108:111], v[76:79]
ds_read_b64_tr_b16 a[6:7], v24 offset:6144
v_mfma_f32_16x16x32_bf16 v[76:79], a[24:27], v[216:219], v[76:79]
buffer_load_dwordx4 v8, s[16:19], s63 offen nt lds
v_mfma_f32_16x16x32_bf16 v[76:79], a[28:31], a[120:123], v[76:79]
ds_read_b64_tr_b16 a[8:9], v24 offset:8192
v_mfma_f32_16x16x32_bf16 v[32:35], a[32:35], v[184:187], 0
ds_read_b64_tr_b16 a[10:11], v24 offset:10240
v_mfma_f32_16x16x32_bf16 v[32:35], a[36:39], v[196:199], v[32:35]
ds_read_b64_tr_b16 a[12:13], v24 offset:12288
v_mfma_f32_16x16x32_bf16 v[32:35], a[40:43], a[64:67], v[32:35]
ds_read_b64_tr_b16 a[14:15], v24 offset:14336
v_mfma_f32_16x16x32_bf16 v[32:35], a[44:47], a[76:79], v[32:35]
ds_read_b64_tr_b16 a[16:17], v24 offset:16384
s_waitcnt lgkmcnt(8)
v_or3_b32 v84, v84, v85, v86
v_mfma_f32_16x16x32_bf16 v[32:35], a[48:51], a[88:91], v[32:35]
ds_read_b64_tr_b16 a[18:19], v24 offset:18432
v_or_b32 v84, v84, v87
v_mfma_f32_16x16x32_bf16 v[32:35], a[52:55], a[100:103], v[32:35]
ds_read_b64_tr_b16 a[20:21], v24 offset:20480
v_cmp_ne_u32 vcc, 0, v84
v_mfma_f32_16x16x32_bf16 v[32:35], a[56:59], v[208:211], v[32:35]
ds_read_b64_tr_b16 a[22:23], v24 offset:22528
v_mfma_f32_16x16x32_bf16 v[32:35], a[60:63], a[112:115], v[32:35]
s_add_u32 m0, s61, 81920
ds_read_b64_tr_b16 a[24:25], v24 offset:24576
v_mfma_f32_16x16x32_bf16 v[36:39], a[32:35], v[188:191], 0
s_mov_b32 s63, 213248
ds_read_b64_tr_b16 a[26:27], v24 offset:26624
v_mfma_f32_16x16x32_bf16 v[36:39], a[36:39], v[200:203], v[36:39]
ds_read_b64_tr_b16 a[28:29], v24 offset:28672
v_mfma_f32_16x16x32_bf16 v[36:39], a[40:43], a[68:71], v[36:39]
s_cbranch_vccnz L_restart
ds_read_b64_tr_b16 a[30:31], v24 offset:30720
v_mfma_f32_16x16x32_bf16 v[36:39], a[44:47], a[80:83], v[36:39]
ds_read_b128 a[184:187], v11 offset:0
v_mfma_f32_16x16x32_bf16 v[36:39], a[48:51], a[92:95], v[36:39]
buffer_load_dwordx4 v8, s[16:19], s62 offen nt lds
v_mfma_f32_16x16x32_bf16 v[36:39], a[52:55], a[104:107], v[36:39]
s_add_u32 m0, s61, 86016
ds_read_b128 a[188:191], v11 offset:1024
v_mfma_f32_16x16x32_bf16 v[36:39], a[56:59], v[212:215], v[36:39]
s_mov_b32 s62, 229632
ds_read_b128 a[192:195], v11 offset:2048
v_mfma_f32_16x16x32_bf16 v[36:39], a[60:63], a[116:119], v[36:39]
ds_read_b128 a[196:199], v11 offset:3072
v_mfma_f32_16x16x32_bf16 v[40:43], a[32:35], v[192:195], 0
ds_read_b64_tr_b16 a[32:33], v25 offset:0
v_mfma_f32_16x16x32_bf16 v[40:43], a[36:39], v[204:207], v[40:43]
ds_read_b64_tr_b16 a[34:35], v25 offset:2048
v_mfma_f32_16x16x32_bf16 v[40:43], a[40:43], a[72:75], v[40:43]
ds_read_b64_tr_b16 a[36:37], v25 offset:4096
v_mfma_f32_16x16x32_bf16 v[40:43], a[44:47], a[84:87], v[40:43]
ds_read_b64_tr_b16 a[38:39], v25 offset:6144
v_mfma_f32_16x16x32_bf16 v[40:43], a[48:51], a[96:99], v[40:43]
ds_read_b64_tr_b16 a[40:41], v25 offset:8192
v_mfma_f32_16x16x32_bf16 v[40:43], a[52:55], a[108:111], v[40:43]
ds_read_b64_tr_b16 a[42:43], v25 offset:10240
v_mfma_f32_16x16x32_bf16 v[40:43], a[56:59], v[216:219], v[40:43]
ds_read_b64_tr_b16 a[44:45], v25 offset:12288
v_mfma_f32_16x16x32_bf16 v[40:43], a[60:63], a[120:123], v[40:43]
ds_read_b64_tr_b16 a[46:47], v25 offset:14336
v_mfma_f32_16x16x32_bf16 v[44:47], a[0:3], a[124:127], v[44:47]
s_waitcnt lgkmcnt(6)
ds_read_b64_tr_b16 a[48:49], v25 offset:16384
v_mfma_f32_16x16x32_bf16 v[44:47], a[4:7], a[136:139], v[44:47]
ds_read_b64_tr_b16 a[50:51], v25 offset:18432
v_mfma_f32_16x16x32_bf16 v[44:47], a[8:11], a[148:151], v[44:47]
buffer_load_dwordx4 v8, s[16:19], s63 offen nt lds
v_mfma_f32_16x16x32_bf16 v[44:47], a[12:15], v[220:223], v[44:47]
ds_read_b64_tr_b16 a[52:53], v25 offset:20480
v_mfma_f32_16x16x32_bf16 v[44:47], a[16:19], a[160:163], v[44:47]
ds_read_b64_tr_b16 a[54:55], v25 offset:22528
v_mfma_f32_16x16x32_bf16 v[44:47], a[20:23], a[172:175], v[44:47]
ds_read_b64_tr_b16 a[56:57], v25 offset:24576
v_mfma_f32_16x16x32_bf16 v[44:47], a[24:27], v[232:235], v[44:47]
ds_read_b64_tr_b16 a[58:59], v25 offset:26624
v_mfma_f32_16x16x32_bf16 v[44:47], a[28:31], v[244:247], v[44:47]
s_add_u32 m0, s61, 90112
ds_read_b64_tr_b16 a[60:61], v25 offset:28672
v_mfma_f32_16x16x32_bf16 v[48:51], a[0:3], a[128:131], v[48:51]
s_mov_b32 s63, 246016
ds_read_b64_tr_b16 a[62:63], v25 offset:30720
v_mfma_f32_16x16x32_bf16 v[48:51], a[4:7], a[140:143], v[48:51]
ds_read_b128 a[200:203], v11 offset:4096
v_mfma_f32_16x16x32_bf16 v[48:51], a[8:11], a[152:155], v[48:51]
ds_read_b128 a[204:207], v11 offset:5120
v_mul_f32 v44, v80, v44
v_mfma_f32_16x16x32_bf16 v[48:51], a[12:15], v[224:227], v[48:51]
v_mul_f32 v45, v80, v45
v_cvt_pk_bf16_f32 v112, v44, v45
v_mfma_f32_16x16x32_bf16 v[48:51], a[16:19], a[164:167], v[48:51]
v_mul_f32 v46, v80, v46
v_mul_f32 v47, v80, v47
v_mfma_f32_16x16x32_bf16 v[48:51], a[20:23], a[176:179], v[48:51]
v_cvt_pk_bf16_f32 v113, v46, v47
v_mfma_f32_16x16x32_bf16 v[48:51], a[24:27], v[236:239], v[48:51]
v_mfma_f32_16x16x32_bf16 v[48:51], a[28:31], v[248:251], v[48:51]
v_mfma_f32_16x16x32_bf16 v[52:55], a[0:3], a[132:135], v[52:55]
buffer_load_dwordx4 v8, s[16:19], s62 offen nt lds
v_mfma_f32_16x16x32_bf16 v[52:55], a[4:7], a[144:147], v[52:55]
s_add_u32 m0, s61, 94208
ds_read_b64_tr_b16 a[0:1], v26 offset:0
v_mfma_f32_16x16x32_bf16 v[52:55], a[8:11], a[156:159], v[52:55]
s_mov_b32 s62, 384
ds_read_b64_tr_b16 a[2:3], v26 offset:2048
v_mul_f32 v48, v81, v48
v_mfma_f32_16x16x32_bf16 v[52:55], a[12:15], v[228:231], v[52:55]
ds_read_b64_tr_b16 a[4:5], v26 offset:4096
v_mul_f32 v49, v81, v49
v_mfma_f32_16x16x32_bf16 v[52:55], a[16:19], a[168:171], v[52:55]
ds_read_b64_tr_b16 a[6:7], v26 offset:6144
v_cvt_pk_bf16_f32 v116, v48, v49
v_mfma_f32_16x16x32_bf16 v[52:55], a[20:23], a[180:183], v[52:55]
ds_read_b64_tr_b16 a[8:9], v26 offset:8192
v_mul_f32 v50, v81, v50
v_mfma_f32_16x16x32_bf16 v[52:55], a[24:27], v[240:243], v[52:55]
ds_read_b64_tr_b16 a[10:11], v26 offset:10240
v_mul_f32 v51, v81, v51
v_mfma_f32_16x16x32_bf16 v[52:55], a[28:31], v[252:255], v[52:55]
ds_read_b64_tr_b16 a[12:13], v26 offset:12288
v_cvt_pk_bf16_f32 v117, v50, v51
v_mfma_f32_16x16x32_bf16 v[56:59], a[32:35], a[124:127], v[56:59]
s_waitcnt lgkmcnt(6)
ds_read_b64_tr_b16 a[14:15], v26 offset:14336
v_mfma_f32_16x16x32_bf16 v[56:59], a[36:39], a[136:139], v[56:59]
ds_read_b64_tr_b16 a[16:17], v26 offset:16384
v_mfma_f32_16x16x32_bf16 v[56:59], a[40:43], a[148:151], v[56:59]
ds_read_b64_tr_b16 a[18:19], v26 offset:18432
v_mul_f32 v52, v82, v52
v_mfma_f32_16x16x32_bf16 v[56:59], a[44:47], v[220:223], v[56:59]
ds_read_b64_tr_b16 a[20:21], v26 offset:20480
v_mul_f32 v53, v82, v53
v_mfma_f32_16x16x32_bf16 v[56:59], a[48:51], a[160:163], v[56:59]
ds_read_b64_tr_b16 a[22:23], v26 offset:22528
v_cvt_pk_bf16_f32 v120, v52, v53
v_mfma_f32_16x16x32_bf16 v[56:59], a[52:55], a[172:175], v[56:59]
ds_read_b64_tr_b16 a[24:25], v26 offset:24576
v_mul_f32 v54, v82, v54
v_mfma_f32_16x16x32_bf16 v[56:59], a[56:59], v[232:235], v[56:59]
ds_read_b64_tr_b16 a[26:27], v26 offset:26624
v_mul_f32 v55, v82, v55
v_mfma_f32_16x16x32_bf16 v[56:59], a[60:63], v[244:247], v[56:59]
buffer_load_dwordx4 v8, s[16:19], s63 offen nt lds
v_mfma_f32_16x16x32_bf16 v[60:63], a[32:35], a[128:131], v[60:63]
s_add_u32 m0, s61, 131072
ds_read_b64_tr_b16 a[28:29], v26 offset:28672
v_cvt_pk_bf16_f32 v121, v54, v55
v_mfma_f32_16x16x32_bf16 v[60:63], a[36:39], a[140:143], v[60:63]
s_mov_b32 s63, 16768
ds_read_b64_tr_b16 a[30:31], v26 offset:30720
v_mfma_f32_16x16x32_bf16 v[60:63], a[40:43], a[152:155], v[60:63]
v_mul_f32 v56, v80, v56
v_mul_f32 v57, v80, v57
v_mfma_f32_16x16x32_bf16 v[60:63], a[44:47], v[224:227], v[60:63]
v_cvt_pk_bf16_f32 v114, v56, v57
v_mul_f32 v58, v80, v58
v_mfma_f32_16x16x32_bf16 v[60:63], a[48:51], a[164:167], v[60:63]
v_mul_f32 v59, v80, v59
v_cvt_pk_bf16_f32 v115, v58, v59
v_mfma_f32_16x16x32_bf16 v[60:63], a[52:55], a[176:179], v[60:63]
v_mfma_f32_16x16x32_bf16 v[60:63], a[56:59], v[236:239], v[60:63]
v_mfma_f32_16x16x32_bf16 v[60:63], a[60:63], v[248:251], v[60:63]
v_mfma_f32_16x16x32_bf16 v[64:67], a[32:35], a[132:135], v[64:67]
ds_read_b64_tr_b16 a[32:33], v27 offset:0
v_mfma_f32_16x16x32_bf16 v[64:67], a[36:39], a[144:147], v[64:67]
ds_read_b64_tr_b16 a[34:35], v27 offset:2048
v_mfma_f32_16x16x32_bf16 v[64:67], a[40:43], a[156:159], v[64:67]
ds_read_b64_tr_b16 a[36:37], v27 offset:4096
v_mul_f32 v60, v81, v60
v_mfma_f32_16x16x32_bf16 v[64:67], a[44:47], v[228:231], v[64:67]
ds_read_b64_tr_b16 a[38:39], v27 offset:6144
v_mul_f32 v61, v81, v61
v_mfma_f32_16x16x32_bf16 v[64:67], a[48:51], a[168:171], v[64:67]
ds_read_b64_tr_b16 a[40:41], v27 offset:8192
v_cvt_pk_bf16_f32 v118, v60, v61
v_mfma_f32_16x16x32_bf16 v[64:67], a[52:55], a[180:183], v[64:67]
buffer_load_dwordx4 v8, s[16:19], s62 offen nt lds
v_mfma_f32_16x16x32_bf16 v[64:67], a[56:59], v[240:243], v[64:67]
s_add_u32 m0, s61, 135168
ds_read_b64_tr_b16 a[42:43], v27 offset:10240
v_mul_f32 v62, v81, v62
v_mfma_f32_16x16x32_bf16 v[64:67], a[60:63], v[252:255], v[64:67]
s_waitcnt lgkmcnt(5)
ds_read_b64_tr_b16 a[44:45], v27 offset:12288
v_mul_f32 v63, v81, v63
v_mfma_f32_16x16x32_bf16 v[68:71], a[0:3], a[124:127], v[68:71]
ds_read_b64_tr_b16 a[46:47], v27 offset:14336
v_cvt_pk_bf16_f32 v119, v62, v63
v_mfma_f32_16x16x32_bf16 v[68:71], a[4:7], a[136:139], v[68:71]
ds_read_b64_tr_b16 a[48:49], v27 offset:16384
v_mfma_f32_16x16x32_bf16 v[68:71], a[8:11], a[148:151], v[68:71]
ds_read_b64_tr_b16 a[50:51], v27 offset:18432
v_mul_f32 v64, v82, v64
v_mfma_f32_16x16x32_bf16 v[68:71], a[12:15], v[220:223], v[68:71]
ds_read_b64_tr_b16 a[52:53], v27 offset:20480
v_mul_f32 v65, v82, v65
v_mfma_f32_16x16x32_bf16 v[68:71], a[16:19], a[160:163], v[68:71]
ds_read_b64_tr_b16 a[54:55], v27 offset:22528
v_cvt_pk_bf16_f32 v122, v64, v65
v_mfma_f32_16x16x32_bf16 v[68:71], a[20:23], a[172:175], v[68:71]
ds_read_b64_tr_b16 a[56:57], v27 offset:24576
v_mul_f32 v66, v82, v66
v_mfma_f32_16x16x32_bf16 v[68:71], a[24:27], v[232:235], v[68:71]
ds_read_b64_tr_b16 a[58:59], v27 offset:26624
v_mul_f32 v67, v82, v67
v_mfma_f32_16x16x32_bf16 v[68:71], a[28:31], v[244:247], v[68:71]
s_mov_b32 s62, 33152
ds_read_b64_tr_b16 a[60:61], v27 offset:28672
v_cvt_pk_bf16_f32 v123, v66, v67
v_mfma_f32_16x16x32_bf16 v[72:75], a[0:3], a[128:131], v[72:75]
ds_read_b64_tr_b16 a[62:63], v27 offset:30720
v_add_u32 v24, 0xfffe8000, v24
v_mfma_f32_16x16x32_bf16 v[72:75], a[4:7], a[140:143], v[72:75]
v_add_u32 v25, 0xfffe8000, v25
v_add_u32 v26, 0xfffe8000, v26
v_mfma_f32_16x16x32_bf16 v[72:75], a[8:11], a[152:155], v[72:75]
v_add_u32 v27, 0xfffe8000, v27
v_mul_f32 v68, v80, v68
v_mfma_f32_16x16x32_bf16 v[72:75], a[12:15], v[224:227], v[72:75]
buffer_load_dwordx4 v8, s[16:19], s63 offen nt lds
v_mfma_f32_16x16x32_bf16 v[72:75], a[16:19], a[164:167], v[72:75]
s_add_u32 m0, s61, 139264
v_mul_f32 v69, v80, v69
v_cvt_pk_bf16_f32 v124, v68, v69
v_mfma_f32_16x16x32_bf16 v[72:75], a[20:23], a[176:179], v[72:75]
s_mov_b32 s63, 49536
v_mul_f32 v70, v80, v70
v_mul_f32 v71, v80, v71
v_mfma_f32_16x16x32_bf16 v[72:75], a[24:27], v[236:239], v[72:75]
s_waitcnt vmcnt(10) lgkmcnt(0)
s_barrier
v_cvt_pk_bf16_f32 v125, v70, v71
v_mfma_f32_16x16x32_bf16 v[72:75], a[28:31], v[248:251], v[72:75]
ds_write_b64 v10, v[112:113] offset:0
v_mfma_f32_16x16x32_bf16 v[76:79], a[0:3], a[132:135], v[76:79]
ds_read_b64_tr_b16 a[0:1], v24 offset:0
v_mfma_f32_16x16x32_bf16 v[76:79], a[4:7], a[144:147], v[76:79]
ds_read_b64_tr_b16 a[2:3], v24 offset:2048
v_mfma_f32_16x16x32_bf16 v[76:79], a[8:11], a[156:159], v[76:79]
ds_read_b64_tr_b16 a[4:5], v24 offset:4096
v_mul_f32 v72, v81, v72
v_mfma_f32_16x16x32_bf16 v[76:79], a[12:15], v[228:231], v[76:79]
ds_read_b64_tr_b16 a[6:7], v24 offset:6144
v_mul_f32 v73, v81, v73
v_mfma_f32_16x16x32_bf16 v[76:79], a[16:19], a[168:171], v[76:79]
ds_read_b64_tr_b16 a[8:9], v24 offset:8192
v_cvt_pk_bf16_f32 v128, v72, v73
v_mfma_f32_16x16x32_bf16 v[76:79], a[20:23], a[180:183], v[76:79]
ds_read_b64_tr_b16 a[10:11], v24 offset:10240
v_mul_f32 v74, v81, v74
v_mfma_f32_16x16x32_bf16 v[76:79], a[24:27], v[240:243], v[76:79]
ds_read_b64_tr_b16 a[12:13], v24 offset:12288
v_mul_f32 v75, v81, v75
v_mfma_f32_16x16x32_bf16 v[76:79], a[28:31], v[252:255], v[76:79]
ds_read_b64_tr_b16 a[14:15], v24 offset:14336
v_cvt_pk_bf16_f32 v129, v74, v75
v_mfma_f32_16x16x32_bf16 v[32:35], a[32:35], a[124:127], v[32:35]
ds_read_b64_tr_b16 a[16:17], v24 offset:16384
v_mfma_f32_16x16x32_bf16 v[32:35], a[36:39], a[136:139], v[32:35]
buffer_load_dwordx4 v8, s[16:19], s62 offen nt lds
v_mfma_f32_16x16x32_bf16 v[32:35], a[40:43], a[148:151], v[32:35]
ds_read_b64_tr_b16 a[18:19], v24 offset:18432
v_mul_f32 v76, v82, v76
v_mfma_f32_16x16x32_bf16 v[32:35], a[44:47], v[220:223], v[32:35]
ds_read_b64_tr_b16 a[20:21], v24 offset:20480
v_mul_f32 v77, v82, v77
v_mfma_f32_16x16x32_bf16 v[32:35], a[48:51], a[160:163], v[32:35]
ds_read_b64_tr_b16 a[22:23], v24 offset:22528
v_cvt_pk_bf16_f32 v132, v76, v77
v_mfma_f32_16x16x32_bf16 v[32:35], a[52:55], a[172:175], v[32:35]
ds_read_b64_tr_b16 a[24:25], v24 offset:24576
v_mul_f32 v78, v82, v78
v_mfma_f32_16x16x32_bf16 v[32:35], a[56:59], v[232:235], v[32:35]
ds_read_b64_tr_b16 a[26:27], v24 offset:26624
v_mul_f32 v79, v82, v79
v_mfma_f32_16x16x32_bf16 v[32:35], a[60:63], v[244:247], v[32:35]
s_add_u32 m0, s61, 143360
ds_read_b64_tr_b16 a[28:29], v24 offset:28672
v_cvt_pk_bf16_f32 v133, v78, v79
v_mfma_f32_16x16x32_bf16 v[36:39], a[32:35], a[128:131], v[36:39]
s_mov_b32 s62, 65920
ds_read_b64_tr_b16 a[30:31], v24 offset:30720
v_mfma_f32_16x16x32_bf16 v[36:39], a[36:39], a[140:143], v[36:39]
ds_write_b64 v10, v[114:115] offset:8
v_mfma_f32_16x16x32_bf16 v[36:39], a[40:43], a[152:155], v[36:39]
ds_write_b64 v10, v[116:117] offset:1024
v_mfma_f32_16x16x32_bf16 v[36:39], a[44:47], v[224:227], v[36:39]
ds_write_b64 v10, v[118:119] offset:1032
v_mfma_f32_16x16x32_bf16 v[36:39], a[48:51], a[164:167], v[36:39]
ds_write_b64 v10, v[120:121] offset:2048
v_mfma_f32_16x16x32_bf16 v[36:39], a[52:55], a[176:179], v[36:39]
ds_write_b64 v10, v[122:123] offset:2056
v_mfma_f32_16x16x32_bf16 v[36:39], a[56:59], v[236:239], v[36:39]
ds_write_b64 v10, v[124:125] offset:3072
v_mfma_f32_16x16x32_bf16 v[36:39], a[60:63], v[248:251], v[36:39]
ds_write_b64 v10, v[128:129] offset:4096
v_mfma_f32_16x16x32_bf16 v[40:43], a[32:35], a[132:135], v[40:43]
buffer_load_dwordx4 v8, s[16:19], s63 offen nt lds
v_mfma_f32_16x16x32_bf16 v[40:43], a[36:39], a[144:147], v[40:43]
s_add_u32 m0, s61, 147456
ds_read_b64_tr_b16 a[32:33], v25 offset:0
v_mul_f32 v32, v80, v32
v_mfma_f32_16x16x32_bf16 v[40:43], a[40:43], a[156:159], v[40:43]
s_mov_b32 s63, 82304
ds_read_b64_tr_b16 a[34:35], v25 offset:2048
v_mul_f32 v33, v80, v33
v_mfma_f32_16x16x32_bf16 v[40:43], a[44:47], v[228:231], v[40:43]
ds_read_b64_tr_b16 a[36:37], v25 offset:4096
v_cvt_pk_bf16_f32 v126, v32, v33
v_mfma_f32_16x16x32_bf16 v[40:43], a[48:51], a[168:171], v[40:43]
ds_read_b64_tr_b16 a[38:39], v25 offset:6144
v_mul_f32 v34, v80, v34
v_mfma_f32_16x16x32_bf16 v[40:43], a[52:55], a[180:183], v[40:43]
ds_read_b64_tr_b16 a[40:41], v25 offset:8192
v_mul_f32 v35, v80, v35
v_mfma_f32_16x16x32_bf16 v[40:43], a[56:59], v[240:243], v[40:43]
ds_read_b64_tr_b16 a[42:43], v25 offset:10240
v_cvt_pk_bf16_f32 v127, v34, v35
v_mfma_f32_16x16x32_bf16 v[40:43], a[60:63], v[252:255], v[40:43]
s_waitcnt lgkmcnt(6)
ds_read_b64_tr_b16 a[44:45], v25 offset:12288
v_mul_f32 v36, v81, v36
v_mfma_f32_16x16x32_bf16 v[44:47], a[0:3], v[184:187], 0
ds_read_b64_tr_b16 a[46:47], v25 offset:14336
v_mul_f32 v37, v81, v37
v_mfma_f32_16x16x32_bf16 v[44:47], a[4:7], v[196:199], v[44:47]
ds_read_b64_tr_b16 a[48:49], v25 offset:16384
v_cvt_pk_bf16_f32 v130, v36, v37
v_mfma_f32_16x16x32_bf16 v[44:47], a[8:11], a[64:67], v[44:47]
ds_read_b64_tr_b16 a[50:51], v25 offset:18432
v_mul_f32 v38, v81, v38
v_mfma_f32_16x16x32_bf16 v[44:47], a[12:15], a[76:79], v[44:47]
ds_read_b64_tr_b16 a[52:53], v25 offset:20480
v_mul_f32 v39, v81, v39
v_mfma_f32_16x16x32_bf16 v[44:47], a[16:19], a[88:91], v[44:47]
ds_read_b64_tr_b16 a[54:55], v25 offset:22528
v_cvt_pk_bf16_f32 v131, v38, v39
v_mfma_f32_16x16x32_bf16 v[44:47], a[20:23], a[100:103], v[44:47]
ds_read_b64_tr_b16 a[56:57], v25 offset:24576
v_mul_f32 v40, v82, v40
v_mfma_f32_16x16x32_bf16 v[44:47], a[24:27], v[208:211], v[44:47]
buffer_load_dwordx4 v8, s[16:19], s62 offen nt lds
v_mfma_f32_16x16x32_bf16 v[44:47], a[28:31], a[112:115], v[44:47]
s_add_u32 m0, s61, 151552
ds_read_b64_tr_b16 a[58:59], v25 offset:26624
v_mul_f32 v41, v82, v41
v_mfma_f32_16x16x32_bf16 v[48:51], a[0:3], v[188:191], 0
s_mov_b32 s62, 98688
ds_read_b64_tr_b16 a[60:61], v25 offset:28672
v_cvt_pk_bf16_f32 v134, v40, v41
v_mfma_f32_16x16x32_bf16 v[48:51], a[4:7], v[200:203], v[48:51]
ds_read_b64_tr_b16 a[62:63], v25 offset:30720
v_mul_f32 v42, v82, v42
v_mfma_f32_16x16x32_bf16 v[48:51], a[8:11], a[68:71], v[48:51]
ds_write_b64 v10, v[126:127] offset:3080
v_mfma_f32_16x16x32_bf16 v[48:51], a[12:15], a[80:83], v[48:51]
ds_write_b64 v10, v[130:131] offset:4104
v_mfma_f32_16x16x32_bf16 v[48:51], a[16:19], a[92:95], v[48:51]
ds_write_b64 v10, v[132:133] offset:5120
v_mfma_f32_16x16x32_bf16 v[48:51], a[20:23], a[104:107], v[48:51]
v_mul_f32 v43, v82, v43
v_cvt_pk_bf16_f32 v135, v42, v43
v_mfma_f32_16x16x32_bf16 v[48:51], a[24:27], v[212:215], v[48:51]
ds_write_b64 v10, v[134:135] offset:5128
v_mfma_f32_16x16x32_bf16 v[48:51], a[28:31], a[116:119], v[48:51]
v_mfma_f32_16x16x32_bf16 v[52:55], a[0:3], v[192:195], 0
ds_read_b64_tr_b16 a[0:1], v26 offset:0
v_mfma_f32_16x16x32_bf16 v[52:55], a[4:7], v[204:207], v[52:55]
ds_read_b64_tr_b16 a[2:3], v26 offset:2048
v_mfma_f32_16x16x32_bf16 v[52:55], a[8:11], a[72:75], v[52:55]
ds_read_b64_tr_b16 a[4:5], v26 offset:4096
v_mfma_f32_16x16x32_bf16 v[52:55], a[12:15], a[84:87], v[52:55]
ds_read_b64_tr_b16 a[6:7], v26 offset:6144
v_mfma_f32_16x16x32_bf16 v[52:55], a[16:19], a[96:99], v[52:55]
buffer_load_dwordx4 v8, s[16:19], s63 offen nt lds
v_mfma_f32_16x16x32_bf16 v[52:55], a[20:23], a[108:111], v[52:55]
s_add_u32 m0, s61, 155648
ds_read_b64_tr_b16 a[8:9], v26 offset:8192
v_mfma_f32_16x16x32_bf16 v[52:55], a[24:27], v[216:219], v[52:55]
s_mov_b32 s63, 115072
ds_read_b64_tr_b16 a[10:11], v26 offset:10240
v_mfma_f32_16x16x32_bf16 v[52:55], a[28:31], a[120:123], v[52:55]
s_waitcnt lgkmcnt(5)
ds_read_b64_tr_b16 a[12:13], v26 offset:12288
v_mfma_f32_16x16x32_bf16 v[56:59], a[32:35], v[184:187], 0
ds_read_b64_tr_b16 a[14:15], v26 offset:14336
v_mfma_f32_16x16x32_bf16 v[56:59], a[36:39], v[196:199], v[56:59]
ds_read_b64_tr_b16 a[16:17], v26 offset:16384
v_mfma_f32_16x16x32_bf16 v[56:59], a[40:43], a[64:67], v[56:59]
ds_read_b64_tr_b16 a[18:19], v26 offset:18432
v_mfma_f32_16x16x32_bf16 v[56:59], a[44:47], a[76:79], v[56:59]
ds_read_b64_tr_b16 a[20:21], v26 offset:20480
v_mfma_f32_16x16x32_bf16 v[56:59], a[48:51], a[88:91], v[56:59]
ds_read_b64_tr_b16 a[22:23], v26 offset:22528
v_mfma_f32_16x16x32_bf16 v[56:59], a[52:55], a[100:103], v[56:59]
ds_read_b64_tr_b16 a[24:25], v26 offset:24576
v_mfma_f32_16x16x32_bf16 v[56:59], a[56:59], v[208:211], v[56:59]
ds_read_b64_tr_b16 a[26:27], v26 offset:26624
v_mfma_f32_16x16x32_bf16 v[56:59], a[60:63], a[112:115], v[56:59]
ds_read_b64_tr_b16 a[28:29], v26 offset:28672
v_mfma_f32_16x16x32_bf16 v[60:63], a[32:35], v[188:191], 0
ds_read_b64_tr_b16 a[30:31], v26 offset:30720
v_mfma_f32_16x16x32_bf16 v[60:63], a[36:39], v[200:203], v[60:63]
v_mfma_f32_16x16x32_bf16 v[60:63], a[40:43], a[68:71], v[60:63]
buffer_load_dwordx4 v8, s[16:19], s62 offen nt lds
v_mfma_f32_16x16x32_bf16 v[60:63], a[44:47], a[80:83], v[60:63]
s_add_u32 m0, s61, 159744
v_mfma_f32_16x16x32_bf16 v[60:63], a[48:51], a[92:95], v[60:63]
s_mov_b32 s62, 131456
v_mfma_f32_16x16x32_bf16 v[60:63], a[52:55], a[104:107], v[60:63]
v_mfma_f32_16x16x32_bf16 v[60:63], a[56:59], v[212:215], v[60:63]
v_mfma_f32_16x16x32_bf16 v[60:63], a[60:63], a[116:119], v[60:63]
v_mfma_f32_16x16x32_bf16 v[64:67], a[32:35], v[192:195], 0
ds_read_b64_tr_b16 a[32:33], v27 offset:0
v_mfma_f32_16x16x32_bf16 v[64:67], a[36:39], v[204:207], v[64:67]
ds_read_b64_tr_b16 a[34:35], v27 offset:2048
v_mfma_f32_16x16x32_bf16 v[64:67], a[40:43], a[72:75], v[64:67]
ds_read_b64_tr_b16 a[36:37], v27 offset:4096
v_mfma_f32_16x16x32_bf16 v[64:67], a[44:47], a[84:87], v[64:67]
ds_read_b64_tr_b16 a[38:39], v27 offset:6144
v_mfma_f32_16x16x32_bf16 v[64:67], a[48:51], a[96:99], v[64:67]
ds_read_b64_tr_b16 a[40:41], v27 offset:8192
v_mfma_f32_16x16x32_bf16 v[64:67], a[52:55], a[108:111], v[64:67]
ds_read_b64_tr_b16 a[42:43], v27 offset:10240
v_mfma_f32_16x16x32_bf16 v[64:67], a[56:59], v[216:219], v[64:67]
ds_read_b64_tr_b16 a[44:45], v27 offset:12288
v_mfma_f32_16x16x32_bf16 v[64:67], a[60:63], a[120:123], v[64:67]
s_waitcnt lgkmcnt(6)
ds_read_b64_tr_b16 a[46:47], v27 offset:14336
v_mfma_f32_16x16x32_bf16 v[68:71], a[0:3], v[184:187], 0
ds_read_b64_tr_b16 a[48:49], v27 offset:16384
v_mfma_f32_16x16x32_bf16 v[68:71], a[4:7], v[196:199], v[68:71]
buffer_load_dwordx4 v8, s[16:19], s63 offen nt lds
v_mfma_f32_16x16x32_bf16 v[68:71], a[8:11], a[64:67], v[68:71]
ds_read_b64_tr_b16 a[50:51], v27 offset:18432
v_mfma_f32_16x16x32_bf16 v[68:71], a[12:15], a[76:79], v[68:71]
ds_read_b64_tr_b16 a[52:53], v27 offset:20480
v_mfma_f32_16x16x32_bf16 v[68:71], a[16:19], a[88:91], v[68:71]
ds_read_b64_tr_b16 a[54:55], v27 offset:22528
v_mfma_f32_16x16x32_bf16 v[68:71], a[20:23], a[100:103], v[68:71]
ds_read_b64_tr_b16 a[56:57], v27 offset:24576
v_mfma_f32_16x16x32_bf16 v[68:71], a[24:27], v[208:211], v[68:71]
ds_read_b64_tr_b16 a[58:59], v27 offset:26624
v_mfma_f32_16x16x32_bf16 v[68:71], a[28:31], a[112:115], v[68:71]
s_add_u32 m0, s61, 98304
ds_read_b64_tr_b16 a[60:61], v27 offset:28672
v_mfma_f32_16x16x32_bf16 v[72:75], a[0:3], v[188:191], 0
s_mov_b32 s63, 147840
ds_read_b64_tr_b16 a[62:63], v27 offset:30720
v_add_u32 v24, 0x10000, v24
v_mfma_f32_16x16x32_bf16 v[72:75], a[4:7], v[200:203], v[72:75]
v_add_u32 v25, 0x10000, v25
v_add_u32 v26, 0x10000, v26
v_mfma_f32_16x16x32_bf16 v[72:75], a[8:11], a[68:71], v[72:75]
v_add_u32 v27, 0x10000, v27
v_mfma_f32_16x16x32_bf16 v[72:75], a[12:15], a[80:83], v[72:75]
v_mfma_f32_16x16x32_bf16 v[72:75], a[16:19], a[92:95], v[72:75]
v_mfma_f32_16x16x32_bf16 v[72:75], a[20:23], a[104:107], v[72:75]
v_mfma_f32_16x16x32_bf16 v[72:75], a[24:27], v[212:215], v[72:75]
s_waitcnt vmcnt(8) lgkmcnt(0)
s_barrier
ds_read_b128 a[208:211], v11 offset:0
v_mfma_f32_16x16x32_bf16 v[72:75], a[28:31], a[116:119], v[72:75]
buffer_load_dwordx4 v8, s[16:19], s62 offen nt lds
v_mfma_f32_16x16x32_bf16 v[76:79], a[0:3], v[192:195], 0
s_add_u32 m0, s61, 102400
ds_read_b64_tr_b16 a[0:1], v24 offset:0
v_mfma_f32_16x16x32_bf16 v[76:79], a[4:7], v[204:207], v[76:79]
s_mov_b32 s62, 164224
ds_read_b64_tr_b16 a[2:3], v24 offset:2048
v_mfma_f32_16x16x32_bf16 v[76:79], a[8:11], a[72:75], v[76:79]
ds_read_b64_tr_b16 a[4:5], v24 offset:4096
v_mfma_f32_16x16x32_bf16 v[76:79], a[12:15], a[84:87], v[76:79]
ds_read_b64_tr_b16 a[6:7], v24 offset:6144
v_mfma_f32_16x16x32_bf16 v[76:79], a[16:19], a[96:99], v[76:79]
ds_read_b64_tr_b16 a[8:9], v24 offset:8192
v_mfma_f32_16x16x32_bf16 v[76:79], a[20:23], a[108:111], v[76:79]
ds_read_b64_tr_b16 a[10:11], v24 offset:10240
v_mfma_f32_16x16x32_bf16 v[76:79], a[24:27], v[216:219], v[76:79]
ds_read_b64_tr_b16 a[12:13], v24 offset:12288
v_mfma_f32_16x16x32_bf16 v[76:79], a[28:31], a[120:123], v[76:79]
ds_read_b64_tr_b16 a[14:15], v24 offset:14336
v_mfma_f32_16x16x32_bf16 v[32:35], a[32:35], v[184:187], 0
ds_read_b64_tr_b16 a[16:17], v24 offset:16384
v_mfma_f32_16x16x32_bf16 v[32:35], a[36:39], v[196:199], v[32:35]
ds_read_b64_tr_b16 a[18:19], v24 offset:18432
v_mfma_f32_16x16x32_bf16 v[32:35], a[40:43], a[64:67], v[32:35]
ds_read_b64_tr_b16 a[20:21], v24 offset:20480
v_mfma_f32_16x16x32_bf16 v[32:35], a[44:47], a[76:79], v[32:35]
ds_read_b64_tr_b16 a[22:23], v24 offset:22528
v_mfma_f32_16x16x32_bf16 v[32:35], a[48:51], a[88:91], v[32:35]
ds_read_b64_tr_b16 a[24:25], v24 offset:24576
v_mfma_f32_16x16x32_bf16 v[32:35], a[52:55], a[100:103], v[32:35]
buffer_load_dwordx4 v8, s[16:19], s63 offen nt lds
v_mfma_f32_16x16x32_bf16 v[32:35], a[56:59], v[208:211], v[32:35]
ds_read_b64_tr_b16 a[26:27], v24 offset:26624
v_mfma_f32_16x16x32_bf16 v[32:35], a[60:63], a[112:115], v[32:35]
s_add_u32 m0, s61, 106496
ds_read_b64_tr_b16 a[28:29], v24 offset:28672
v_mfma_f32_16x16x32_bf16 v[36:39], a[32:35], v[188:191], 0
s_mov_b32 s63, 180608
ds_read_b64_tr_b16 a[30:31], v24 offset:30720
v_mfma_f32_16x16x32_bf16 v[36:39], a[36:39], v[200:203], v[36:39]
ds_read_b128 a[212:215], v11 offset:1024
v_mfma_f32_16x16x32_bf16 v[36:39], a[40:43], a[68:71], v[36:39]
ds_read_b128 a[216:219], v11 offset:2048
v_mfma_f32_16x16x32_bf16 v[36:39], a[44:47], a[80:83], v[36:39]
ds_read_b128 a[220:223], v11 offset:3072
v_mfma_f32_16x16x32_bf16 v[36:39], a[48:51], a[92:95], v[36:39]
ds_read_b128 a[224:227], v11 offset:4096
v_mfma_f32_16x16x32_bf16 v[36:39], a[52:55], a[104:107], v[36:39]
ds_read_b128 a[228:231], v11 offset:5120
v_mfma_f32_16x16x32_bf16 v[36:39], a[56:59], v[212:215], v[36:39]
v_mfma_f32_16x16x32_bf16 v[36:39], a[60:63], a[116:119], v[36:39]
v_mfma_f32_16x16x32_bf16 v[40:43], a[32:35], v[192:195], 0
ds_read_b64_tr_b16 a[32:33], v25 offset:0
v_mfma_f32_16x16x32_bf16 v[40:43], a[36:39], v[204:207], v[40:43]
ds_read_b64_tr_b16 a[34:35], v25 offset:2048
v_mfma_f32_16x16x32_bf16 v[40:43], a[40:43], a[72:75], v[40:43]
ds_read_b64_tr_b16 a[36:37], v25 offset:4096
v_mfma_f32_16x16x32_bf16 v[40:43], a[44:47], a[84:87], v[40:43]
buffer_load_dwordx4 v8, s[16:19], s62 offen nt lds
v_mfma_f32_16x16x32_bf16 v[40:43], a[48:51], a[96:99], v[40:43]
s_add_u32 m0, s61, 110592
ds_read_b64_tr_b16 a[38:39], v25 offset:6144
v_mfma_f32_16x16x32_bf16 v[40:43], a[52:55], a[108:111], v[40:43]
s_mov_b32 s62, 196992
ds_read_b64_tr_b16 a[40:41], v25 offset:8192
v_mfma_f32_16x16x32_bf16 v[40:43], a[56:59], v[216:219], v[40:43]
ds_read_b64_tr_b16 a[42:43], v25 offset:10240
v_mfma_f32_16x16x32_bf16 v[40:43], a[60:63], a[120:123], v[40:43]
s_waitcnt lgkmcnt(5)
ds_read_b64_tr_b16 a[44:45], v25 offset:12288
v_mfma_f32_16x16x32_bf16 v[44:47], a[0:3], a[124:127], v[44:47]
ds_read_b64_tr_b16 a[46:47], v25 offset:14336
v_mfma_f32_16x16x32_bf16 v[44:47], a[4:7], a[136:139], v[44:47]
ds_read_b64_tr_b16 a[48:49], v25 offset:16384
v_mfma_f32_16x16x32_bf16 v[44:47], a[8:11], a[148:151], v[44:47]
ds_read_b64_tr_b16 a[50:51], v25 offset:18432
v_mfma_f32_16x16x32_bf16 v[44:47], a[12:15], v[220:223], v[44:47]
ds_read_b64_tr_b16 a[52:53], v25 offset:20480
v_mfma_f32_16x16x32_bf16 v[44:47], a[16:19], a[160:163], v[44:47]
ds_read_b64_tr_b16 a[54:55], v25 offset:22528
v_mfma_f32_16x16x32_bf16 v[44:47], a[20:23], a[172:175], v[44:47]
ds_read_b64_tr_b16 a[56:57], v25 offset:24576
v_mfma_f32_16x16x32_bf16 v[44:47], a[24:27], v[232:235], v[44:47]
ds_read_b64_tr_b16 a[58:59], v25 offset:26624
v_mfma_f32_16x16x32_bf16 v[44:47], a[28:31], v[244:247], v[44:47]
ds_read_b64_tr_b16 a[60:61], v25 offset:28672
v_mfma_f32_16x16x32_bf16 v[48:51], a[0:3], a[128:131], v[48:51]
ds_read_b64_tr_b16 a[62:63], v25 offset:30720
v_mfma_f32_16x16x32_bf16 v[48:51], a[4:7], a[140:143], v[48:51]
v_mfma_f32_16x16x32_bf16 v[48:51], a[8:11], a[152:155], v[48:51]
buffer_load_dwordx4 v8, s[16:19], s63 offen nt lds
v_mfma_f32_16x16x32_bf16 v[48:51], a[12:15], v[224:227], v[48:51]
s_add_u32 m0, s61, 114688
v_mul_f32 v44, v80, v44
v_mul_f32 v45, v80, v45
v_mfma_f32_16x16x32_bf16 v[48:51], a[16:19], a[164:167], v[48:51]
s_mov_b32 s63, 213376
v_cvt_pk_bf16_f32 v136, v44, v45
v_mul_f32 v46, v80, v46
v_mfma_f32_16x16x32_bf16 v[48:51], a[20:23], a[176:179], v[48:51]
v_mul_f32 v47, v80, v47
v_cvt_pk_bf16_f32 v137, v46, v47
v_mfma_f32_16x16x32_bf16 v[48:51], a[24:27], v[236:239], v[48:51]
v_mfma_f32_16x16x32_bf16 v[48:51], a[28:31], v[248:251], v[48:51]
v_mfma_f32_16x16x32_bf16 v[52:55], a[0:3], a[132:135], v[52:55]
ds_read_b64_tr_b16 a[0:1], v26 offset:0
v_mfma_f32_16x16x32_bf16 v[52:55], a[4:7], a[144:147], v[52:55]
ds_read_b64_tr_b16 a[2:3], v26 offset:2048
v_mfma_f32_16x16x32_bf16 v[52:55], a[8:11], a[156:159], v[52:55]
ds_read_b64_tr_b16 a[4:5], v26 offset:4096
v_mul_f32 v48, v81, v48
v_mfma_f32_16x16x32_bf16 v[52:55], a[12:15], v[228:231], v[52:55]
ds_read_b64_tr_b16 a[6:7], v26 offset:6144
v_mul_f32 v49, v81, v49
v_mfma_f32_16x16x32_bf16 v[52:55], a[16:19], a[168:171], v[52:55]
ds_read_b64_tr_b16 a[8:9], v26 offset:8192
v_cvt_pk_bf16_f32 v140, v48, v49
v_mfma_f32_16x16x32_bf16 v[52:55], a[20:23], a[180:183], v[52:55]
ds_read_b64_tr_b16 a[10:11], v26 offset:10240
v_mul_f32 v50, v81, v50
v_mfma_f32_16x16x32_bf16 v[52:55], a[24:27], v[240:243], v[52:55]
ds_read_b64_tr_b16 a[12:13], v26 offset:12288
v_mul_f32 v51, v81, v51
v_mfma_f32_16x16x32_bf16 v[52:55], a[28:31], v[252:255], v[52:55]
s_waitcnt lgkmcnt(6)
ds_read_b64_tr_b16 a[14:15], v26 offset:14336
v_cvt_pk_bf16_f32 v141, v50, v51
v_mfma_f32_16x16x32_bf16 v[56:59], a[32:35], a[124:127], v[56:59]
buffer_load_dwordx4 v8, s[16:19], s62 offen nt lds
v_mfma_f32_16x16x32_bf16 v[56:59], a[36:39], a[136:139], v[56:59]
ds_read_b64_tr_b16 a[16:17], v26 offset:16384
v_mfma_f32_16x16x32_bf16 v[56:59], a[40:43], a[148:151], v[56:59]
ds_read_b64_tr_b16 a[18:19], v26 offset:18432
v_mul_f32 v52, v82, v52
v_mfma_f32_16x16x32_bf16 v[56:59], a[44:47], v[220:223], v[56:59]
ds_read_b64_tr_b16 a[20:21], v26 offset:20480
v_mul_f32 v53, v82, v53
v_mfma_f32_16x16x32_bf16 v[56:59], a[48:51], a[160:163], v[56:59]
ds_read_b64_tr_b16 a[22:23], v26 offset:22528
v_cvt_pk_bf16_f32 v144, v52, v53
v_mfma_f32_16x16x32_bf16 v[56:59], a[52:55], a[172:175], v[56:59]
ds_read_b64_tr_b16 a[24:25], v26 offset:24576
v_mul_f32 v54, v82, v54
v_mfma_f32_16x16x32_bf16 v[56:59], a[56:59], v[232:235], v[56:59]
ds_read_b64_tr_b16 a[26:27], v26 offset:26624
v_mul_f32 v55, v82, v55
v_mfma_f32_16x16x32_bf16 v[56:59], a[60:63], v[244:247], v[56:59]
s_add_u32 m0, s61, 118784
ds_read_b64_tr_b16 a[28:29], v26 offset:28672
v_cvt_pk_bf16_f32 v145, v54, v55
v_mfma_f32_16x16x32_bf16 v[60:63], a[32:35], a[128:131], v[60:63]
s_mov_b32 s62, 229760
ds_read_b64_tr_b16 a[30:31], v26 offset:30720
v_mfma_f32_16x16x32_bf16 v[60:63], a[36:39], a[140:143], v[60:63]
v_mfma_f32_16x16x32_bf16 v[60:63], a[40:43], a[152:155], v[60:63]
v_mul_f32 v56, v80, v56
v_mul_f32 v57, v80, v57
v_mfma_f32_16x16x32_bf16 v[60:63], a[44:47], v[224:227], v[60:63]
v_cvt_pk_bf16_f32 v138, v56, v57
v_mul_f32 v58, v80, v58
v_mfma_f32_16x16x32_bf16 v[60:63], a[48:51], a[164:167], v[60:63]
v_mul_f32 v59, v80, v59
v_cvt_pk_bf16_f32 v139, v58, v59
v_mfma_f32_16x16x32_bf16 v[60:63], a[52:55], a[176:179], v[60:63]
v_mfma_f32_16x16x32_bf16 v[60:63], a[56:59], v[236:239], v[60:63]
buffer_load_dwordx4 v8, s[16:19], s63 offen nt lds
v_mfma_f32_16x16x32_bf16 v[60:63], a[60:63], v[248:251], v[60:63]
s_add_u32 m0, s61, 122880
v_mfma_f32_16x16x32_bf16 v[64:67], a[32:35], a[132:135], v[64:67]
s_mov_b32 s63, 246144
ds_read_b64_tr_b16 a[32:33], v27 offset:0
v_mfma_f32_16x16x32_bf16 v[64:67], a[36:39], a[144:147], v[64:67]
ds_read_b64_tr_b16 a[34:35], v27 offset:2048
v_mfma_f32_16x16x32_bf16 v[64:67], a[40:43], a[156:159], v[64:67]
ds_read_b64_tr_b16 a[36:37], v27 offset:4096
v_mul_f32 v60, v81, v60
v_mfma_f32_16x16x32_bf16 v[64:67], a[44:47], v[228:231], v[64:67]
ds_read_b64_tr_b16 a[38:39], v27 offset:6144
v_mul_f32 v61, v81, v61
v_mfma_f32_16x16x32_bf16 v[64:67], a[48:51], a[168:171], v[64:67]
ds_read_b64_tr_b16 a[40:41], v27 offset:8192
v_cvt_pk_bf16_f32 v142, v60, v61
v_mfma_f32_16x16x32_bf16 v[64:67], a[52:55], a[180:183], v[64:67]
ds_read_b64_tr_b16 a[42:43], v27 offset:10240
v_mul_f32 v62, v81, v62
v_mfma_f32_16x16x32_bf16 v[64:67], a[56:59], v[240:243], v[64:67]
ds_read_b64_tr_b16 a[44:45], v27 offset:12288
v_mul_f32 v63, v81, v63
v_mfma_f32_16x16x32_bf16 v[64:67], a[60:63], v[252:255], v[64:67]
s_waitcnt lgkmcnt(6)
ds_read_b64_tr_b16 a[46:47], v27 offset:14336
v_cvt_pk_bf16_f32 v143, v62, v63
v_mfma_f32_16x16x32_bf16 v[68:71], a[0:3], a[124:127], v[68:71]
ds_read_b64_tr_b16 a[48:49], v27 offset:16384
v_mfma_f32_16x16x32_bf16 v[68:71], a[4:7], a[136:139], v[68:71]
ds_read_b64_tr_b16 a[50:51], v27 offset:18432
v_mfma_f32_16x16x32_bf16 v[68:71], a[8:11], a[148:151], v[68:71]
ds_read_b64_tr_b16 a[52:53], v27 offset:20480
v_mul_f32 v64, v82, v64
v_mfma_f32_16x16x32_bf16 v[68:71], a[12:15], v[220:223], v[68:71]
ds_read_b64_tr_b16 a[54:55], v27 offset:22528
v_mul_f32 v65, v82, v65
v_mfma_f32_16x16x32_bf16 v[68:71], a[16:19], a[160:163], v[68:71]
buffer_load_dwordx4 v8, s[16:19], s62 offen nt lds
v_mfma_f32_16x16x32_bf16 v[68:71], a[20:23], a[172:175], v[68:71]
ds_read_b64_tr_b16 a[56:57], v27 offset:24576
v_cvt_pk_bf16_f32 v146, v64, v65
v_mfma_f32_16x16x32_bf16 v[68:71], a[24:27], v[232:235], v[68:71]
ds_read_b64_tr_b16 a[58:59], v27 offset:26624
v_mul_f32 v66, v82, v66
v_mfma_f32_16x16x32_bf16 v[68:71], a[28:31], v[244:247], v[68:71]
s_add_u32 m0, s61, 126976
ds_read_b64_tr_b16 a[60:61], v27 offset:28672
v_mul_f32 v67, v82, v67
v_mfma_f32_16x16x32_bf16 v[72:75], a[0:3], a[128:131], v[72:75]
s_add_u32 s62, s70, 0
ds_read_b64_tr_b16 a[62:63], v27 offset:30720
v_add_u32 v24, 0x10000, v24
v_mfma_f32_16x16x32_bf16 v[72:75], a[4:7], a[140:143], v[72:75]
v_add_u32 v25, 0x10000, v25
v_add_u32 v26, 0x10000, v26
v_mfma_f32_16x16x32_bf16 v[72:75], a[8:11], a[152:155], v[72:75]
v_add_u32 v27, 0x10000, v27
v_cvt_pk_bf16_f32 v147, v66, v67
v_mfma_f32_16x16x32_bf16 v[72:75], a[12:15], v[224:227], v[72:75]
v_mul_f32 v68, v80, v68
v_mul_f32 v69, v80, v69
v_mfma_f32_16x16x32_bf16 v[72:75], a[16:19], a[164:167], v[72:75]
v_cvt_pk_bf16_f32 v148, v68, v69
v_mul_f32 v70, v80, v70
v_mfma_f32_16x16x32_bf16 v[72:75], a[20:23], a[176:179], v[72:75]
v_mul_f32 v71, v80, v71
v_cvt_pk_bf16_f32 v149, v70, v71
v_mfma_f32_16x16x32_bf16 v[72:75], a[24:27], v[236:239], v[72:75]
s_waitcnt vmcnt(7) lgkmcnt(0)
s_barrier
v_mfma_f32_16x16x32_bf16 v[72:75], a[28:31], v[248:251], v[72:75]
ds_write_b64 v10, v[136:137] offset:0
v_mfma_f32_16x16x32_bf16 v[76:79], a[0:3], a[132:135], v[76:79]
ds_read_b64_tr_b16 a[0:1], v24 offset:0
v_mfma_f32_16x16x32_bf16 v[76:79], a[4:7], a[144:147], v[76:79]
ds_read_b64_tr_b16 a[2:3], v24 offset:2048
v_mfma_f32_16x16x32_bf16 v[76:79], a[8:11], a[156:159], v[76:79]
ds_read_b64_tr_b16 a[4:5], v24 offset:4096
v_mul_f32 v72, v81, v72
v_mfma_f32_16x16x32_bf16 v[76:79], a[12:15], v[228:231], v[76:79]
buffer_load_dwordx4 v8, s[16:19], s63 offen nt lds
v_mfma_f32_16x16x32_bf16 v[76:79], a[16:19], a[168:171], v[76:79]
s_add_u32 m0, s61, 0
ds_read_b64_tr_b16 a[6:7], v24 offset:6144
v_mul_f32 v73, v81, v73
v_mfma_f32_16x16x32_bf16 v[76:79], a[20:23], a[180:183], v[76:79]
s_add_u32 s63, s70, 28672
buffer_load_dwordx4 v9, s[20:23], s62 offen lds
v_mfma_f32_16x16x32_bf16 v[76:79], a[24:27], v[240:243], v[76:79]
s_add_u32 m0, s61, 4096
ds_read_b64_tr_b16 a[8:9], v24 offset:8192
v_cvt_pk_bf16_f32 v152, v72, v73
v_mfma_f32_16x16x32_bf16 v[76:79], a[28:31], v[252:255], v[76:79]
buffer_load_dwordx4 v9, s[20:23], s63 offen lds
v_mfma_f32_16x16x32_bf16 v[32:35], a[32:35], a[124:127], v[32:35]
ds_read_b64_tr_b16 a[10:11], v24 offset:10240
v_mul_f32 v74, v81, v74
v_mfma_f32_16x16x32_bf16 v[32:35], a[36:39], a[136:139], v[32:35]
ds_read_b64_tr_b16 a[12:13], v24 offset:12288
v_mul_f32 v75, v81, v75
v_mfma_f32_16x16x32_bf16 v[32:35], a[40:43], a[148:151], v[32:35]
ds_read_b64_tr_b16 a[14:15], v24 offset:14336
v_cvt_pk_bf16_f32 v153, v74, v75
v_mfma_f32_16x16x32_bf16 v[32:35], a[44:47], v[220:223], v[32:35]
ds_read_b64_tr_b16 a[16:17], v24 offset:16384
v_mul_f32 v76, v82, v76
v_mfma_f32_16x16x32_bf16 v[32:35], a[48:51], a[160:163], v[32:35]
ds_read_b64_tr_b16 a[18:19], v24 offset:18432
v_mul_f32 v77, v82, v77
v_mfma_f32_16x16x32_bf16 v[32:35], a[52:55], a[172:175], v[32:35]
ds_read_b64_tr_b16 a[20:21], v24 offset:20480
v_cvt_pk_bf16_f32 v156, v76, v77
v_mfma_f32_16x16x32_bf16 v[32:35], a[56:59], v[232:235], v[32:35]
ds_read_b64_tr_b16 a[22:23], v24 offset:22528
v_mul_f32 v78, v82, v78
v_mfma_f32_16x16x32_bf16 v[32:35], a[60:63], v[244:247], v[32:35]
s_add_u32 s62, s70, 57344
ds_read_b64_tr_b16 a[24:25], v24 offset:24576
v_mul_f32 v79, v82, v79
v_mfma_f32_16x16x32_bf16 v[36:39], a[32:35], a[128:131], v[36:39]
s_add_u32 m0, s61, 8192
ds_read_b64_tr_b16 a[26:27], v24 offset:26624
v_cvt_pk_bf16_f32 v157, v78, v79
v_mfma_f32_16x16x32_bf16 v[36:39], a[36:39], a[140:143], v[36:39]
s_add_u32 s63, s70, 86016
buffer_load_dwordx4 v9, s[20:23], s62 offen lds
v_mfma_f32_16x16x32_bf16 v[36:39], a[40:43], a[152:155], v[36:39]
s_add_u32 m0, s61, 12288
ds_read_b64_tr_b16 a[28:29], v24 offset:28672
v_mul_f32 v32, v80, v32
v_mfma_f32_16x16x32_bf16 v[36:39], a[44:47], v[224:227], v[36:39]
s_add_u32 s62, s70, 229376
buffer_load_dwordx4 v9, s[20:23], s63 offen lds
v_mfma_f32_16x16x32_bf16 v[36:39], a[48:51], a[164:167], v[36:39]
s_add_u32 m0, s61, 16384
ds_read_b64_tr_b16 a[30:31], v24 offset:30720
v_mul_f32 v33, v80, v33
v_mfma_f32_16x16x32_bf16 v[36:39], a[52:55], a[176:179], v[36:39]
s_add_u32 s63, s70, 258048
buffer_load_dwordx4 v9, s[20:23], s62 offen lds
v_mfma_f32_16x16x32_bf16 v[36:39], a[56:59], v[236:239], v[36:39]
s_add_u32 m0, s61, 20480
ds_write_b64 v10, v[138:139] offset:8
v_mfma_f32_16x16x32_bf16 v[36:39], a[60:63], v[248:251], v[36:39]
s_add_u32 s62, s70, 286720
ds_write_b64 v10, v[140:141] offset:1024
v_mfma_f32_16x16x32_bf16 v[40:43], a[32:35], a[132:135], v[40:43]
ds_read_b64_tr_b16 a[32:33], v25 offset:0
v_cvt_pk_bf16_f32 v150, v32, v33
v_mfma_f32_16x16x32_bf16 v[40:43], a[36:39], a[144:147], v[40:43]
ds_read_b64_tr_b16 a[34:35], v25 offset:2048
v_mul_f32 v34, v80, v34
v_mfma_f32_16x16x32_bf16 v[40:43], a[40:43], a[156:159], v[40:43]
buffer_load_dwordx4 v9, s[20:23], s63 offen lds
v_mfma_f32_16x16x32_bf16 v[40:43], a[44:47], v[228:231], v[40:43]
s_add_u32 m0, s61, 24576
ds_read_b64_tr_b16 a[36:37], v25 offset:4096
v_mul_f32 v35, v80, v35
v_mfma_f32_16x16x32_bf16 v[40:43], a[48:51], a[168:171], v[40:43]
s_add_u32 s63, s70, 315392
ds_read_b64_tr_b16 a[38:39], v25 offset:6144
v_cvt_pk_bf16_f32 v151, v34, v35
v_mfma_f32_16x16x32_bf16 v[40:43], a[52:55], a[180:183], v[40:43]
ds_read_b64_tr_b16 a[40:41], v25 offset:8192
v_mul_f32 v36, v81, v36
v_mfma_f32_16x16x32_bf16 v[40:43], a[56:59], v[240:243], v[40:43]
buffer_load_dwordx4 v9, s[20:23], s62 offen lds
v_mfma_f32_16x16x32_bf16 v[40:43], a[60:63], v[252:255], v[40:43]
s_waitcnt lgkmcnt(4)
ds_read_b64_tr_b16 a[42:43], v25 offset:10240
v_mul_f32 v37, v81, v37
v_mfma_f32_16x16x32_bf16 v[44:47], a[0:3], v[184:187], 0
ds_read_b64_tr_b16 a[44:45], v25 offset:12288
v_cvt_pk_bf16_f32 v154, v36, v37
v_mfma_f32_16x16x32_bf16 v[44:47], a[4:7], v[196:199], v[44:47]
ds_read_b64_tr_b16 a[46:47], v25 offset:14336
v_mul_f32 v38, v81, v38
v_mfma_f32_16x16x32_bf16 v[44:47], a[8:11], a[64:67], v[44:47]
ds_read_b64_tr_b16 a[48:49], v25 offset:16384
v_mul_f32 v39, v81, v39
v_mfma_f32_16x16x32_bf16 v[44:47], a[12:15], a[76:79], v[44:47]
ds_read_b64_tr_b16 a[50:51], v25 offset:18432
v_cvt_pk_bf16_f32 v155, v38, v39
v_mfma_f32_16x16x32_bf16 v[44:47], a[16:19], a[88:91], v[44:47]
ds_read_b64_tr_b16 a[52:53], v25 offset:20480
v_mul_f32 v40, v82, v40
v_mfma_f32_16x16x32_bf16 v[44:47], a[20:23], a[100:103], v[44:47]
ds_read_b64_tr_b16 a[54:55], v25 offset:22528
v_mul_f32 v41, v82, v41
v_mfma_f32_16x16x32_bf16 v[44:47], a[24:27], v[208:211], v[44:47]
ds_read_b64_tr_b16 a[56:57], v25 offset:24576
v_cvt_pk_bf16_f32 v158, v40, v41
v_mfma_f32_16x16x32_bf16 v[44:47], a[28:31], a[112:115], v[44:47]
s_add_u32 m0, s61, 28672
ds_read_b64_tr_b16 a[58:59], v25 offset:26624
v_mul_f32 v42, v82, v42
v_mfma_f32_16x16x32_bf16 v[48:51], a[0:3], v[188:191], 0
s_add_u32 s62, s70, 114688
buffer_load_dwordx4 v9, s[20:23], s63 offen lds
v_mfma_f32_16x16x32_bf16 v[48:51], a[4:7], v[200:203], v[48:51]
s_add_u32 m0, s61, 65536
ds_read_b64_tr_b16 a[60:61], v25 offset:28672
v_mul_f32 v43, v82, v43
v_mfma_f32_16x16x32_bf16 v[48:51], a[8:11], a[68:71], v[48:51]
s_add_u32 s63, s70, 143360
buffer_load_dwordx4 v9, s[20:23], s62 offen lds
v_mfma_f32_16x16x32_bf16 v[48:51], a[12:15], a[80:83], v[48:51]
s_add_u32 m0, s61, 69632
ds_read_b64_tr_b16 a[62:63], v25 offset:30720
v_cvt_pk_bf16_f32 v159, v42, v43
v_mfma_f32_16x16x32_bf16 v[48:51], a[16:19], a[92:95], v[48:51]
s_add_u32 s62, s70, 172032
buffer_load_dwordx4 v9, s[20:23], s63 offen lds
v_mfma_f32_16x16x32_bf16 v[48:51], a[20:23], a[104:107], v[48:51]
s_add_u32 m0, s61, 73728
ds_write_b64 v10, v[142:143] offset:1032
v_mfma_f32_16x16x32_bf16 v[48:51], a[24:27], v[212:215], v[48:51]
s_add_u32 s63, s70, 200704
ds_write_b64 v10, v[144:145] offset:2048
v_mfma_f32_16x16x32_bf16 v[48:51], a[28:31], a[116:119], v[48:51]
ds_write_b64 v10, v[146:147] offset:2056
v_mfma_f32_16x16x32_bf16 v[52:55], a[0:3], v[192:195], 0
ds_read_b64_tr_b16 a[0:1], v26 offset:0
v_mfma_f32_16x16x32_bf16 v[52:55], a[4:7], v[204:207], v[52:55]
buffer_load_dwordx4 v9, s[20:23], s62 offen lds
v_mfma_f32_16x16x32_bf16 v[52:55], a[8:11], a[72:75], v[52:55]
s_add_u32 m0, s61, 77824
ds_read_b64_tr_b16 a[2:3], v26 offset:2048
v_mfma_f32_16x16x32_bf16 v[52:55], a[12:15], a[84:87], v[52:55]
s_add_u32 s62, s70, 344064
ds_read_b64_tr_b16 a[4:5], v26 offset:4096
v_mfma_f32_16x16x32_bf16 v[52:55], a[16:19], a[96:99], v[52:55]
ds_read_b64_tr_b16 a[6:7], v26 offset:6144
v_mfma_f32_16x16x32_bf16 v[52:55], a[20:23], a[108:111], v[52:55]
buffer_load_dwordx4 v9, s[20:23], s63 offen lds
v_mfma_f32_16x16x32_bf16 v[52:55], a[24:27], v[216:219], v[52:55]
s_add_u32 m0, s61, 81920
ds_read_b64_tr_b16 a[8:9], v26 offset:8192
v_mfma_f32_16x16x32_bf16 v[52:55], a[28:31], a[120:123], v[52:55]
s_waitcnt lgkmcnt(4)
ds_read_b64_tr_b16 a[10:11], v26 offset:10240
v_mfma_f32_16x16x32_bf16 v[56:59], a[32:35], v[184:187], 0
ds_read_b64_tr_b16 a[12:13], v26 offset:12288
v_mfma_f32_16x16x32_bf16 v[56:59], a[36:39], v[196:199], v[56:59]
ds_read_b64_tr_b16 a[14:15], v26 offset:14336
v_mfma_f32_16x16x32_bf16 v[56:59], a[40:43], a[64:67], v[56:59]
buffer_load_dwordx4 v9, s[20:23], s62 offen lds
v_mfma_f32_16x16x32_bf16 v[56:59], a[44:47], a[76:79], v[56:59]
ds_read_b64_tr_b16 a[16:17], v26 offset:16384
v_mfma_f32_16x16x32_bf16 v[56:59], a[48:51], a[88:91], v[56:59]
ds_read_b64_tr_b16 a[18:19], v26 offset:18432
v_mfma_f32_16x16x32_bf16 v[56:59], a[52:55], a[100:103], v[56:59]
ds_read_b64_tr_b16 a[20:21], v26 offset:20480
v_mfma_f32_16x16x32_bf16 v[56:59], a[56:59], v[208:211], v[56:59]
ds_read_b64_tr_b16 a[22:23], v26 offset:22528
v_mfma_f32_16x16x32_bf16 v[56:59], a[60:63], a[112:115], v[56:59]
s_add_u32 s63, s70, 372736
ds_read_b64_tr_b16 a[24:25], v26 offset:24576
v_mfma_f32_16x16x32_bf16 v[60:63], a[32:35], v[188:191], 0
s_add_u32 m0, s61, 86016
ds_read_b64_tr_b16 a[26:27], v26 offset:26624
v_mfma_f32_16x16x32_bf16 v[60:63], a[36:39], v[200:203], v[60:63]
s_add_u32 s62, s70, 401408
buffer_load_dwordx4 v9, s[20:23], s63 offen lds
v_mfma_f32_16x16x32_bf16 v[60:63], a[40:43], a[68:71], v[60:63]
s_add_u32 m0, s61, 90112
ds_read_b64_tr_b16 a[28:29], v26 offset:28672
v_mfma_f32_16x16x32_bf16 v[60:63], a[44:47], a[80:83], v[60:63]
s_add_u32 s63, s70, 430080
buffer_load_dwordx4 v9, s[20:23], s62 offen lds
v_mfma_f32_16x16x32_bf16 v[60:63], a[48:51], a[92:95], v[60:63]
s_add_u32 m0, s61, 94208
ds_read_b64_tr_b16 a[30:31], v26 offset:30720
v_mfma_f32_16x16x32_bf16 v[60:63], a[52:55], a[104:107], v[60:63]
s_add_u32 s62, s71, 0
ds_write_b64 v10, v[148:149] offset:3072
v_mfma_f32_16x16x32_bf16 v[60:63], a[56:59], v[212:215], v[60:63]
ds_write_b64 v10, v[150:151] offset:3080
v_mfma_f32_16x16x32_bf16 v[60:63], a[60:63], a[116:119], v[60:63]
buffer_load_dwordx4 v9, s[20:23], s63 offen lds
v_mfma_f32_16x16x32_bf16 v[64:67], a[32:35], v[192:195], 0
s_mul_i32 s97, s93, 28672
ds_read_b64_tr_b16 a[32:33], v27 offset:0
v_mfma_f32_16x16x32_bf16 v[64:67], a[36:39], v[204:207], v[64:67]
s_add_u32 m0, s61, 131072
ds_read_b64_tr_b16 a[34:35], v27 offset:2048
v_mfma_f32_16x16x32_bf16 v[64:67], a[40:43], a[72:75], v[64:67]
s_add_u32 s63, s71, 28672
ds_read_b64_tr_b16 a[36:37], v27 offset:4096
v_mfma_f32_16x16x32_bf16 v[64:67], a[44:47], a[84:87], v[64:67]
ds_read_b64_tr_b16 a[38:39], v27 offset:6144
v_mfma_f32_16x16x32_bf16 v[64:67], a[48:51], a[96:99], v[64:67]
buffer_load_dwordx4 a[252:255], v83, s[20:23], s97 offen
v_mfma_f32_16x16x32_bf16 v[64:67], a[52:55], a[108:111], v[64:67]
s_add_u32 s97, s97, 4096
ds_read_b64_tr_b16 a[40:41], v27 offset:8192
v_mfma_f32_16x16x32_bf16 v[64:67], a[56:59], v[216:219], v[64:67]
ds_read_b64_tr_b16 a[42:43], v27 offset:10240
v_mfma_f32_16x16x32_bf16 v[64:67], a[60:63], a[120:123], v[64:67]
s_waitcnt lgkmcnt(5)
ds_read_b64_tr_b16 a[44:45], v27 offset:12288
v_mfma_f32_16x16x32_bf16 v[68:71], a[0:3], v[184:187], 0
buffer_load_dwordx4 a[252:255], v83, s[20:23], s97 offen
v_mfma_f32_16x16x32_bf16 v[68:71], a[4:7], v[196:199], v[68:71]
ds_read_b64_tr_b16 a[46:47], v27 offset:14336
v_mfma_f32_16x16x32_bf16 v[68:71], a[8:11], a[64:67], v[68:71]
ds_read_b64_tr_b16 a[48:49], v27 offset:16384
v_mfma_f32_16x16x32_bf16 v[68:71], a[12:15], a[76:79], v[68:71]
ds_read_b64_tr_b16 a[50:51], v27 offset:18432
v_mfma_f32_16x16x32_bf16 v[68:71], a[16:19], a[88:91], v[68:71]
ds_read_b64_tr_b16 a[52:53], v27 offset:20480
v_mfma_f32_16x16x32_bf16 v[68:71], a[20:23], a[100:103], v[68:71]
ds_read_b64_tr_b16 a[54:55], v27 offset:22528
v_mfma_f32_16x16x32_bf16 v[68:71], a[24:27], v[208:211], v[68:71]
ds_read_b64_tr_b16 a[56:57], v27 offset:24576
v_mfma_f32_16x16x32_bf16 v[68:71], a[28:31], a[112:115], v[68:71]
s_add_u32 s97, s97, 4096
buffer_load_dwordx4 a[252:255], v83, s[20:23], s97 offen
v_mfma_f32_16x16x32_bf16 v[72:75], a[0:3], v[188:191], 0
s_add_u32 s97, s97, 4096
ds_read_b64_tr_b16 a[58:59], v27 offset:26624
v_mfma_f32_16x16x32_bf16 v[72:75], a[4:7], v[200:203], v[72:75]
buffer_load_dwordx4 a[252:255], v83, s[20:23], s97 offen
v_mfma_f32_16x16x32_bf16 v[72:75], a[8:11], a[68:71], v[72:75]
s_add_u32 s97, s97, 4096
ds_read_b64_tr_b16 a[60:61], v27 offset:28672
v_mfma_f32_16x16x32_bf16 v[72:75], a[12:15], a[80:83], v[72:75]
ds_read_b64_tr_b16 a[62:63], v27 offset:30720
v_add_u32 v24, 0xffff8000, v24
v_mfma_f32_16x16x32_bf16 v[72:75], a[16:19], a[92:95], v[72:75]
v_add_u32 v25, 0xffff8000, v25
v_add_u32 v26, 0xffff8000, v26
v_mfma_f32_16x16x32_bf16 v[72:75], a[20:23], a[104:107], v[72:75]
v_add_u32 v27, 0xffff8000, v27
v_mfma_f32_16x16x32_bf16 v[72:75], a[24:27], v[212:215], v[72:75]
buffer_load_dwordx4 a[252:255], v83, s[20:23], s97 offen
v_mfma_f32_16x16x32_bf16 v[72:75], a[28:31], a[116:119], v[72:75]
s_add_u32 s97, s97, 4096
ds_write_b64 v10, v[152:153] offset:4096
v_mfma_f32_16x16x32_bf16 v[76:79], a[0:3], v[192:195], 0
ds_write_b64 v10, v[154:155] offset:4104
v_mfma_f32_16x16x32_bf16 v[76:79], a[4:7], v[204:207], v[76:79]
ds_write_b64 v10, v[156:157] offset:5120
v_mfma_f32_16x16x32_bf16 v[76:79], a[8:11], a[72:75], v[76:79]
buffer_load_dwordx4 a[252:255], v83, s[20:23], s97 offen
v_mfma_f32_16x16x32_bf16 v[76:79], a[12:15], a[84:87], v[76:79]
s_add_u32 s97, s97, 4096
ds_write_b64 v10, v[158:159] offset:5128
v_mfma_f32_16x16x32_bf16 v[76:79], a[16:19], a[96:99], v[76:79]
v_mfma_f32_16x16x32_bf16 v[76:79], a[20:23], a[108:111], v[76:79]
v_mfma_f32_16x16x32_bf16 v[76:79], a[24:27], v[216:219], v[76:79]
v_mfma_f32_16x16x32_bf16 v[76:79], a[28:31], a[120:123], v[76:79]
s_waitcnt lgkmcnt(2)
buffer_load_dwordx4 a[252:255], v83, s[20:23], s97 offen
v_mfma_f32_16x16x32_bf16 v[32:35], a[32:35], v[184:187], 0
s_waitcnt vmcnt(23) lgkmcnt(0)
s_barrier
v_mfma_f32_16x16x32_bf16 v[32:35], a[36:39], v[196:199], v[32:35]
ds_read_b64_tr_b16 a[0:1], v24 offset:0
v_mfma_f32_16x16x32_bf16 v[32:35], a[40:43], a[64:67], v[32:35]
ds_read_b64_tr_b16 a[2:3], v24 offset:2048
v_mfma_f32_16x16x32_bf16 v[32:35], a[44:47], a[76:79], v[32:35]
buffer_load_dwordx4 v9, s[20:23], s62 offen lds
v_mfma_f32_16x16x32_bf16 v[32:35], a[48:51], a[88:91], v[32:35]
ds_read_b64_tr_b16 a[4:5], v24 offset:4096
v_mfma_f32_16x16x32_bf16 v[32:35], a[52:55], a[100:103], v[32:35]
ds_read_b64_tr_b16 a[6:7], v24 offset:6144
v_mfma_f32_16x16x32_bf16 v[32:35], a[56:59], v[208:211], v[32:35]
ds_read_b64_tr_b16 a[8:9], v24 offset:8192
v_mfma_f32_16x16x32_bf16 v[32:35], a[60:63], a[112:115], v[32:35]
s_add_u32 m0, s61, 135168
ds_read_b64_tr_b16 a[10:11], v24 offset:10240
v_mfma_f32_16x16x32_bf16 v[36:39], a[32:35], v[188:191], 0
s_add_u32 s62, s71, 57344
buffer_load_dwordx4 v9, s[20:23], s63 offen lds
v_mfma_f32_16x16x32_bf16 v[36:39], a[36:39], v[200:203], v[36:39]
s_add_u32 m0, s61, 139264
ds_read_b64_tr_b16 a[12:13], v24 offset:12288
v_mfma_f32_16x16x32_bf16 v[36:39], a[40:43], a[68:71], v[36:39]
s_add_u32 s63, s71, 86016
ds_read_b64_tr_b16 a[14:15], v24 offset:14336
v_mfma_f32_16x16x32_bf16 v[36:39], a[44:47], a[80:83], v[36:39]
ds_read_b64_tr_b16 a[16:17], v24 offset:16384
v_mfma_f32_16x16x32_bf16 v[36:39], a[48:51], a[92:95], v[36:39]
buffer_load_dwordx4 v9, s[20:23], s62 offen lds
v_mfma_f32_16x16x32_bf16 v[36:39], a[52:55], a[104:107], v[36:39]
s_add_u32 m0, s61, 143360
ds_read_b64_tr_b16 a[18:19], v24 offset:18432
v_mfma_f32_16x16x32_bf16 v[36:39], a[56:59], v[212:215], v[36:39]
s_add_u32 s62, s71, 229376
ds_read_b64_tr_b16 a[20:21], v24 offset:20480
v_mfma_f32_16x16x32_bf16 v[36:39], a[60:63], a[116:119], v[36:39]
ds_read_b64_tr_b16 a[22:23], v24 offset:22528
v_mfma_f32_16x16x32_bf16 v[40:43], a[32:35], v[192:195], 0
ds_read_b64_tr_b16 a[24:25], v24 offset:24576
v_mfma_f32_16x16x32_bf16 v[40:43], a[36:39], v[204:207], v[40:43]
ds_read_b64_tr_b16 a[26:27], v24 offset:26624
v_mfma_f32_16x16x32_bf16 v[40:43], a[40:43], a[72:75], v[40:43]
ds_read_b64_tr_b16 a[28:29], v24 offset:28672
v_mfma_f32_16x16x32_bf16 v[40:43], a[44:47], a[84:87], v[40:43]
ds_read_b64_tr_b16 a[30:31], v24 offset:30720
v_mfma_f32_16x16x32_bf16 v[40:43], a[48:51], a[96:99], v[40:43]
buffer_load_dwordx4 v9, s[20:23], s63 offen lds
v_mfma_f32_16x16x32_bf16 v[40:43], a[52:55], a[108:111], v[40:43]
s_add_u32 m0, s61, 147456
ds_read_b64_tr_b16 a[32:33], v25 offset:0
v_mfma_f32_16x16x32_bf16 v[40:43], a[56:59], v[216:219], v[40:43]
s_add_u32 s63, s71, 258048
buffer_load_dwordx4 v9, s[20:23], s62 offen lds
v_mfma_f32_16x16x32_bf16 v[40:43], a[60:63], a[120:123], v[40:43]
s_waitcnt lgkmcnt(4)
ds_read_b64_tr_b16 a[34:35], v25 offset:2048
v_mfma_f32_16x16x32_bf16 v[44:47], a[0:3], a[124:127], v[44:47]
ds_read_b64_tr_b16 a[36:37], v25 offset:4096
v_mfma_f32_16x16x32_bf16 v[44:47], a[4:7], a[136:139], v[44:47]
ds_read_b64_tr_b16 a[38:39], v25 offset:6144
v_mfma_f32_16x16x32_bf16 v[44:47], a[8:11], a[148:151], v[44:47]
ds_read_b64_tr_b16 a[40:41], v25 offset:8192
v_mfma_f32_16x16x32_bf16 v[44:47], a[12:15], v[220:223], v[44:47]
ds_read_b64_tr_b16 a[42:43], v25 offset:10240
v_mfma_f32_16x16x32_bf16 v[44:47], a[16:19], a[160:163], v[44:47]
ds_read_b64_tr_b16 a[44:45], v25 offset:12288
v_mfma_f32_16x16x32_bf16 v[44:47], a[20:23], a[172:175], v[44:47]
s_waitcnt lgkmcnt(6)
ds_read_b64_tr_b16 a[46:47], v25 offset:14336
v_mfma_f32_16x16x32_bf16 v[44:47], a[24:27], v[232:235], v[44:47]
ds_read_b64_tr_b16 a[48:49], v25 offset:16384
v_mfma_f32_16x16x32_bf16 v[44:47], a[28:31], v[244:247], v[44:47]
s_add_u32 m0, s61, 151552
ds_read_b64_tr_b16 a[50:51], v25 offset:18432
v_mfma_f32_16x16x32_bf16 v[48:51], a[0:3], a[128:131], v[48:51]
s_add_u32 s62, s71, 286720
buffer_load_dwordx4 v9, s[20:23], s63 offen lds
v_mfma_f32_16x16x32_bf16 v[48:51], a[4:7], a[140:143], v[48:51]
s_add_u32 m0, s61, 155648
ds_read_b64_tr_b16 a[52:53], v25 offset:20480
v_mfma_f32_16x16x32_bf16 v[48:51], a[8:11], a[152:155], v[48:51]
s_add_u32 s63, s71, 315392
buffer_load_dwordx4 v9, s[20:23], s62 offen lds
v_mfma_f32_16x16x32_bf16 v[48:51], a[12:15], v[224:227], v[48:51]
s_add_u32 m0, s61, 159744
ds_read_b64_tr_b16 a[54:55], v25 offset:22528
v_mul_f32 v44, v80, v44
v_mfma_f32_16x16x32_bf16 v[48:51], a[16:19], a[164:167], v[48:51]
s_add_u32 s62, s71, 114688
ds_read_b64_tr_b16 a[56:57], v25 offset:24576
v_mul_f32 v45, v80, v45
v_mfma_f32_16x16x32_bf16 v[48:51], a[20:23], a[176:179], v[48:51]
ds_read_b64_tr_b16 a[58:59], v25 offset:26624
v_cvt_pk_bf16_f32 v160, v44, v45
v_mfma_f32_16x16x32_bf16 v[48:51], a[24:27], v[236:239], v[48:51]
ds_read_b64_tr_b16 a[60:61], v25 offset:28672
v_mul_f32 v46, v80, v46
v_mfma_f32_16x16x32_bf16 v[48:51], a[28:31], v[248:251], v[48:51]
ds_read_b64_tr_b16 a[62:63], v25 offset:30720
v_mul_f32 v47, v80, v47
v_mfma_f32_16x16x32_bf16 v[52:55], a[0:3], a[132:135], v[52:55]
ds_read_b64_tr_b16 a[0:1], v26 offset:0
v_cvt_pk_bf16_f32 v161, v46, v47
v_mfma_f32_16x16x32_bf16 v[52:55], a[4:7], a[144:147], v[52:55]
ds_read_b64_tr_b16 a[2:3], v26 offset:2048
v_mfma_f32_16x16x32_bf16 v[52:55], a[8:11], a[156:159], v[52:55]
ds_read_b64_tr_b16 a[4:5], v26 offset:4096
v_mul_f32 v48, v81, v48
v_mfma_f32_16x16x32_bf16 v[52:55], a[12:15], v[228:231], v[52:55]
ds_read_b64_tr_b16 a[6:7], v26 offset:6144
v_mul_f32 v49, v81, v49
v_mfma_f32_16x16x32_bf16 v[52:55], a[16:19], a[168:171], v[52:55]
ds_read_b64_tr_b16 a[8:9], v26 offset:8192
v_cvt_pk_bf16_f32 v164, v48, v49
v_mfma_f32_16x16x32_bf16 v[52:55], a[20:23], a[180:183], v[52:55]
ds_read_b64_tr_b16 a[10:11], v26 offset:10240
v_mul_f32 v50, v81, v50
v_mfma_f32_16x16x32_bf16 v[52:55], a[24:27], v[240:243], v[52:55]
ds_read_b64_tr_b16 a[12:13], v26 offset:12288
v_mul_f32 v51, v81, v51
v_mfma_f32_16x16x32_bf16 v[52:55], a[28:31], v[252:255], v[52:55]
s_waitcnt lgkmcnt(6)
ds_read_b64_tr_b16 a[14:15], v26 offset:14336
v_cvt_pk_bf16_f32 v165, v50, v51
v_mfma_f32_16x16x32_bf16 v[56:59], a[32:35], a[124:127], v[56:59]
ds_read_b64_tr_b16 a[16:17], v26 offset:16384
v_mfma_f32_16x16x32_bf16 v[56:59], a[36:39], a[136:139], v[56:59]
ds_read_b64_tr_b16 a[18:19], v26 offset:18432
v_mfma_f32_16x16x32_bf16 v[56:59], a[40:43], a[148:151], v[56:59]
ds_read_b64_tr_b16 a[20:21], v26 offset:20480
v_mul_f32 v52, v82, v52
v_mfma_f32_16x16x32_bf16 v[56:59], a[44:47], v[220:223], v[56:59]
ds_read_b64_tr_b16 a[22:23], v26 offset:22528
v_mul_f32 v53, v82, v53
v_mfma_f32_16x16x32_bf16 v[56:59], a[48:51], a[160:163], v[56:59]
ds_read_b64_tr_b16 a[24:25], v26 offset:24576
v_cvt_pk_bf16_f32 v168, v52, v53
v_mfma_f32_16x16x32_bf16 v[56:59], a[52:55], a[172:175], v[56:59]
ds_read_b64_tr_b16 a[26:27], v26 offset:26624
v_mul_f32 v54, v82, v54
v_mfma_f32_16x16x32_bf16 v[56:59], a[56:59], v[232:235], v[56:59]
ds_read_b64_tr_b16 a[28:29], v26 offset:28672
v_mul_f32 v55, v82, v55
v_mfma_f32_16x16x32_bf16 v[56:59], a[60:63], v[244:247], v[56:59]
ds_read_b64_tr_b16 a[30:31], v26 offset:30720
v_cvt_pk_bf16_f32 v169, v54, v55
v_mfma_f32_16x16x32_bf16 v[60:63], a[32:35], a[128:131], v[60:63]
buffer_load_dwordx4 v9, s[20:23], s63 offen lds
v_mfma_f32_16x16x32_bf16 v[60:63], a[36:39], a[140:143], v[60:63]
s_add_u32 m0, s61, 98304
ds_read_b128 a[64:67], v11 offset:0
v_mfma_f32_16x16x32_bf16 v[60:63], a[40:43], a[152:155], v[60:63]
s_add_u32 s63, s71, 143360
ds_read_b128 a[68:71], v11 offset:1024
v_mul_f32 v56, v80, v56
v_mfma_f32_16x16x32_bf16 v[60:63], a[44:47], v[224:227], v[60:63]
ds_read_b128 a[72:75], v11 offset:2048
v_mul_f32 v57, v80, v57
v_mfma_f32_16x16x32_bf16 v[60:63], a[48:51], a[164:167], v[60:63]
ds_read_b128 a[76:79], v11 offset:3072
v_cvt_pk_bf16_f32 v162, v56, v57
v_mfma_f32_16x16x32_bf16 v[60:63], a[52:55], a[176:179], v[60:63]
ds_read_b128 a[80:83], v11 offset:4096
v_mul_f32 v58, v80, v58
v_mfma_f32_16x16x32_bf16 v[60:63], a[56:59], v[236:239], v[60:63]
ds_read_b128 a[84:87], v11 offset:5120
v_mul_f32 v59, v80, v59
v_mfma_f32_16x16x32_bf16 v[60:63], a[60:63], v[248:251], v[60:63]
v_cvt_pk_bf16_f32 v163, v58, v59
v_mfma_f32_16x16x32_bf16 v[64:67], a[32:35], a[132:135], v[64:67]
ds_read_b64_tr_b16 a[32:33], v27 offset:0
v_mfma_f32_16x16x32_bf16 v[64:67], a[36:39], a[144:147], v[64:67]
ds_read_b64_tr_b16 a[34:35], v27 offset:2048
v_mfma_f32_16x16x32_bf16 v[64:67], a[40:43], a[156:159], v[64:67]
ds_read_b64_tr_b16 a[36:37], v27 offset:4096
v_mul_f32 v60, v81, v60
v_mfma_f32_16x16x32_bf16 v[64:67], a[44:47], v[228:231], v[64:67]
ds_read_b64_tr_b16 a[38:39], v27 offset:6144
v_mul_f32 v61, v81, v61
v_mfma_f32_16x16x32_bf16 v[64:67], a[48:51], a[168:171], v[64:67]
ds_read_b64_tr_b16 a[40:41], v27 offset:8192
v_cvt_pk_bf16_f32 v166, v60, v61
v_mfma_f32_16x16x32_bf16 v[64:67], a[52:55], a[180:183], v[64:67]
ds_read_b64_tr_b16 a[42:43], v27 offset:10240
v_mul_f32 v62, v81, v62
v_mfma_f32_16x16x32_bf16 v[64:67], a[56:59], v[240:243], v[64:67]
ds_read_b64_tr_b16 a[44:45], v27 offset:12288
v_mul_f32 v63, v81, v63
v_mfma_f32_16x16x32_bf16 v[64:67], a[60:63], v[252:255], v[64:67]
s_waitcnt lgkmcnt(6)
ds_read_b64_tr_b16 a[46:47], v27 offset:14336
v_cvt_pk_bf16_f32 v167, v62, v63
v_mfma_f32_16x16x32_bf16 v[68:71], a[0:3], a[124:127], v[68:71]
ds_read_b64_tr_b16 a[48:49], v27 offset:16384
v_mfma_f32_16x16x32_bf16 v[68:71], a[4:7], a[136:139], v[68:71]
ds_read_b64_tr_b16 a[50:51], v27 offset:18432
v_mfma_f32_16x16x32_bf16 v[68:71], a[8:11], a[148:151], v[68:71]
ds_read_b64_tr_b16 a[52:53], v27 offset:20480
v_mul_f32 v64, v82, v64
v_mfma_f32_16x16x32_bf16 v[68:71], a[12:15], v[220:223], v[68:71]
ds_read_b64_tr_b16 a[54:55], v27 offset:22528
v_mul_f32 v65, v82, v65
v_mfma_f32_16x16x32_bf16 v[68:71], a[16:19], a[160:163], v[68:71]
ds_read_b64_tr_b16 a[56:57], v27 offset:24576
v_cvt_pk_bf16_f32 v170, v64, v65
v_mfma_f32_16x16x32_bf16 v[68:71], a[20:23], a[172:175], v[68:71]
ds_read_b64_tr_b16 a[58:59], v27 offset:26624
v_mul_f32 v66, v82, v66
v_mfma_f32_16x16x32_bf16 v[68:71], a[24:27], v[232:235], v[68:71]
ds_read_b64_tr_b16 a[60:61], v27 offset:28672
v_mul_f32 v67, v82, v67
v_mfma_f32_16x16x32_bf16 v[68:71], a[28:31], v[244:247], v[68:71]
ds_read_b64_tr_b16 a[62:63], v27 offset:30720
v_cvt_pk_bf16_f32 v171, v66, v67
v_mfma_f32_16x16x32_bf16 v[72:75], a[0:3], a[128:131], v[72:75]
v_mfma_f32_16x16x32_bf16 v[72:75], a[4:7], a[140:143], v[72:75]
v_mfma_f32_16x16x32_bf16 v[72:75], a[8:11], a[152:155], v[72:75]
v_mul_f32 v68, v80, v68
v_mul_f32 v69, v80, v69
v_mfma_f32_16x16x32_bf16 v[72:75], a[12:15], v[224:227], v[72:75]
v_cvt_pk_bf16_f32 v172, v68, v69
v_mul_f32 v70, v80, v70
v_mfma_f32_16x16x32_bf16 v[72:75], a[16:19], a[164:167], v[72:75]
v_mul_f32 v71, v80, v71
v_cvt_pk_bf16_f32 v173, v70, v71
v_mfma_f32_16x16x32_bf16 v[72:75], a[20:23], a[176:179], v[72:75]
s_waitcnt vmcnt(23) lgkmcnt(0)
s_barrier
ds_read_b64_tr_b16 a[112:113], v28 offset:0
v_mfma_f32_16x16x32_bf16 v[72:75], a[24:27], v[236:239], v[72:75]
buffer_load_dwordx4 v9, s[20:23], s62 offen lds
v_mfma_f32_16x16x32_bf16 v[72:75], a[28:31], v[248:251], v[72:75]
s_add_u32 m0, s61, 102400
ds_read_b64_tr_b16 a[114:115], v28 offset:2048
v_mfma_f32_16x16x32_bf16 v[76:79], a[0:3], a[132:135], v[76:79]
s_add_u32 s62, s71, 172032
buffer_load_dwordx4 v9, s[20:23], s63 offen lds
v_mfma_f32_16x16x32_bf16 v[76:79], a[4:7], a[144:147], v[76:79]
s_add_u32 m0, s61, 106496
ds_read_b64_tr_b16 a[116:117], v28 offset:4096
v_mfma_f32_16x16x32_bf16 v[76:79], a[8:11], a[156:159], v[76:79]
s_add_u32 s63, s71, 200704
buffer_load_dwordx4 v9, s[20:23], s62 offen lds
v_mfma_f32_16x16x32_bf16 v[76:79], a[12:15], v[228:231], v[76:79]
s_add_u32 m0, s61, 110592
ds_read_b64_tr_b16 a[118:119], v28 offset:6144
v_mul_f32 v72, v81, v72
v_mfma_f32_16x16x32_bf16 v[76:79], a[16:19], a[168:171], v[76:79]
s_add_u32 s62, s71, 344064
ds_read_b64_tr_b16 a[120:121], v28 offset:8192
v_mul_f32 v73, v81, v73
v_mfma_f32_16x16x32_bf16 v[76:79], a[20:23], a[180:183], v[76:79]
ds_read_b64_tr_b16 a[122:123], v28 offset:10240
v_cvt_pk_bf16_f32 v176, v72, v73
v_mfma_f32_16x16x32_bf16 v[76:79], a[24:27], v[240:243], v[76:79]
v_mul_f32 v74, v81, v74
v_mul_f32 v75, v81, v75
v_mfma_f32_16x16x32_bf16 v[76:79], a[28:31], v[252:255], v[76:79]
buffer_load_dwordx4 v9, s[20:23], s63 offen lds
v_mfma_f32_16x16x32_bf16 v[32:35], a[32:35], a[124:127], v[32:35]
ds_read_b64_tr_b16 a[124:125], v28 offset:12288
v_cvt_pk_bf16_f32 v177, v74, v75
v_mfma_f32_16x16x32_bf16 v[32:35], a[36:39], a[136:139], v[32:35]
ds_read_b64_tr_b16 a[126:127], v28 offset:14336
v_mfma_f32_16x16x32_bf16 v[32:35], a[40:43], a[148:151], v[32:35]
ds_read_b64_tr_b16 a[136:137], v30 offset:0
v_mul_f32 v76, v82, v76
v_mfma_f32_16x16x32_bf16 v[32:35], a[44:47], v[220:223], v[32:35]
ds_read_b64_tr_b16 a[138:139], v30 offset:2048
v_mul_f32 v77, v82, v77
v_mfma_f32_16x16x32_bf16 v[32:35], a[48:51], a[160:163], v[32:35]
ds_read_b64_tr_b16 a[148:149], v30 offset:4096
v_cvt_pk_bf16_f32 v180, v76, v77
v_mfma_f32_16x16x32_bf16 v[32:35], a[52:55], a[172:175], v[32:35]
ds_read_b64_tr_b16 a[150:151], v30 offset:6144
v_mul_f32 v78, v82, v78
v_mfma_f32_16x16x32_bf16 v[32:35], a[56:59], v[232:235], v[32:35]
ds_read_b64_tr_b16 a[160:161], v30 offset:8192
v_mul_f32 v79, v82, v79
v_mfma_f32_16x16x32_bf16 v[32:35], a[60:63], v[244:247], v[32:35]
s_add_u32 m0, s61, 114688
ds_read_b64_tr_b16 a[162:163], v30 offset:10240
v_cvt_pk_bf16_f32 v181, v78, v79
v_mfma_f32_16x16x32_bf16 v[36:39], a[32:35], a[128:131], v[36:39]
s_add_u32 s63, s71, 372736
buffer_load_dwordx4 v9, s[20:23], s62 offen lds
v_mfma_f32_16x16x32_bf16 v[36:39], a[36:39], a[140:143], v[36:39]
s_add_u32 m0, s61, 118784
ds_read_b64_tr_b16 a[172:173], v30 offset:12288
v_mfma_f32_16x16x32_bf16 v[36:39], a[40:43], a[152:155], v[36:39]
s_add_u32 s62, s71, 401408
ds_read_b64_tr_b16 a[174:175], v30 offset:14336
v_mul_f32 v32, v80, v32
v_mfma_f32_16x16x32_bf16 v[36:39], a[44:47], v[224:227], v[36:39]
ds_read_b64_tr_b16 a[128:129], v29 offset:0
v_mul_f32 v33, v80, v33
v_mfma_f32_16x16x32_bf16 v[36:39], a[48:51], a[164:167], v[36:39]
ds_read_b64_tr_b16 a[130:131], v29 offset:2048
v_cvt_pk_bf16_f32 v174, v32, v33
v_mfma_f32_16x16x32_bf16 v[36:39], a[52:55], a[176:179], v[36:39]
ds_read_b64_tr_b16 a[140:141], v29 offset:4096
v_mul_f32 v34, v80, v34
v_mfma_f32_16x16x32_bf16 v[36:39], a[56:59], v[236:239], v[36:39]
ds_read_b64_tr_b16 a[142:143], v29 offset:6144
v_mul_f32 v35, v80, v35
v_mfma_f32_16x16x32_bf16 v[36:39], a[60:63], v[248:251], v[36:39]
ds_read_b64_tr_b16 a[152:153], v29 offset:8192
v_cvt_pk_bf16_f32 v175, v34, v35
v_mfma_f32_16x16x32_bf16 v[40:43], a[32:35], a[132:135], v[40:43]
ds_read_b64_tr_b16 a[154:155], v29 offset:10240
v_mfma_f32_16x16x32_bf16 v[40:43], a[36:39], a[144:147], v[40:43]
ds_read_b64_tr_b16 a[164:165], v29 offset:12288
v_mfma_f32_16x16x32_bf16 v[40:43], a[40:43], a[156:159], v[40:43]
ds_read_b64_tr_b16 a[166:167], v29 offset:14336
v_mul_f32 v36, v81, v36
v_mfma_f32_16x16x32_bf16 v[40:43], a[44:47], v[228:231], v[40:43]
ds_read_b64_tr_b16 a[132:133], v31 offset:0
v_mul_f32 v37, v81, v37
v_mfma_f32_16x16x32_bf16 v[40:43], a[48:51], a[168:171], v[40:43]
ds_read_b64_tr_b16 a[134:135], v31 offset:2048
v_cvt_pk_bf16_f32 v178, v36, v37
v_mfma_f32_16x16x32_bf16 v[40:43], a[52:55], a[180:183], v[40:43]
ds_read_b64_tr_b16 a[144:145], v31 offset:4096
v_mul_f32 v38, v81, v38
v_mfma_f32_16x16x32_bf16 v[40:43], a[56:59], v[240:243], v[40:43]
ds_read_b64_tr_b16 a[146:147], v31 offset:6144
v_mul_f32 v39, v81, v39
v_mfma_f32_16x16x32_bf16 v[40:43], a[60:63], v[252:255], v[40:43]
s_waitcnt lgkmcnt(6)
ds_read_b64_tr_b16 a[156:157], v31 offset:8192
v_cvt_pk_bf16_f32 v179, v38, v39
v_mfma_f32_16x16x32_bf16 v[184:187], a[112:115], v[88:91], 0
ds_read_b64_tr_b16 a[158:159], v31 offset:10240
v_mfma_f32_16x16x32_bf16 v[184:187], a[116:119], v[100:103], v[184:187]
ds_read_b64_tr_b16 a[168:169], v31 offset:12288
v_mfma_f32_16x16x32_bf16 v[184:187], a[120:123], v[112:115], v[184:187]
ds_read_b64_tr_b16 a[170:171], v31 offset:14336
v_mul_f32 v40, v82, v40
v_mfma_f32_16x16x32_bf16 v[184:187], a[124:127], v[124:127], v[184:187]
buffer_load_dwordx4 v9, s[20:23], s63 offen lds
v_mfma_f32_16x16x32_bf16 v[184:187], a[136:139], a[184:187], v[184:187]
v_mul_f32 v41, v82, v41
v_cvt_pk_bf16_f32 v182, v40, v41
v_mfma_f32_16x16x32_bf16 v[184:187], a[148:151], a[196:199], v[184:187]
v_mul_f32 v42, v82, v42
v_mul_f32 v43, v82, v43
v_mfma_f32_16x16x32_bf16 v[184:187], a[160:163], a[208:211], v[184:187]
v_add_u32 v28, 0x10000, v28
v_cvt_pk_bf16_f32 v183, v42, v43
v_mfma_f32_16x16x32_bf16 v[184:187], a[172:175], a[220:223], v[184:187]
s_add_u32 m0, s61, 122880
ds_write_b64 v10, v[160:161] offset:0
v_mfma_f32_16x16x32_bf16 v[188:191], a[112:115], v[92:95], 0
s_add_u32 s63, s71, 430080
ds_write_b64 v10, v[162:163] offset:8
v_mfma_f32_16x16x32_bf16 v[188:191], a[116:119], v[104:107], v[188:191]
ds_write_b64 v10, v[164:165] offset:1024
v_mfma_f32_16x16x32_bf16 v[188:191], a[120:123], v[116:119], v[188:191]
ds_write_b64 v10, v[166:167] offset:1032
v_mfma_f32_16x16x32_bf16 v[188:191], a[124:127], v[128:131], v[188:191]
ds_write_b64 v10, v[168:169] offset:2048
v_mfma_f32_16x16x32_bf16 v[188:191], a[136:139], a[188:191], v[188:191]
ds_write_b64 v10, v[170:171] offset:2056
v_mfma_f32_16x16x32_bf16 v[188:191], a[148:151], a[200:203], v[188:191]
ds_write_b64 v10, v[172:173] offset:3072
v_mfma_f32_16x16x32_bf16 v[188:191], a[160:163], a[212:215], v[188:191]
ds_write_b64 v10, v[174:175] offset:3080
v_mfma_f32_16x16x32_bf16 v[188:191], a[172:175], a[224:227], v[188:191]
ds_write_b64 v10, v[176:177] offset:4096
v_mfma_f32_16x16x32_bf16 v[192:195], a[112:115], v[96:99], 0
ds_write_b64 v10, v[178:179] offset:4104
v_mfma_f32_16x16x32_bf16 v[192:195], a[116:119], v[108:111], v[192:195]
ds_write_b64 v10, v[180:181] offset:5120
v_mfma_f32_16x16x32_bf16 v[192:195], a[120:123], v[120:123], v[192:195]
ds_write_b64 v10, v[182:183] offset:5128
v_mfma_f32_16x16x32_bf16 v[192:195], a[124:127], v[132:135], v[192:195]
buffer_load_dwordx4 v9, s[20:23], s62 offen lds
v_mfma_f32_16x16x32_bf16 v[192:195], a[136:139], a[192:195], v[192:195]
v_add_u32 v29, 0x10000, v29
v_add_u32 v30, 0x10000, v30
v_mfma_f32_16x16x32_bf16 v[192:195], a[148:151], a[204:207], v[192:195]
v_add_u32 v31, 0x10000, v31
v_mfma_f32_16x16x32_bf16 v[192:195], a[160:163], a[216:219], v[192:195]
v_mfma_f32_16x16x32_bf16 v[192:195], a[172:175], a[228:231], v[192:195]
s_waitcnt vmcnt(22) lgkmcnt(0)
s_barrier
v_mfma_f32_16x16x32_bf16 v[196:199], a[128:131], v[88:91], 0
ds_read_b64_tr_b16 a[0:1], v28 offset:0
v_mfma_f32_16x16x32_bf16 v[196:199], a[140:143], v[100:103], v[196:199]
ds_read_b64_tr_b16 a[2:3], v28 offset:2048
v_mfma_f32_16x16x32_bf16 v[196:199], a[152:155], v[112:115], v[196:199]
ds_read_b64_tr_b16 a[4:5], v28 offset:4096
v_mfma_f32_16x16x32_bf16 v[196:199], a[164:167], v[124:127], v[196:199]
ds_read_b64_tr_b16 a[6:7], v28 offset:6144
v_mfma_f32_16x16x32_bf16 v[196:199], a[132:135], a[184:187], v[196:199]
ds_read_b64_tr_b16 a[8:9], v28 offset:8192
v_mfma_f32_16x16x32_bf16 v[196:199], a[144:147], a[196:199], v[196:199]
ds_read_b64_tr_b16 a[10:11], v28 offset:10240
v_mfma_f32_16x16x32_bf16 v[196:199], a[156:159], a[208:211], v[196:199]
ds_read_b64_tr_b16 a[12:13], v28 offset:12288
v_mfma_f32_16x16x32_bf16 v[196:199], a[168:171], a[220:223], v[196:199]
s_add_u32 m0, s61, 126976
ds_read_b64_tr_b16 a[14:15], v28 offset:14336
v_mfma_f32_16x16x32_bf16 v[200:203], a[128:131], v[92:95], 0
s_add_u32 s62, s72, 0
buffer_load_dwordx4 v9, s[20:23], s63 offen lds
v_mfma_f32_16x16x32_bf16 v[200:203], a[140:143], v[104:107], v[200:203]
s_add_u32 m0, s61, 0
ds_read_b64_tr_b16 a[16:17], v30 offset:0
v_mfma_f32_16x16x32_bf16 v[200:203], a[152:155], v[116:119], v[200:203]
s_add_u32 s63, s72, 28672
buffer_load_dwordx4 v9, s[20:23], s62 offen lds
v_mfma_f32_16x16x32_bf16 v[200:203], a[164:167], v[128:131], v[200:203]
s_add_u32 m0, s61, 4096
ds_read_b64_tr_b16 a[18:19], v30 offset:2048
v_mfma_f32_16x16x32_bf16 v[200:203], a[132:135], a[188:191], v[200:203]
s_add_u32 s62, s72, 57344
buffer_load_dwordx4 v9, s[20:23], s63 offen lds
v_mfma_f32_16x16x32_bf16 v[200:203], a[144:147], a[200:203], v[200:203]
s_add_u32 m0, s61, 8192
ds_read_b64_tr_b16 a[20:21], v30 offset:4096
v_mfma_f32_16x16x32_bf16 v[200:203], a[156:159], a[212:215], v[200:203]
s_add_u32 s63, s72, 86016
ds_read_b64_tr_b16 a[22:23], v30 offset:6144
v_mfma_f32_16x16x32_bf16 v[200:203], a[168:171], a[224:227], v[200:203]
ds_read_b64_tr_b16 a[24:25], v30 offset:8192
v_mfma_f32_16x16x32_bf16 v[204:207], a[128:131], v[96:99], 0
ds_read_b64_tr_b16 a[26:27], v30 offset:10240
v_mfma_f32_16x16x32_bf16 v[204:207], a[140:143], v[108:111], v[204:207]
buffer_load_dwordx4 v9, s[20:23], s62 offen lds
v_mfma_f32_16x16x32_bf16 v[204:207], a[152:155], v[120:123], v[204:207]
s_add_u32 m0, s61, 12288
ds_read_b64_tr_b16 a[28:29], v30 offset:12288
v_mfma_f32_16x16x32_bf16 v[204:207], a[164:167], v[132:135], v[204:207]
s_add_u32 s62, s72, 229376
ds_read_b64_tr_b16 a[30:31], v30 offset:14336
v_mfma_f32_16x16x32_bf16 v[204:207], a[132:135], a[192:195], v[204:207]
ds_read_b64_tr_b16 a[32:33], v29 offset:0
v_mfma_f32_16x16x32_bf16 v[204:207], a[144:147], a[204:207], v[204:207]
buffer_load_dwordx4 v9, s[20:23], s63 offen lds
v_mfma_f32_16x16x32_bf16 v[204:207], a[156:159], a[216:219], v[204:207]
s_add_u32 m0, s61, 16384
ds_read_b64_tr_b16 a[34:35], v29 offset:2048
v_mfma_f32_16x16x32_bf16 v[204:207], a[168:171], a[228:231], v[204:207]
s_waitcnt lgkmcnt(4)
ds_read_b64_tr_b16 a[36:37], v29 offset:4096
v_mfma_f32_16x16x32_bf16 v[184:187], a[0:3], v[136:139], v[184:187]
ds_read_b64_tr_b16 a[38:39], v29 offset:6144
ds_read_b128 a[88:91], v11 offset:0
v_mfma_f32_16x16x32_bf16 v[184:187], a[4:7], v[148:151], v[184:187]
ds_read_b64_tr_b16 a[40:41], v29 offset:8192
ds_read_b128 a[100:103], v11 offset:3072
v_mfma_f32_16x16x32_bf16 v[184:187], a[8:11], v[160:163], v[184:187]
buffer_load_dwordx4 v9, s[20:23], s62 offen lds
v_mfma_f32_16x16x32_bf16 v[184:187], a[12:15], v[172:175], v[184:187]
ds_read_b64_tr_b16 a[42:43], v29 offset:10240
v_mfma_f32_16x16x32_bf16 v[184:187], a[16:19], a[64:67], v[184:187]
ds_read_b64_tr_b16 a[44:45], v29 offset:12288
v_mfma_f32_16x16x32_bf16 v[184:187], a[20:23], a[76:79], v[184:187]
s_waitcnt lgkmcnt(4)
ds_read_b64_tr_b16 a[46:47], v29 offset:14336
v_mfma_f32_16x16x32_bf16 v[184:187], a[24:27], a[88:91], v[184:187]
s_waitcnt lgkmcnt(3)
ds_read_b64_tr_b16 a[48:49], v31 offset:0
v_mfma_f32_16x16x32_bf16 v[184:187], a[28:31], a[100:103], v[184:187]
s_add_u32 m0, s61, 20480
ds_read_b64_tr_b16 a[50:51], v31 offset:2048
v_mfma_f32_16x16x32_bf16 v[188:191], a[0:3], v[140:143], v[188:191]
s_add_u32 s63, s72, 258048
ds_read_b64_tr_b16 a[52:53], v31 offset:4096
ds_read_b128 a[92:95], v11 offset:1024
v_mfma_f32_16x16x32_bf16 v[188:191], a[4:7], v[152:155], v[188:191]
s_add_u32 s62, s72, 286720
ds_read_b64_tr_b16 a[54:55], v31 offset:6144
ds_read_b128 a[104:107], v11 offset:4096
v_mfma_f32_16x16x32_bf16 v[188:191], a[8:11], v[164:167], v[188:191]
ds_read_b64_tr_b16 a[56:57], v31 offset:8192
v_cvt_pk_bf16_f32 v68, v184, v185
v_mfma_f32_16x16x32_bf16 v[188:191], a[12:15], v[176:179], v[188:191]
ds_read_b64_tr_b16 a[58:59], v31 offset:10240
v_cvt_pk_bf16_f32 v69, v186, v187
v_mfma_f32_16x16x32_bf16 v[188:191], a[16:19], a[68:71], v[188:191]
ds_read_b64_tr_b16 a[60:61], v31 offset:12288
v_mfma_f32_16x16x32_bf16 v[188:191], a[20:23], a[80:83], v[188:191]
s_waitcnt lgkmcnt(5)
ds_read_b64_tr_b16 a[62:63], v31 offset:14336
v_add_u32 v28, 0x10000, v28
v_mfma_f32_16x16x32_bf16 v[188:191], a[24:27], a[92:95], v[188:191]
s_waitcnt lgkmcnt(4)
buffer_load_dwordx4 v9, s[20:23], s63 offen lds
v_mfma_f32_16x16x32_bf16 v[188:191], a[28:31], a[104:107], v[188:191]
s_add_u32 m0, s61, 24576
ds_read_b128 a[96:99], v11 offset:2048
v_add_u32 v29, 0x10000, v29
v_mfma_f32_16x16x32_bf16 v[192:195], a[0:3], v[144:147], v[192:195]
s_add_u32 s63, s72, 315392
buffer_load_dwordx4 v9, s[20:23], s62 offen lds
v_mfma_f32_16x16x32_bf16 v[192:195], a[4:7], v[156:159], v[192:195]
s_add_u32 m0, s61, 28672
ds_read_b128 a[108:111], v11 offset:5120
v_add_u32 v30, 0x10000, v30
v_mfma_f32_16x16x32_bf16 v[192:195], a[8:11], v[168:171], v[192:195]
s_add_u32 s62, s72, 114688
buffer_load_dwordx4 v9, s[20:23], s63 offen lds
v_mfma_f32_16x16x32_bf16 v[192:195], a[12:15], v[180:183], v[192:195]
v_cvt_pk_bf16_f32 v72, v188, v189
v_cvt_pk_bf16_f32 v73, v190, v191
v_mfma_f32_16x16x32_bf16 v[192:195], a[16:19], a[72:75], v[192:195]
v_add_u32 v31, 0x10000, v31
v_mfma_f32_16x16x32_bf16 v[192:195], a[20:23], a[84:87], v[192:195]
s_waitcnt vmcnt(16) lgkmcnt(0)
s_barrier
v_mfma_f32_16x16x32_bf16 v[192:195], a[24:27], a[96:99], v[192:195]
ds_read_b64_tr_b16 a[112:113], v28 offset:0
v_mfma_f32_16x16x32_bf16 v[192:195], a[28:31], a[108:111], v[192:195]
ds_read_b64_tr_b16 a[114:115], v28 offset:2048
v_mfma_f32_16x16x32_bf16 v[196:199], a[32:35], v[136:139], v[196:199]
ds_read_b64_tr_b16 a[116:117], v28 offset:4096
v_mfma_f32_16x16x32_bf16 v[196:199], a[36:39], v[148:151], v[196:199]
ds_read_b64_tr_b16 a[118:119], v28 offset:6144
v_mfma_f32_16x16x32_bf16 v[196:199], a[40:43], v[160:163], v[196:199]
ds_read_b64_tr_b16 a[120:121], v28 offset:8192
v_cvt_pk_bf16_f32 v76, v192, v193
v_mfma_f32_16x16x32_bf16 v[196:199], a[44:47], v[172:175], v[196:199]
ds_read_b64_tr_b16 a[122:123], v28 offset:10240
v_cvt_pk_bf16_f32 v77, v194, v195
v_mfma_f32_16x16x32_bf16 v[196:199], a[48:51], a[64:67], v[196:199]
ds_read_b64_tr_b16 a[124:125], v28 offset:12288
v_mfma_f32_16x16x32_bf16 v[196:199], a[52:55], a[76:79], v[196:199]
ds_read_b64_tr_b16 a[126:127], v28 offset:14336
v_mfma_f32_16x16x32_bf16 v[196:199], a[56:59], a[88:91], v[196:199]
ds_read_b64_tr_b16 a[136:137], v30 offset:0
v_mfma_f32_16x16x32_bf16 v[196:199], a[60:63], a[100:103], v[196:199]
s_add_u32 m0, s61, 32768
ds_read_b64_tr_b16 a[138:139], v30 offset:2048
v_mfma_f32_16x16x32_bf16 v[200:203], a[32:35], v[140:143], v[200:203]
s_add_u32 s63, s72, 143360
buffer_load_dwordx4 v9, s[20:23], s62 offen lds
v_mfma_f32_16x16x32_bf16 v[200:203], a[36:39], v[152:155], v[200:203]
s_add_u32 m0, s61, 36864
ds_read_b64_tr_b16 a[148:149], v30 offset:4096
v_mfma_f32_16x16x32_bf16 v[200:203], a[40:43], v[164:167], v[200:203]
s_add_u32 s62, s72, 172032
buffer_load_dwordx4 v9, s[20:23], s63 offen lds
v_mfma_f32_16x16x32_bf16 v[200:203], a[44:47], v[176:179], v[200:203]
s_add_u32 m0, s61, 40960
ds_read_b64_tr_b16 a[150:151], v30 offset:6144
v_cvt_pk_bf16_f32 v70, v196, v197
v_mfma_f32_16x16x32_bf16 v[200:203], a[48:51], a[68:71], v[200:203]
s_add_u32 s63, s72, 200704
buffer_load_dwordx4 v9, s[20:23], s62 offen lds
v_mfma_f32_16x16x32_bf16 v[200:203], a[52:55], a[80:83], v[200:203]
s_add_u32 m0, s61, 45056
ds_read_b64_tr_b16 a[160:161], v30 offset:8192
v_cvt_pk_bf16_f32 v71, v198, v199
v_mfma_f32_16x16x32_bf16 v[200:203], a[56:59], a[92:95], v[200:203]
s_add_u32 s62, s72, 344064
ds_read_b64_tr_b16 a[162:163], v30 offset:10240
v_mfma_f32_16x16x32_bf16 v[200:203], a[60:63], a[104:107], v[200:203]
ds_read_b64_tr_b16 a[172:173], v30 offset:12288
v_mfma_f32_16x16x32_bf16 v[204:207], a[32:35], v[144:147], v[204:207]
ds_read_b64_tr_b16 a[174:175], v30 offset:14336
v_mfma_f32_16x16x32_bf16 v[204:207], a[36:39], v[156:159], v[204:207]
buffer_load_dwordx4 v9, s[20:23], s63 offen lds
v_mfma_f32_16x16x32_bf16 v[204:207], a[40:43], v[168:171], v[204:207]
s_add_u32 m0, s61, 49152
ds_read_b64_tr_b16 a[128:129], v29 offset:0
v_cvt_pk_bf16_f32 v74, v200, v201
v_mfma_f32_16x16x32_bf16 v[204:207], a[44:47], v[180:183], v[204:207]
s_add_u32 s63, s72, 372736
ds_read_b64_tr_b16 a[130:131], v29 offset:2048
v_cvt_pk_bf16_f32 v75, v202, v203
v_mfma_f32_16x16x32_bf16 v[204:207], a[48:51], a[72:75], v[204:207]
ds_read_b64_tr_b16 a[140:141], v29 offset:4096
v_mfma_f32_16x16x32_bf16 v[204:207], a[52:55], a[84:87], v[204:207]
buffer_load_dwordx4 v9, s[20:23], s62 offen lds
v_mfma_f32_16x16x32_bf16 v[204:207], a[56:59], a[96:99], v[204:207]
s_add_u32 m0, s61, 53248
ds_read_b64_tr_b16 a[142:143], v29 offset:6144
v_mfma_f32_16x16x32_bf16 v[204:207], a[60:63], a[108:111], v[204:207]
s_waitcnt lgkmcnt(4)
ds_read_b64_tr_b16 a[152:153], v29 offset:8192
v_mfma_f32_16x16x32_bf16 v[208:211], a[112:115], v[88:91], 0
ds_read_b64_tr_b16 a[154:155], v29 offset:10240
v_mfma_f32_16x16x32_bf16 v[208:211], a[116:119], v[100:103], v[208:211]
ds_read_b64_tr_b16 a[164:165], v29 offset:12288
v_mfma_f32_16x16x32_bf16 v[208:211], a[120:123], v[112:115], v[208:211]
ds_read_b64_tr_b16 a[166:167], v29 offset:14336
v_cvt_pk_bf16_f32 v78, v204, v205
v_mfma_f32_16x16x32_bf16 v[208:211], a[124:127], v[124:127], v[208:211]
ds_read_b64_tr_b16 a[132:133], v31 offset:0
v_cvt_pk_bf16_f32 v79, v206, v207
v_mfma_f32_16x16x32_bf16 v[208:211], a[136:139], a[184:187], v[208:211]
buffer_store_dwordx4 v[68:71], v12, s[28:31], s77 offen offset:0 sc1
v_mfma_f32_16x16x32_bf16 v[208:211], a[148:151], a[196:199], v[208:211]
ds_read_b64_tr_b16 a[134:135], v31 offset:2048
v_bfe_u32 v62, v2, 2, 2
v_mfma_f32_16x16x32_bf16 v[208:211], a[160:163], a[208:211], v[208:211]
ds_read_b64_tr_b16 a[144:145], v31 offset:4096
v_lshrrev_b32 v63, 4, v2
v_mfma_f32_16x16x32_bf16 v[208:211], a[172:175], a[220:223], v[208:211]
s_add_u32 s62, s72, 401408
ds_read_b64_tr_b16 a[146:147], v31 offset:6144
v_cmp_eq_u32 vcc, v62, v63
v_mfma_f32_16x16x32_bf16 v[212:215], a[112:115], v[92:95], 0
s_mul_i32 s94, s59, 7
ds_read_b64_tr_b16 a[156:157], v31 offset:8192
v_and_b32 v62, 1, v2
v_mfma_f32_16x16x32_bf16 v[212:215], a[116:119], v[104:107], v[212:215]
s_add_u32 s94, s94, s60
ds_read_b64_tr_b16 a[158:159], v31 offset:10240
v_lshlrev_b32 v62, 4, v62
v_mfma_f32_16x16x32_bf16 v[212:215], a[120:123], v[116:119], v[212:215]
s_mul_i32 s94, s94, 98304
ds_read_b64_tr_b16 a[168:169], v31 offset:12288
v_mov_b32 v63, 0x3f80
v_mfma_f32_16x16x32_bf16 v[212:215], a[124:127], v[128:131], v[212:215]
s_cmp_eq_u32 s60, 7
s_cselect_b32 s94, 0x7ff00000, s94
ds_read_b64_tr_b16 a[170:171], v31 offset:14336
v_add_u32 v28, 0xffff8000, v28
v_mfma_f32_16x16x32_bf16 v[212:215], a[136:139], a[188:191], v[212:215]
s_mul_i32 s70, s70, 96
v_add_u32 v29, 0xffff8000, v29
v_add_u32 v30, 0xffff8000, v30
v_mfma_f32_16x16x32_bf16 v[212:215], a[148:151], a[200:203], v[212:215]
s_mul_i32 s71, s71, 96
v_add_u32 v31, 0xffff8000, v31
v_lshlrev_b32 v62, v62, v63
v_mfma_f32_16x16x32_bf16 v[212:215], a[160:163], a[212:215], v[212:215]
s_lshl_b32 s95, s60, 6
v_cndmask_b32 v62, 0, v62, vcc
v_and_b32 v63, 2, v2
v_mfma_f32_16x16x32_bf16 v[212:215], a[172:175], a[224:227], v[212:215]
s_add_u32 s70, s70, s94
v_mov_b32 v56, 0
v_cmp_eq_u32 vcc, 0, v63
v_mfma_f32_16x16x32_bf16 v[216:219], a[112:115], v[96:99], 0
s_add_u32 s71, s71, s94
buffer_store_dwordx4 v[72:75], v12, s[28:31], s77 offen offset:1024 sc1
v_mfma_f32_16x16x32_bf16 v[216:219], a[116:119], v[108:111], v[216:219]
s_waitcnt vmcnt(15) lgkmcnt(0)
s_barrier
ds_read_b64_tr_b16 a[0:1], v28 offset:0
v_mfma_f32_16x16x32_bf16 v[216:219], a[120:123], v[120:123], v[216:219]
s_mov_b32 s64, 14336
ds_read_b64_tr_b16 a[2:3], v28 offset:2048
v_mov_b32 v57, 0
v_mfma_f32_16x16x32_bf16 v[216:219], a[124:127], v[132:135], v[216:219]
s_mov_b32 s65, 28672
ds_read_b64_tr_b16 a[4:5], v28 offset:4096
v_mov_b32 v60, 0
v_mfma_f32_16x16x32_bf16 v[216:219], a[136:139], a[192:195], v[216:219]
ds_read_b64_tr_b16 a[6:7], v28 offset:6144
v_mov_b32 v61, 0
v_mfma_f32_16x16x32_bf16 v[216:219], a[148:151], a[204:207], v[216:219]
ds_read_b64_tr_b16 a[8:9], v28 offset:8192
v_cndmask_b32 v58, 0, v62, vcc
v_mfma_f32_16x16x32_bf16 v[216:219], a[160:163], a[216:219], v[216:219]
ds_read_b64_tr_b16 a[10:11], v28 offset:10240
v_sub_u32 v59, v62, v58
v_mfma_f32_16x16x32_bf16 v[216:219], a[172:175], a[228:231], v[216:219]
ds_read_b64_tr_b16 a[12:13], v28 offset:12288
v_and_b32 v3, 7, v2
v_mfma_f32_16x16x32_bf16 v[220:223], a[128:131], v[88:91], 0
ds_read_b64_tr_b16 a[14:15], v28 offset:14336
v_lshlrev_b32 v3, 3, v3
v_mfma_f32_16x16x32_bf16 v[220:223], a[140:143], v[100:103], v[220:223]
ds_read_b64_tr_b16 a[16:17], v30 offset:0
v_and_b32 v80, 15, v2
v_mfma_f32_16x16x32_bf16 v[220:223], a[152:155], v[112:115], v[220:223]
ds_read_b64_tr_b16 a[18:19], v30 offset:2048
v_lshrrev_b32 v81, 4, v2
v_mfma_f32_16x16x32_bf16 v[220:223], a[164:167], v[124:127], v[220:223]
ds_read_b64_tr_b16 a[20:21], v30 offset:4096
v_mfma_f32_16x16x32_bf16 v[220:223], a[132:135], a[184:187], v[220:223]
ds_read_b64_tr_b16 a[22:23], v30 offset:6144
v_mfma_f32_16x16x32_bf16 v[220:223], a[144:147], a[196:199], v[220:223]
ds_read_b64_tr_b16 a[24:25], v30 offset:8192
v_mfma_f32_16x16x32_bf16 v[220:223], a[156:159], a[208:211], v[220:223]
buffer_store_dwordx4 v[76:79], v12, s[28:31], s77 offen offset:2048 sc1
v_mfma_f32_16x16x32_bf16 v[220:223], a[168:171], a[220:223], v[220:223]
s_mul_i32 s66, s58, 48
ds_read_b64_tr_b16 a[26:27], v30 offset:10240
v_mfma_f32_16x16x32_bf16 v[224:227], a[128:131], v[92:95], 0
ds_read_b64_tr_b16 a[28:29], v30 offset:12288
v_add_u32 v80, s66, v80
v_mfma_f32_16x16x32_bf16 v[224:227], a[140:143], v[104:107], v[224:227]
ds_read_b64_tr_b16 a[30:31], v30 offset:14336
v_mul_u32_u24 v80, 896, v80
v_mfma_f32_16x16x32_bf16 v[224:227], a[152:155], v[116:119], v[224:227]
ds_read_b64_tr_b16 a[32:33], v29 offset:0
v_lshl_add_u32 v80, v81, 3, v80
v_mfma_f32_16x16x32_bf16 v[224:227], a[164:167], v[128:131], v[224:227]
s_lshl_b32 s66, s60, 1
ds_read_b64_tr_b16 a[34:35], v29 offset:2048
v_mfma_f32_16x16x32_bf16 v[224:227], a[132:135], a[188:191], v[224:227]
s_add_u32 s66, s66, s57
ds_read_b64_tr_b16 a[36:37], v29 offset:4096
v_mfma_f32_16x16x32_bf16 v[224:227], a[144:147], a[200:203], v[224:227]
s_lshl_b32 s66, s66, 6
ds_read_b64_tr_b16 a[38:39], v29 offset:6144
v_mfma_f32_16x16x32_bf16 v[224:227], a[156:159], a[212:215], v[224:227]
ds_read_b64_tr_b16 a[40:41], v29 offset:8192
v_add_u32 v82, s66, v80
v_mfma_f32_16x16x32_bf16 v[224:227], a[168:171], a[224:227], v[224:227]
ds_read_b64_tr_b16 a[42:43], v29 offset:10240
v_mfma_f32_16x16x32_bf16 v[228:231], a[128:131], v[96:99], 0
ds_read_b64_tr_b16 a[44:45], v29 offset:12288
v_mfma_f32_16x16x32_bf16 v[228:231], a[140:143], v[108:111], v[228:231]
ds_read_b64_tr_b16 a[46:47], v29 offset:14336
v_mfma_f32_16x16x32_bf16 v[228:231], a[152:155], v[120:123], v[228:231]
ds_read_b64_tr_b16 a[48:49], v31 offset:0
v_mfma_f32_16x16x32_bf16 v[228:231], a[164:167], v[132:135], v[228:231]
ds_read_b64_tr_b16 a[50:51], v31 offset:2048
v_mfma_f32_16x16x32_bf16 v[228:231], a[132:135], a[192:195], v[228:231]
buffer_load_dwordx4 v9, s[20:23], s63 offen lds
v_mfma_f32_16x16x32_bf16 v[228:231], a[144:147], a[204:207], v[228:231]
s_add_u32 m0, s61, 57344
ds_read_b64_tr_b16 a[52:53], v31 offset:4096
v_mfma_f32_16x16x32_bf16 v[228:231], a[156:159], a[216:219], v[228:231]
s_add_u32 s63, s72, 430080
ds_read_b64_tr_b16 a[54:55], v31 offset:6144
v_mfma_f32_16x16x32_bf16 v[228:231], a[168:171], a[228:231], v[228:231]
s_waitcnt lgkmcnt(5)
ds_read_b64_tr_b16 a[56:57], v31 offset:8192
v_mfma_f32_16x16x32_bf16 v[208:211], a[0:3], v[136:139], v[208:211]
buffer_load_dwordx4 v9, s[20:23], s62 offen lds
v_mfma_f32_16x16x32_bf16 v[208:211], a[4:7], v[148:151], v[208:211]
ds_read_b64_tr_b16 a[58:59], v31 offset:10240
v_mfma_f32_16x16x32_bf16 v[208:211], a[8:11], v[160:163], v[208:211]
ds_read_b64_tr_b16 a[60:61], v31 offset:12288
v_mfma_f32_16x16x32_bf16 v[208:211], a[12:15], v[172:175], v[208:211]
ds_read_b64_tr_b16 a[62:63], v31 offset:14336
v_add_u32 v28, 0xfffe8000, v28
v_mfma_f32_16x16x32_bf16 v[208:211], a[16:19], a[64:67], v[208:211]
v_add_u32 v29, 0xfffe8000, v29
v_add_u32 v30, 0xfffe8000, v30
v_mfma_f32_16x16x32_bf16 v[208:211], a[20:23], a[76:79], v[208:211]
v_add_u32 v31, 0xfffe8000, v31
v_mfma_f32_16x16x32_bf16 v[208:211], a[24:27], a[88:91], v[208:211]
v_mfma_f32_16x16x32_bf16 v[208:211], a[28:31], a[100:103], v[208:211]
s_add_u32 m0, s61, 61440
v_mfma_f32_16x16x32_bf16 v[212:215], a[0:3], v[140:143], v[212:215]
s_add_u32 s62, s73, 0
buffer_load_dwordx4 v9, s[20:23], s63 offen lds
v_mfma_f32_16x16x32_bf16 v[212:215], a[4:7], v[152:155], v[212:215]
s_add_u32 m0, s61, 65536
v_mfma_f32_16x16x32_bf16 v[212:215], a[8:11], v[164:167], v[212:215]
s_add_u32 s63, s73, 28672
buffer_load_dwordx4 v9, s[20:23], s62 offen lds
v_mfma_f32_16x16x32_bf16 v[212:215], a[12:15], v[176:179], v[212:215]
s_add_u32 m0, s61, 69632
v_cvt_pk_bf16_f32 v32, v208, v209
v_cvt_pk_bf16_f32 v33, v210, v211
v_mfma_f32_16x16x32_bf16 v[212:215], a[16:19], a[68:71], v[212:215]
s_add_u32 s62, s73, 57344
v_mfma_f32_16x16x32_bf16 v[212:215], a[20:23], a[80:83], v[212:215]
s_mul_i32 s72, s72, 96
v_mfma_f32_16x16x32_bf16 v[212:215], a[24:27], a[92:95], v[212:215]
s_add_u32 s72, s72, s94
buffer_load_dwordx4 v9, s[20:23], s63 offen lds
v_mfma_f32_16x16x32_bf16 v[212:215], a[28:31], a[104:107], v[212:215]
s_add_u32 m0, s61, 73728
v_mfma_f32_16x16x32_bf16 v[216:219], a[0:3], v[144:147], v[216:219]
s_add_u32 s63, s73, 86016
v_mfma_f32_16x16x32_bf16 v[216:219], a[4:7], v[156:159], v[216:219]
v_mfma_f32_16x16x32_bf16 v[216:219], a[8:11], v[168:171], v[216:219]
buffer_load_dwordx4 v9, s[20:23], s62 offen lds
v_mfma_f32_16x16x32_bf16 v[216:219], a[12:15], v[180:183], v[216:219]
s_add_u32 m0, s61, 77824
v_cvt_pk_bf16_f32 v36, v212, v213
v_cvt_pk_bf16_f32 v37, v214, v215
v_mfma_f32_16x16x32_bf16 v[216:219], a[16:19], a[72:75], v[216:219]
s_add_u32 s62, s73, 229376
v_mfma_f32_16x16x32_bf16 v[216:219], a[20:23], a[84:87], v[216:219]
v_mfma_f32_16x16x32_bf16 v[216:219], a[24:27], a[96:99], v[216:219]
s_waitcnt vmcnt(6) lgkmcnt(0)
s_barrier
ds_read_b64_tr_b16 a[112:113], v28 offset:0
v_mfma_f32_16x16x32_bf16 v[216:219], a[28:31], a[108:111], v[216:219]
buffer_store_dwordx2 v[14:15], v13, s[36:39], s86 offen sc1
v_mfma_f32_16x16x32_bf16 v[220:223], a[32:35], v[136:139], v[220:223]
buffer_load_dwordx4 v9, s[20:23], s63 offen lds
v_mfma_f32_16x16x32_bf16 v[220:223], a[36:39], v[148:151], v[220:223]
ds_read_b64_tr_b16 a[114:115], v28 offset:2048
v_mfma_f32_16x16x32_bf16 v[220:223], a[40:43], v[160:163], v[220:223]
ds_read_b64_tr_b16 a[116:117], v28 offset:4096
v_cvt_pk_bf16_f32 v40, v216, v217
v_mfma_f32_16x16x32_bf16 v[220:223], a[44:47], v[172:175], v[220:223]
ds_read_b64_tr_b16 a[118:119], v28 offset:6144
v_cvt_pk_bf16_f32 v41, v218, v219
v_mfma_f32_16x16x32_bf16 v[220:223], a[48:51], a[64:67], v[220:223]
ds_read_b64_tr_b16 a[120:121], v28 offset:8192
v_mfma_f32_16x16x32_bf16 v[220:223], a[52:55], a[76:79], v[220:223]
ds_read_b64_tr_b16 a[122:123], v28 offset:10240
v_mfma_f32_16x16x32_bf16 v[220:223], a[56:59], a[88:91], v[220:223]
ds_read_b64_tr_b16 a[124:125], v28 offset:12288
v_mfma_f32_16x16x32_bf16 v[220:223], a[60:63], a[100:103], v[220:223]
s_add_u32 m0, s61, 81920
ds_read_b64_tr_b16 a[126:127], v28 offset:14336
v_mfma_f32_16x16x32_bf16 v[224:227], a[32:35], v[140:143], v[224:227]
s_add_u32 s63, s73, 258048
buffer_load_dwordx4 v9, s[20:23], s62 offen lds
v_mfma_f32_16x16x32_bf16 v[224:227], a[36:39], v[152:155], v[224:227]
s_add_u32 m0, s61, 86016
ds_read_b64_tr_b16 a[136:137], v30 offset:0
v_mfma_f32_16x16x32_bf16 v[224:227], a[40:43], v[164:167], v[224:227]
s_add_u32 s62, s73, 286720
buffer_load_dwordx4 v9, s[20:23], s63 offen lds
v_mfma_f32_16x16x32_bf16 v[224:227], a[44:47], v[176:179], v[224:227]
s_add_u32 m0, s61, 90112
ds_read_b64_tr_b16 a[138:139], v30 offset:2048
v_cvt_pk_bf16_f32 v34, v220, v221
v_mfma_f32_16x16x32_bf16 v[224:227], a[48:51], a[68:71], v[224:227]
s_add_u32 s63, s73, 315392
buffer_load_dwordx4 v9, s[20:23], s62 offen lds
v_mfma_f32_16x16x32_bf16 v[224:227], a[52:55], a[80:83], v[224:227]
s_add_u32 m0, s61, 94208
ds_read_b64_tr_b16 a[148:149], v30 offset:4096
v_cvt_pk_bf16_f32 v35, v222, v223
v_mfma_f32_16x16x32_bf16 v[224:227], a[56:59], a[92:95], v[224:227]
s_add_u32 s62, s73, 114688
ds_read_b64_tr_b16 a[150:151], v30 offset:6144
v_mfma_f32_16x16x32_bf16 v[224:227], a[60:63], a[104:107], v[224:227]
ds_read_b64_tr_b16 a[160:161], v30 offset:8192
v_mfma_f32_16x16x32_bf16 v[228:231], a[32:35], v[144:147], v[228:231]
ds_read_b64_tr_b16 a[162:163], v30 offset:10240
v_mfma_f32_16x16x32_bf16 v[228:231], a[36:39], v[156:159], v[228:231]
buffer_load_dwordx4 v9, s[20:23], s63 offen lds
v_mfma_f32_16x16x32_bf16 v[228:231], a[40:43], v[168:171], v[228:231]
s_add_u32 m0, s61, 131072
ds_read_b64_tr_b16 a[172:173], v30 offset:12288
v_cvt_pk_bf16_f32 v38, v224, v225
v_mfma_f32_16x16x32_bf16 v[228:231], a[44:47], v[180:183], v[228:231]
s_add_u32 s63, s73, 143360
ds_read_b64_tr_b16 a[174:175], v30 offset:14336
v_cvt_pk_bf16_f32 v39, v226, v227
v_mfma_f32_16x16x32_bf16 v[228:231], a[48:51], a[72:75], v[228:231]
ds_read_b64_tr_b16 a[128:129], v29 offset:0
v_mfma_f32_16x16x32_bf16 v[228:231], a[52:55], a[84:87], v[228:231]
buffer_load_dwordx4 v9, s[20:23], s62 offen lds
v_mfma_f32_16x16x32_bf16 v[228:231], a[56:59], a[96:99], v[228:231]
s_add_u32 m0, s61, 135168
ds_read_b64_tr_b16 a[130:131], v29 offset:2048
v_mfma_f32_16x16x32_bf16 v[228:231], a[60:63], a[108:111], v[228:231]
s_waitcnt lgkmcnt(4)
ds_read_b64_tr_b16 a[140:141], v29 offset:4096
v_mfma_f32_16x16x32_bf16 v[184:187], a[112:115], v[88:91], 0
ds_read_b64_tr_b16 a[142:143], v29 offset:6144
v_mfma_f32_16x16x32_bf16 v[184:187], a[116:119], v[100:103], v[184:187]
ds_read_b64_tr_b16 a[152:153], v29 offset:8192
v_mfma_f32_16x16x32_bf16 v[184:187], a[120:123], v[112:115], v[184:187]
buffer_load_dwordx4 v9, s[20:23], s63 offen lds
v_mfma_f32_16x16x32_bf16 v[184:187], a[124:127], v[124:127], v[184:187]
ds_read_b64_tr_b16 a[154:155], v29 offset:10240
v_cvt_pk_bf16_f32 v42, v228, v229
v_mfma_f32_16x16x32_bf16 v[184:187], a[136:139], a[184:187], v[184:187]
ds_read_b64_tr_b16 a[164:165], v29 offset:12288
v_cvt_pk_bf16_f32 v43, v230, v231
v_mfma_f32_16x16x32_bf16 v[184:187], a[148:151], a[196:199], v[184:187]
ds_read_b64_tr_b16 a[166:167], v29 offset:14336
v_mfma_f32_16x16x32_bf16 v[184:187], a[160:163], a[208:211], v[184:187]
s_waitcnt lgkmcnt(5)
buffer_store_dwordx4 v[32:35], v12, s[28:31], s78 offen offset:0 sc1
v_mfma_f32_16x16x32_bf16 v[184:187], a[172:175], a[220:223], v[184:187]
s_add_u32 m0, s61, 139264
ds_read_b64_tr_b16 a[132:133], v31 offset:0
v_mfma_f32_16x16x32_bf16 v[188:191], a[112:115], v[92:95], 0
s_add_u32 s62, s73, 172032
ds_read_b64_tr_b16 a[134:135], v31 offset:2048
v_mfma_f32_16x16x32_bf16 v[188:191], a[116:119], v[104:107], v[188:191]
s_add_u32 s63, s73, 200704
ds_read_b64_tr_b16 a[144:145], v31 offset:4096
v_mfma_f32_16x16x32_bf16 v[188:191], a[120:123], v[116:119], v[188:191]
ds_read_b64_tr_b16 a[146:147], v31 offset:6144
v_mfma_f32_16x16x32_bf16 v[188:191], a[124:127], v[128:131], v[188:191]
ds_read_b64_tr_b16 a[156:157], v31 offset:8192
v_mfma_f32_16x16x32_bf16 v[188:191], a[136:139], a[188:191], v[188:191]
ds_read_b64_tr_b16 a[158:159], v31 offset:10240
v_mfma_f32_16x16x32_bf16 v[188:191], a[148:151], a[200:203], v[188:191]
ds_read_b64_tr_b16 a[168:169], v31 offset:12288
v_mfma_f32_16x16x32_bf16 v[188:191], a[160:163], a[212:215], v[188:191]
ds_read_b64_tr_b16 a[170:171], v31 offset:14336
v_mfma_f32_16x16x32_bf16 v[188:191], a[172:175], a[224:227], v[188:191]
v_mfma_f32_16x16x32_bf16 v[192:195], a[112:115], v[96:99], 0
v_mfma_f32_16x16x32_bf16 v[192:195], a[116:119], v[108:111], v[192:195]
v_mfma_f32_16x16x32_bf16 v[192:195], a[120:123], v[120:123], v[192:195]
v_mfma_f32_16x16x32_bf16 v[192:195], a[124:127], v[132:135], v[192:195]
v_mfma_f32_16x16x32_bf16 v[192:195], a[136:139], a[192:195], v[192:195]
s_waitcnt vmcnt(12) lgkmcnt(0)
s_barrier
ds_read_b64_tr_b16 a[0:1], v28 offset:32768
v_mfma_f32_16x16x32_bf16 v[192:195], a[148:151], a[204:207], v[192:195]
buffer_load_dwordx4 v9, s[20:23], s62 offen lds
v_mfma_f32_16x16x32_bf16 v[192:195], a[160:163], a[216:219], v[192:195]
s_add_u32 m0, s61, 143360
ds_read_b64_tr_b16 a[2:3], v28 offset:34816
v_mfma_f32_16x16x32_bf16 v[192:195], a[172:175], a[228:231], v[192:195]
ds_read_b64_tr_b16 a[4:5], v28 offset:36864
v_mfma_f32_16x16x32_bf16 v[196:199], a[128:131], v[88:91], 0
ds_read_b64_tr_b16 a[6:7], v28 offset:38912
v_mfma_f32_16x16x32_bf16 v[196:199], a[140:143], v[100:103], v[196:199]
buffer_load_dwordx4 v9, s[20:23], s63 offen lds
v_mfma_f32_16x16x32_bf16 v[196:199], a[152:155], v[112:115], v[196:199]
ds_read_b64_tr_b16 a[8:9], v28 offset:40960
v_mfma_f32_16x16x32_bf16 v[196:199], a[164:167], v[124:127], v[196:199]
ds_read_b64_tr_b16 a[10:11], v28 offset:43008
v_mfma_f32_16x16x32_bf16 v[196:199], a[132:135], a[184:187], v[196:199]
ds_read_b64_tr_b16 a[12:13], v28 offset:45056
v_mfma_f32_16x16x32_bf16 v[196:199], a[144:147], a[196:199], v[196:199]
buffer_store_dwordx4 v[36:39], v12, s[28:31], s78 offen offset:1024 sc1
v_mfma_f32_16x16x32_bf16 v[196:199], a[156:159], a[208:211], v[196:199]
ds_read_b64_tr_b16 a[14:15], v28 offset:47104
v_mfma_f32_16x16x32_bf16 v[196:199], a[168:171], a[220:223], v[196:199]
s_add_u32 m0, s61, 147456
ds_read_b64_tr_b16 a[16:17], v30 offset:32768
v_mfma_f32_16x16x32_bf16 v[200:203], a[128:131], v[92:95], 0
s_add_u32 s62, s73, 344064
ds_read_b64_tr_b16 a[18:19], v30 offset:34816
v_mfma_f32_16x16x32_bf16 v[200:203], a[140:143], v[104:107], v[200:203]
s_add_u32 s63, s73, 372736
ds_read_b64_tr_b16 a[20:21], v30 offset:36864
v_mfma_f32_16x16x32_bf16 v[200:203], a[152:155], v[116:119], v[200:203]
ds_read_b64_tr_b16 a[22:23], v30 offset:38912
v_mfma_f32_16x16x32_bf16 v[200:203], a[164:167], v[128:131], v[200:203]
ds_read_b64_tr_b16 a[24:25], v30 offset:40960
v_mfma_f32_16x16x32_bf16 v[200:203], a[132:135], a[188:191], v[200:203]
ds_read_b64_tr_b16 a[26:27], v30 offset:43008
v_mfma_f32_16x16x32_bf16 v[200:203], a[144:147], a[200:203], v[200:203]
buffer_store_dwordx4 v[40:43], v12, s[28:31], s78 offen offset:2048 sc1
v_mfma_f32_16x16x32_bf16 v[200:203], a[156:159], a[212:215], v[200:203]
ds_read_b64_tr_b16 a[28:29], v30 offset:45056
v_mfma_f32_16x16x32_bf16 v[200:203], a[168:171], a[224:227], v[200:203]
ds_read_b64_tr_b16 a[30:31], v30 offset:47104
v_mfma_f32_16x16x32_bf16 v[204:207], a[128:131], v[96:99], 0
ds_read_b64_tr_b16 a[32:33], v29 offset:32768
v_mfma_f32_16x16x32_bf16 v[204:207], a[140:143], v[108:111], v[204:207]
ds_read_b64_tr_b16 a[34:35], v29 offset:34816
v_mfma_f32_16x16x32_bf16 v[204:207], a[152:155], v[120:123], v[204:207]
buffer_load_dwordx4 v9, s[20:23], s62 offen lds
v_mfma_f32_16x16x32_bf16 v[204:207], a[164:167], v[132:135], v[204:207]
s_add_u32 m0, s61, 151552
ds_read_b64_tr_b16 a[36:37], v29 offset:36864
v_mfma_f32_16x16x32_bf16 v[204:207], a[132:135], a[192:195], v[204:207]
s_add_u32 s62, s73, 401408
ds_read_b64_tr_b16 a[38:39], v29 offset:38912
v_mfma_f32_16x16x32_bf16 v[204:207], a[144:147], a[204:207], v[204:207]
ds_read_b64_tr_b16 a[40:41], v29 offset:40960
v_mfma_f32_16x16x32_bf16 v[204:207], a[156:159], a[216:219], v[204:207]
buffer_load_dwordx4 v9, s[20:23], s63 offen lds
v_mfma_f32_16x16x32_bf16 v[204:207], a[168:171], a[228:231], v[204:207]
s_waitcnt lgkmcnt(4)
ds_read_b64_tr_b16 a[42:43], v29 offset:43008
v_mfma_f32_16x16x32_bf16 v[184:187], a[0:3], v[136:139], v[184:187]
ds_read_b64_tr_b16 a[44:45], v29 offset:45056
v_mfma_f32_16x16x32_bf16 v[184:187], a[4:7], v[148:151], v[184:187]
ds_read_b64_tr_b16 a[46:47], v29 offset:47104
v_mfma_f32_16x16x32_bf16 v[184:187], a[8:11], v[160:163], v[184:187]
ds_read_b64_tr_b16 a[48:49], v31 offset:32768
v_mfma_f32_16x16x32_bf16 v[184:187], a[12:15], v[172:175], v[184:187]
ds_read_b64_tr_b16 a[50:51], v31 offset:34816
v_mfma_f32_16x16x32_bf16 v[184:187], a[16:19], a[64:67], v[184:187]
ds_read_b64_tr_b16 a[52:53], v31 offset:36864
v_mfma_f32_16x16x32_bf16 v[184:187], a[20:23], a[76:79], v[184:187]
ds_read_b64_tr_b16 a[54:55], v31 offset:38912
v_mfma_f32_16x16x32_bf16 v[184:187], a[24:27], a[88:91], v[184:187]
ds_read_b64_tr_b16 a[56:57], v31 offset:40960
v_mfma_f32_16x16x32_bf16 v[184:187], a[28:31], a[100:103], v[184:187]
s_add_u32 m0, s61, 155648
ds_read_b64_tr_b16 a[58:59], v31 offset:43008
v_mfma_f32_16x16x32_bf16 v[188:191], a[0:3], v[140:143], v[188:191]
s_add_u32 s63, s73, 430080
buffer_load_dwordx4 v9, s[20:23], s62 offen lds
v_mfma_f32_16x16x32_bf16 v[188:191], a[4:7], v[152:155], v[188:191]
s_add_u32 m0, s61, 159744
ds_read_b64_tr_b16 a[60:61], v31 offset:45056
v_mfma_f32_16x16x32_bf16 v[188:191], a[8:11], v[164:167], v[188:191]
s_add_u32 s62, s74, 0
buffer_load_dwordx4 v9, s[20:23], s63 offen lds
v_mfma_f32_16x16x32_bf16 v[188:191], a[12:15], v[176:179], v[188:191]
s_add_u32 m0, s61, 98304
ds_read_b64_tr_b16 a[62:63], v31 offset:47104
v_cvt_pk_bf16_f32 v44, v184, v185
v_mfma_f32_16x16x32_bf16 v[188:191], a[16:19], a[68:71], v[188:191]
s_add_u32 s63, s74, 28672
buffer_load_dwordx4 v9, s[20:23], s62 offen lds
v_mfma_f32_16x16x32_bf16 v[188:191], a[20:23], a[80:83], v[188:191]
s_add_u32 m0, s61, 102400
v_add_u32 v28, 0x10000, v28
v_cvt_pk_bf16_f32 v45, v186, v187
v_mfma_f32_16x16x32_bf16 v[188:191], a[24:27], a[92:95], v[188:191]
s_add_u32 s62, s74, 57344
v_add_u32 v29, 0x10000, v29
v_add_u32 v30, 0x10000, v30
v_mfma_f32_16x16x32_bf16 v[188:191], a[28:31], a[104:107], v[188:191]
s_mul_i32 s73, s73, 96
v_add_u32 v31, 0x10000, v31
v_mfma_f32_16x16x32_bf16 v[192:195], a[0:3], v[144:147], v[192:195]
s_add_u32 s73, s73, s94
v_mfma_f32_16x16x32_bf16 v[192:195], a[4:7], v[156:159], v[192:195]
buffer_load_dwordx4 v9, s[20:23], s63 offen lds
v_mfma_f32_16x16x32_bf16 v[192:195], a[8:11], v[168:171], v[192:195]
s_add_u32 m0, s61, 106496
v_cvt_pk_bf16_f32 v48, v188, v189
v_cvt_pk_bf16_f32 v49, v190, v191
v_mfma_f32_16x16x32_bf16 v[192:195], a[12:15], v[180:183], v[192:195]
s_add_u32 s63, s74, 86016
v_mfma_f32_16x16x32_bf16 v[192:195], a[16:19], a[72:75], v[192:195]
v_mfma_f32_16x16x32_bf16 v[192:195], a[20:23], a[84:87], v[192:195]
buffer_load_dwordx4 v9, s[20:23], s62 offen lds
v_mfma_f32_16x16x32_bf16 v[192:195], a[24:27], a[96:99], v[192:195]
s_add_u32 m0, s61, 110592
v_mfma_f32_16x16x32_bf16 v[192:195], a[28:31], a[108:111], v[192:195]
s_waitcnt lgkmcnt(0)
v_mfma_f32_16x16x32_bf16 v[196:199], a[32:35], v[136:139], v[196:199]
v_mfma_f32_16x16x32_bf16 v[196:199], a[36:39], v[148:151], v[196:199]
v_mfma_f32_16x16x32_bf16 v[196:199], a[40:43], v[160:163], v[196:199]
buffer_load_dwordx4 v9, s[20:23], s63 offen lds
v_mfma_f32_16x16x32_bf16 v[196:199], a[44:47], v[172:175], v[196:199]
v_cvt_pk_bf16_f32 v52, v192, v193
v_cvt_pk_bf16_f32 v53, v194, v195
v_mfma_f32_16x16x32_bf16 v[196:199], a[48:51], a[64:67], v[196:199]
v_mfma_f32_16x16x32_bf16 v[196:199], a[52:55], a[76:79], v[196:199]
s_waitcnt vmcnt(8)
s_barrier
v_mfma_f32_16x16x32_bf16 v[196:199], a[56:59], a[88:91], v[196:199]
buffer_store_dwordx2 v[14:15], v13, s[36:39], s87 offen sc1
v_mfma_f32_16x16x32_bf16 v[196:199], a[60:63], a[100:103], v[196:199]
s_add_u32 m0, s61, 114688
ds_read_b64_tr_b16 a[112:113], v28 offset:0
v_mfma_f32_16x16x32_bf16 v[200:203], a[32:35], v[140:143], v[200:203]
s_add_u32 s62, s74, 229376
buffer_load_dwordx4 v9, s[20:23], s62 offen lds
v_mfma_f32_16x16x32_bf16 v[200:203], a[36:39], v[152:155], v[200:203]
s_add_u32 m0, s61, 118784
ds_read_b64_tr_b16 a[114:115], v28 offset:2048
v_mfma_f32_16x16x32_bf16 v[200:203], a[40:43], v[164:167], v[200:203]
s_add_u32 s63, s74, 258048
ds_read_b64_tr_b16 a[116:117], v28 offset:4096
v_cvt_pk_bf16_f32 v46, v196, v197
v_mfma_f32_16x16x32_bf16 v[200:203], a[44:47], v[176:179], v[200:203]
s_add_u32 s62, s74, 286720
buffer_load_dwordx4 v9, s[20:23], s63 offen lds
v_mfma_f32_16x16x32_bf16 v[200:203], a[48:51], a[68:71], v[200:203]
s_add_u32 m0, s61, 122880
ds_read_b64_tr_b16 a[118:119], v28 offset:6144
v_cvt_pk_bf16_f32 v47, v198, v199
v_mfma_f32_16x16x32_bf16 v[200:203], a[52:55], a[80:83], v[200:203]
s_add_u32 s63, s74, 315392
ds_read_b64_tr_b16 a[120:121], v28 offset:8192
v_mfma_f32_16x16x32_bf16 v[200:203], a[56:59], a[92:95], v[200:203]
ds_read_b64_tr_b16 a[122:123], v28 offset:10240
v_mfma_f32_16x16x32_bf16 v[200:203], a[60:63], a[104:107], v[200:203]
buffer_load_dwordx4 v9, s[20:23], s62 offen lds
v_mfma_f32_16x16x32_bf16 v[204:207], a[32:35], v[144:147], v[204:207]
s_add_u32 m0, s61, 126976
ds_read_b64_tr_b16 a[124:125], v28 offset:12288
v_mfma_f32_16x16x32_bf16 v[204:207], a[36:39], v[156:159], v[204:207]
s_add_u32 s62, s74, 114688
ds_read_b64_tr_b16 a[126:127], v28 offset:14336
v_mfma_f32_16x16x32_bf16 v[204:207], a[40:43], v[168:171], v[204:207]
ds_read_b64_tr_b16 a[136:137], v30 offset:0
v_cvt_pk_bf16_f32 v50, v200, v201
v_mfma_f32_16x16x32_bf16 v[204:207], a[44:47], v[180:183], v[204:207]
ds_read_b64_tr_b16 a[138:139], v30 offset:2048
v_cvt_pk_bf16_f32 v51, v202, v203
v_mfma_f32_16x16x32_bf16 v[204:207], a[48:51], a[72:75], v[204:207]
buffer_load_dwordx4 v9, s[20:23], s63 offen lds
v_mfma_f32_16x16x32_bf16 v[204:207], a[52:55], a[84:87], v[204:207]
s_add_u32 m0, s61, 0
ds_read_b64_tr_b16 a[148:149], v30 offset:4096
v_mfma_f32_16x16x32_bf16 v[204:207], a[56:59], a[96:99], v[204:207]
s_add_u32 s63, s74, 143360
ds_read_b64_tr_b16 a[150:151], v30 offset:6144
v_mfma_f32_16x16x32_bf16 v[204:207], a[60:63], a[108:111], v[204:207]
s_waitcnt lgkmcnt(5)
ds_read_b64_tr_b16 a[160:161], v30 offset:8192
v_mfma_f32_16x16x32_bf16 v[208:211], a[112:115], v[88:91], 0
buffer_load_dwordx4 v9, s[20:23], s62 offen lds
v_mfma_f32_16x16x32_bf16 v[208:211], a[116:119], v[100:103], v[208:211]
ds_read_b64_tr_b16 a[162:163], v30 offset:10240
ds_read_b64_tr_b16 a[172:173], v30 offset:12288
v_mfma_f32_16x16x32_bf16 v[208:211], a[120:123], v[112:115], v[208:211]
s_waitcnt lgkmcnt(5)
ds_read_b64_tr_b16 a[174:175], v30 offset:14336
v_cvt_pk_bf16_f32 v54, v204, v205
v_mfma_f32_16x16x32_bf16 v[208:211], a[124:127], v[124:127], v[208:211]
ds_read_b64_tr_b16 a[128:129], v29 offset:0
v_cvt_pk_bf16_f32 v55, v206, v207
v_mfma_f32_16x16x32_bf16 v[208:211], a[136:139], a[184:187], v[208:211]
s_waitcnt lgkmcnt(5)
ds_read_b64_tr_b16 a[130:131], v29 offset:2048
v_mfma_f32_16x16x32_bf16 v[208:211], a[148:151], a[196:199], v[208:211]
s_waitcnt lgkmcnt(4)
buffer_store_dwordx4 v[44:47], v12, s[28:31], s79 offen offset:0 sc1
v_mfma_f32_16x16x32_bf16 v[208:211], a[160:163], a[208:211], v[208:211]
s_waitcnt lgkmcnt(2)
ds_read_b64_tr_b16 a[140:141], v29 offset:4096
v_mfma_f32_16x16x32_bf16 v[208:211], a[172:175], a[220:223], v[208:211]
s_add_u32 m0, s61, 4096
ds_read_b64_tr_b16 a[142:143], v29 offset:6144
v_mfma_f32_16x16x32_bf16 v[212:215], a[112:115], v[92:95], 0
s_add_u32 s62, s74, 172032
ds_read_b64_tr_b16 a[152:153], v29 offset:8192
v_mfma_f32_16x16x32_bf16 v[212:215], a[116:119], v[104:107], v[212:215]
ds_read_b64_tr_b16 a[154:155], v29 offset:10240
v_mfma_f32_16x16x32_bf16 v[212:215], a[120:123], v[116:119], v[212:215]
ds_read_b64_tr_b16 a[164:165], v29 offset:12288
v_mfma_f32_16x16x32_bf16 v[212:215], a[124:127], v[128:131], v[212:215]
ds_read_b64_tr_b16 a[166:167], v29 offset:14336
v_mfma_f32_16x16x32_bf16 v[212:215], a[136:139], a[188:191], v[212:215]
ds_read_b64_tr_b16 a[132:133], v31 offset:0
v_mfma_f32_16x16x32_bf16 v[212:215], a[148:151], a[200:203], v[212:215]
ds_read_b64_tr_b16 a[134:135], v31 offset:2048
v_mfma_f32_16x16x32_bf16 v[212:215], a[160:163], a[212:215], v[212:215]
ds_read_b64_tr_b16 a[144:145], v31 offset:4096
v_mfma_f32_16x16x32_bf16 v[212:215], a[172:175], a[224:227], v[212:215]
ds_read_b64_tr_b16 a[146:147], v31 offset:6144
v_mfma_f32_16x16x32_bf16 v[216:219], a[112:115], v[96:99], 0
ds_read_b64_tr_b16 a[156:157], v31 offset:8192
v_mfma_f32_16x16x32_bf16 v[216:219], a[116:119], v[108:111], v[216:219]
ds_read_b64_tr_b16 a[158:159], v31 offset:10240
v_mfma_f32_16x16x32_bf16 v[216:219], a[120:123], v[120:123], v[216:219]
ds_read_b64_tr_b16 a[168:169], v31 offset:12288
v_mfma_f32_16x16x32_bf16 v[216:219], a[124:127], v[132:135], v[216:219]
buffer_load_dwordx4 v9, s[20:23], s63 offen lds
v_mfma_f32_16x16x32_bf16 v[216:219], a[136:139], a[192:195], v[216:219]
s_add_u32 m0, s61, 8192
ds_read_b64_tr_b16 a[170:171], v31 offset:14336
v_add_u32 v28, 0x10000, v28
v_mfma_f32_16x16x32_bf16 v[216:219], a[148:151], a[204:207], v[216:219]
s_add_u32 s63, s74, 200704
v_add_u32 v29, 0x10000, v29
v_add_u32 v30, 0x10000, v30
v_mfma_f32_16x16x32_bf16 v[216:219], a[160:163], a[216:219], v[216:219]
v_add_u32 v31, 0x10000, v31
v_mfma_f32_16x16x32_bf16 v[216:219], a[172:175], a[228:231], v[216:219]
s_waitcnt lgkmcnt(3)
buffer_load_dwordx4 v9, s[20:23], s62 offen lds
v_mfma_f32_16x16x32_bf16 v[220:223], a[128:131], v[88:91], 0
v_mfma_f32_16x16x32_bf16 v[220:223], a[140:143], v[100:103], v[220:223]
v_mfma_f32_16x16x32_bf16 v[220:223], a[152:155], v[112:115], v[220:223]
s_waitcnt vmcnt(13) lgkmcnt(0)
s_barrier
v_mfma_f32_16x16x32_bf16 v[220:223], a[164:167], v[124:127], v[220:223]
ds_read_b64_tr_b16 a[0:1], v28 offset:0
v_mfma_f32_16x16x32_bf16 v[220:223], a[132:135], a[184:187], v[220:223]
buffer_store_dwordx4 v[48:51], v12, s[28:31], s79 offen offset:1024 sc1
v_mfma_f32_16x16x32_bf16 v[220:223], a[144:147], a[196:199], v[220:223]
ds_read_b64_tr_b16 a[2:3], v28 offset:2048
v_mfma_f32_16x16x32_bf16 v[220:223], a[156:159], a[208:211], v[220:223]
ds_read_b64_tr_b16 a[4:5], v28 offset:4096
v_mfma_f32_16x16x32_bf16 v[220:223], a[168:171], a[220:223], v[220:223]
s_add_u32 m0, s61, 12288
ds_read_b64_tr_b16 a[6:7], v28 offset:6144
v_mfma_f32_16x16x32_bf16 v[224:227], a[128:131], v[92:95], 0
s_add_u32 s62, s74, 344064
ds_read_b64_tr_b16 a[8:9], v28 offset:8192
v_mfma_f32_16x16x32_bf16 v[224:227], a[140:143], v[104:107], v[224:227]
ds_read_b64_tr_b16 a[10:11], v28 offset:10240
v_mfma_f32_16x16x32_bf16 v[224:227], a[152:155], v[116:119], v[224:227]
ds_read_b64_tr_b16 a[12:13], v28 offset:12288
v_mfma_f32_16x16x32_bf16 v[224:227], a[164:167], v[128:131], v[224:227]
ds_read_b64_tr_b16 a[14:15], v28 offset:14336
v_mfma_f32_16x16x32_bf16 v[224:227], a[132:135], a[188:191], v[224:227]
ds_read_b64_tr_b16 a[16:17], v30 offset:0
v_mfma_f32_16x16x32_bf16 v[224:227], a[144:147], a[200:203], v[224:227]
buffer_store_dwordx4 v[52:55], v12, s[28:31], s79 offen offset:2048 sc1
v_mfma_f32_16x16x32_bf16 v[224:227], a[156:159], a[212:215], v[224:227]
buffer_load_dwordx4 v9, s[20:23], s63 offen lds
v_mfma_f32_16x16x32_bf16 v[224:227], a[168:171], a[224:227], v[224:227]
s_add_u32 m0, s61, 16384
ds_read_b64_tr_b16 a[18:19], v30 offset:2048
v_mfma_f32_16x16x32_bf16 v[228:231], a[128:131], v[96:99], 0
s_add_u32 s63, s74, 372736
ds_read_b64_tr_b16 a[20:21], v30 offset:4096
v_mfma_f32_16x16x32_bf16 v[228:231], a[140:143], v[108:111], v[228:231]
ds_read_b64_tr_b16 a[22:23], v30 offset:6144
v_mfma_f32_16x16x32_bf16 v[228:231], a[152:155], v[120:123], v[228:231]
buffer_load_dwordx4 v9, s[20:23], s62 offen lds
v_mfma_f32_16x16x32_bf16 v[228:231], a[164:167], v[132:135], v[228:231]
s_add_u32 m0, s61, 20480
ds_read_b64_tr_b16 a[24:25], v30 offset:8192
v_mfma_f32_16x16x32_bf16 v[228:231], a[132:135], a[192:195], v[228:231]
s_add_u32 s62, s74, 401408
ds_read_b64_tr_b16 a[26:27], v30 offset:10240
v_mfma_f32_16x16x32_bf16 v[228:231], a[144:147], a[204:207], v[228:231]
ds_read_b64_tr_b16 a[28:29], v30 offset:12288
v_mfma_f32_16x16x32_bf16 v[228:231], a[156:159], a[216:219], v[228:231]
buffer_load_dwordx4 v9, s[20:23], s63 offen lds
v_mfma_f32_16x16x32_bf16 v[228:231], a[168:171], a[228:231], v[228:231]
s_waitcnt lgkmcnt(4)
ds_read_b64_tr_b16 a[30:31], v30 offset:14336
v_mfma_f32_16x16x32_bf16 v[208:211], a[0:3], v[136:139], v[208:211]
ds_read_b64_tr_b16 a[32:33], v29 offset:0
v_mfma_f32_16x16x32_bf16 v[208:211], a[4:7], v[148:151], v[208:211]
ds_read_b64_tr_b16 a[34:35], v29 offset:2048
v_mfma_f32_16x16x32_bf16 v[208:211], a[8:11], v[160:163], v[208:211]
ds_read_b64_tr_b16 a[36:37], v29 offset:4096
v_mfma_f32_16x16x32_bf16 v[208:211], a[12:15], v[172:175], v[208:211]
ds_read_b64_tr_b16 a[38:39], v29 offset:6144
v_mfma_f32_16x16x32_bf16 v[208:211], a[16:19], a[64:67], v[208:211]
s_waitcnt lgkmcnt(5)
ds_read_b64_tr_b16 a[40:41], v29 offset:8192
v_mfma_f32_16x16x32_bf16 v[208:211], a[20:23], a[76:79], v[208:211]
ds_read_b64_tr_b16 a[42:43], v29 offset:10240
v_mfma_f32_16x16x32_bf16 v[208:211], a[24:27], a[88:91], v[208:211]
s_waitcnt lgkmcnt(6)
ds_read_b64_tr_b16 a[44:45], v29 offset:12288
v_mfma_f32_16x16x32_bf16 v[208:211], a[28:31], a[100:103], v[208:211]
s_add_u32 m0, s61, 24576
ds_read_b64_tr_b16 a[46:47], v29 offset:14336
v_mfma_f32_16x16x32_bf16 v[212:215], a[0:3], v[140:143], v[212:215]
s_add_u32 s63, s74, 430080
buffer_load_dwordx4 v9, s[20:23], s62 offen lds
v_mfma_f32_16x16x32_bf16 v[212:215], a[4:7], v[152:155], v[212:215]
s_add_u32 m0, s61, 28672
ds_read_b64_tr_b16 a[48:49], v31 offset:0
v_mfma_f32_16x16x32_bf16 v[212:215], a[8:11], v[164:167], v[212:215]
s_add_u32 s62, s75, 0
buffer_load_dwordx4 v9, s[20:23], s63 offen lds
v_mfma_f32_16x16x32_bf16 v[212:215], a[12:15], v[176:179], v[212:215]
s_add_u32 m0, s61, 32768
ds_read_b64_tr_b16 a[50:51], v31 offset:2048
v_cvt_pk_bf16_f32 v68, v208, v209
v_mfma_f32_16x16x32_bf16 v[212:215], a[16:19], a[68:71], v[212:215]
s_add_u32 s63, s75, 28672
buffer_load_dwordx4 v9, s[20:23], s62 offen lds
v_mfma_f32_16x16x32_bf16 v[212:215], a[20:23], a[80:83], v[212:215]
s_add_u32 m0, s61, 36864
ds_read_b64_tr_b16 a[52:53], v31 offset:4096
v_cvt_pk_bf16_f32 v69, v210, v211
v_mfma_f32_16x16x32_bf16 v[212:215], a[24:27], a[92:95], v[212:215]
s_add_u32 s62, s75, 57344
ds_read_b64_tr_b16 a[54:55], v31 offset:6144
v_mfma_f32_16x16x32_bf16 v[212:215], a[28:31], a[104:107], v[212:215]
s_mul_i32 s74, s74, 96
ds_read_b64_tr_b16 a[56:57], v31 offset:8192
v_mfma_f32_16x16x32_bf16 v[216:219], a[0:3], v[144:147], v[216:219]
s_add_u32 s74, s74, s94
ds_read_b64_tr_b16 a[58:59], v31 offset:10240
v_mfma_f32_16x16x32_bf16 v[216:219], a[4:7], v[156:159], v[216:219]
buffer_load_dwordx4 v9, s[20:23], s63 offen lds
v_mfma_f32_16x16x32_bf16 v[216:219], a[8:11], v[168:171], v[216:219]
s_add_u32 m0, s61, 40960
ds_read_b64_tr_b16 a[60:61], v31 offset:12288
v_cvt_pk_bf16_f32 v72, v212, v213
v_mfma_f32_16x16x32_bf16 v[216:219], a[12:15], v[180:183], v[216:219]
s_add_u32 s63, s75, 86016
ds_read_b64_tr_b16 a[62:63], v31 offset:14336
v_add_u32 v28, 0xffff8000, v28
v_mfma_f32_16x16x32_bf16 v[216:219], a[16:19], a[72:75], v[216:219]
v_add_u32 v29, 0xffff8000, v29
v_add_u32 v30, 0xffff8000, v30
v_mfma_f32_16x16x32_bf16 v[216:219], a[20:23], a[84:87], v[216:219]
buffer_load_dwordx4 v9, s[20:23], s62 offen lds
v_mfma_f32_16x16x32_bf16 v[216:219], a[24:27], a[96:99], v[216:219]
s_add_u32 m0, s61, 45056
v_add_u32 v31, 0xffff8000, v31
v_cvt_pk_bf16_f32 v73, v214, v215
v_mfma_f32_16x16x32_bf16 v[216:219], a[28:31], a[108:111], v[216:219]
s_waitcnt lgkmcnt(2)
v_mfma_f32_16x16x32_bf16 v[220:223], a[32:35], v[136:139], v[220:223]
v_mfma_f32_16x16x32_bf16 v[220:223], a[36:39], v[148:151], v[220:223]
v_mfma_f32_16x16x32_bf16 v[220:223], a[40:43], v[160:163], v[220:223]
buffer_load_dwordx4 v9, s[20:23], s63 offen lds
v_mfma_f32_16x16x32_bf16 v[220:223], a[44:47], v[172:175], v[220:223]
v_cvt_pk_bf16_f32 v76, v216, v217
v_cvt_pk_bf16_f32 v77, v218, v219
v_mfma_f32_16x16x32_bf16 v[220:223], a[48:51], a[64:67], v[220:223]
v_mfma_f32_16x16x32_bf16 v[220:223], a[52:55], a[76:79], v[220:223]
s_waitcnt vmcnt(9) lgkmcnt(0)
s_barrier
v_mfma_f32_16x16x32_bf16 v[220:223], a[56:59], a[88:91], v[220:223]
buffer_store_dwordx2 v[14:15], v13, s[36:39], s88 offen sc1
v_mfma_f32_16x16x32_bf16 v[220:223], a[60:63], a[100:103], v[220:223]
s_add_u32 m0, s61, 49152
ds_read_b64_tr_b16 a[112:113], v28 offset:0
v_mfma_f32_16x16x32_bf16 v[224:227], a[32:35], v[140:143], v[224:227]
s_add_u32 s62, s75, 229376
buffer_load_dwordx4 v9, s[20:23], s62 offen lds
v_mfma_f32_16x16x32_bf16 v[224:227], a[36:39], v[152:155], v[224:227]
s_add_u32 m0, s61, 53248
ds_read_b64_tr_b16 a[114:115], v28 offset:2048
v_mfma_f32_16x16x32_bf16 v[224:227], a[40:43], v[164:167], v[224:227]
s_add_u32 s63, s75, 258048
ds_read_b64_tr_b16 a[116:117], v28 offset:4096
v_cvt_pk_bf16_f32 v70, v220, v221
v_mfma_f32_16x16x32_bf16 v[224:227], a[44:47], v[176:179], v[224:227]
s_add_u32 s62, s75, 286720
buffer_load_dwordx4 v9, s[20:23], s63 offen lds
v_mfma_f32_16x16x32_bf16 v[224:227], a[48:51], a[68:71], v[224:227]
s_add_u32 m0, s61, 57344
ds_read_b64_tr_b16 a[118:119], v28 offset:6144
v_cvt_pk_bf16_f32 v71, v222, v223
v_mfma_f32_16x16x32_bf16 v[224:227], a[52:55], a[80:83], v[224:227]
s_add_u32 s63, s75, 315392
ds_read_b64_tr_b16 a[120:121], v28 offset:8192
v_mfma_f32_16x16x32_bf16 v[224:227], a[56:59], a[92:95], v[224:227]
ds_read_b64_tr_b16 a[122:123], v28 offset:10240
v_mfma_f32_16x16x32_bf16 v[224:227], a[60:63], a[104:107], v[224:227]
buffer_load_dwordx4 v9, s[20:23], s62 offen lds
v_mfma_f32_16x16x32_bf16 v[228:231], a[32:35], v[144:147], v[228:231]
s_add_u32 m0, s61, 61440
ds_read_b64_tr_b16 a[124:125], v28 offset:12288
v_mfma_f32_16x16x32_bf16 v[228:231], a[36:39], v[156:159], v[228:231]
s_add_u32 s62, s75, 114688
ds_read_b64_tr_b16 a[126:127], v28 offset:14336
v_mfma_f32_16x16x32_bf16 v[228:231], a[40:43], v[168:171], v[228:231]
ds_read_b64_tr_b16 a[136:137], v30 offset:0
v_cvt_pk_bf16_f32 v74, v224, v225
v_mfma_f32_16x16x32_bf16 v[228:231], a[44:47], v[180:183], v[228:231]
ds_read_b64_tr_b16 a[138:139], v30 offset:2048
v_cvt_pk_bf16_f32 v75, v226, v227
v_mfma_f32_16x16x32_bf16 v[228:231], a[48:51], a[72:75], v[228:231]
buffer_load_dwordx4 v9, s[20:23], s63 offen lds
v_mfma_f32_16x16x32_bf16 v[228:231], a[52:55], a[84:87], v[228:231]
s_add_u32 m0, s61, 65536
ds_read_b64_tr_b16 a[148:149], v30 offset:4096
v_mfma_f32_16x16x32_bf16 v[228:231], a[56:59], a[96:99], v[228:231]
s_add_u32 s63, s75, 143360
ds_read_b64_tr_b16 a[150:151], v30 offset:6144
v_mfma_f32_16x16x32_bf16 v[228:231], a[60:63], a[108:111], v[228:231]
s_waitcnt lgkmcnt(5)
ds_read_b64_tr_b16 a[160:161], v30 offset:8192
v_mfma_f32_16x16x32_bf16 v[184:187], a[112:115], v[88:91], 0
buffer_load_dwordx4 v9, s[20:23], s62 offen lds
v_mfma_f32_16x16x32_bf16 v[184:187], a[116:119], v[100:103], v[184:187]
ds_read_b64_tr_b16 a[162:163], v30 offset:10240
ds_read_b64_tr_b16 a[172:173], v30 offset:12288
v_mfma_f32_16x16x32_bf16 v[184:187], a[120:123], v[112:115], v[184:187]
s_waitcnt lgkmcnt(5)
ds_read_b64_tr_b16 a[174:175], v30 offset:14336
v_cvt_pk_bf16_f32 v78, v228, v229
v_mfma_f32_16x16x32_bf16 v[184:187], a[124:127], v[124:127], v[184:187]
ds_read_b64_tr_b16 a[128:129], v29 offset:0
v_cvt_pk_bf16_f32 v79, v230, v231
v_mfma_f32_16x16x32_bf16 v[184:187], a[136:139], a[184:187], v[184:187]
s_waitcnt lgkmcnt(5)
ds_read_b64_tr_b16 a[130:131], v29 offset:2048
v_mfma_f32_16x16x32_bf16 v[184:187], a[148:151], a[196:199], v[184:187]
s_waitcnt lgkmcnt(4)
ds_read_b64_tr_b16 a[140:141], v29 offset:4096
v_mfma_f32_16x16x32_bf16 v[184:187], a[160:163], a[208:211], v[184:187]
s_waitcnt lgkmcnt(3)
ds_read_b64_tr_b16 a[142:143], v29 offset:6144
v_mfma_f32_16x16x32_bf16 v[184:187], a[172:175], a[220:223], v[184:187]
s_add_u32 m0, s61, 69632
ds_read_b64_tr_b16 a[152:153], v29 offset:8192
v_mfma_f32_16x16x32_bf16 v[188:191], a[112:115], v[92:95], 0
s_add_u32 s62, s75, 172032
buffer_load_dwordx4 v9, s[20:23], s63 offen lds
v_mfma_f32_16x16x32_bf16 v[188:191], a[116:119], v[104:107], v[188:191]
s_add_u32 m0, s61, 73728
ds_read_b64_tr_b16 a[154:155], v29 offset:10240
v_mfma_f32_16x16x32_bf16 v[188:191], a[120:123], v[116:119], v[188:191]
s_add_u32 s63, s75, 200704
buffer_load_dwordx4 v9, s[20:23], s62 offen lds
v_mfma_f32_16x16x32_bf16 v[188:191], a[124:127], v[128:131], v[188:191]
s_add_u32 m0, s61, 77824
ds_read_b64_tr_b16 a[164:165], v29 offset:12288
v_mfma_f32_16x16x32_bf16 v[188:191], a[136:139], a[188:191], v[188:191]
s_add_u32 s62, s75, 344064
ds_read_b64_tr_b16 a[166:167], v29 offset:14336
v_mfma_f32_16x16x32_bf16 v[188:191], a[148:151], a[200:203], v[188:191]
ds_read_b64_tr_b16 a[132:133], v31 offset:0
v_mfma_f32_16x16x32_bf16 v[188:191], a[160:163], a[212:215], v[188:191]
buffer_load_dwordx4 v9, s[20:23], s63 offen lds
v_mfma_f32_16x16x32_bf16 v[188:191], a[172:175], a[224:227], v[188:191]
s_add_u32 m0, s61, 81920
ds_read_b64_tr_b16 a[134:135], v31 offset:2048
v_mfma_f32_16x16x32_bf16 v[192:195], a[112:115], v[96:99], 0
s_add_u32 s63, s75, 372736
ds_read_b64_tr_b16 a[144:145], v31 offset:4096
v_mfma_f32_16x16x32_bf16 v[192:195], a[116:119], v[108:111], v[192:195]
ds_read_b64_tr_b16 a[146:147], v31 offset:6144
v_mfma_f32_16x16x32_bf16 v[192:195], a[120:123], v[120:123], v[192:195]
buffer_load_dwordx4 v9, s[20:23], s62 offen lds
v_mfma_f32_16x16x32_bf16 v[192:195], a[124:127], v[132:135], v[192:195]
s_add_u32 m0, s61, 86016
ds_read_b64_tr_b16 a[156:157], v31 offset:8192
v_mfma_f32_16x16x32_bf16 v[192:195], a[136:139], a[192:195], v[192:195]
s_add_u32 s62, s75, 401408
ds_read_b64_tr_b16 a[158:159], v31 offset:10240
v_mfma_f32_16x16x32_bf16 v[192:195], a[148:151], a[204:207], v[192:195]
ds_read_b64_tr_b16 a[168:169], v31 offset:12288
v_mfma_f32_16x16x32_bf16 v[192:195], a[160:163], a[216:219], v[192:195]
ds_read_b64_tr_b16 a[170:171], v31 offset:14336
v_add_u32 v28, 0xfffe8000, v28
v_mfma_f32_16x16x32_bf16 v[192:195], a[172:175], a[228:231], v[192:195]
s_waitcnt lgkmcnt(5)
buffer_load_dwordx4 v9, s[20:23], s63 offen lds
v_mfma_f32_16x16x32_bf16 v[196:199], a[128:131], v[88:91], 0
buffer_store_dwordx4 v[68:71], v12, s[28:31], s80 offen offset:0 sc1
v_mfma_f32_16x16x32_bf16 v[196:199], a[140:143], v[100:103], v[196:199]
v_add_u32 v29, 0xfffe8000, v29
v_add_u32 v30, 0xfffe8000, v30
v_mfma_f32_16x16x32_bf16 v[196:199], a[152:155], v[112:115], v[196:199]
v_add_u32 v31, 0xfffe8000, v31
v_mfma_f32_16x16x32_bf16 v[196:199], a[164:167], v[124:127], v[196:199]
v_mfma_f32_16x16x32_bf16 v[196:199], a[132:135], a[184:187], v[196:199]
s_waitcnt vmcnt(16) lgkmcnt(0)
s_barrier
v_mfma_f32_16x16x32_bf16 v[196:199], a[144:147], a[196:199], v[196:199]
buffer_store_dwordx4 v[72:75], v12, s[28:31], s80 offen offset:1024 sc1
v_mfma_f32_16x16x32_bf16 v[196:199], a[156:159], a[208:211], v[196:199]
ds_read_b64_tr_b16 a[0:1], v28 offset:0
v_mfma_f32_16x16x32_bf16 v[196:199], a[168:171], a[220:223], v[196:199]
s_add_u32 m0, s61, 90112
ds_read_b64_tr_b16 a[2:3], v28 offset:2048
v_mfma_f32_16x16x32_bf16 v[200:203], a[128:131], v[92:95], 0
s_add_u32 s63, s75, 430080
ds_read_b64_tr_b16 a[4:5], v28 offset:4096
v_mfma_f32_16x16x32_bf16 v[200:203], a[140:143], v[104:107], v[200:203]
ds_read_b64_tr_b16 a[6:7], v28 offset:6144
v_mfma_f32_16x16x32_bf16 v[200:203], a[152:155], v[116:119], v[200:203]
ds_read_b64_tr_b16 a[8:9], v28 offset:8192
v_mfma_f32_16x16x32_bf16 v[200:203], a[164:167], v[128:131], v[200:203]
ds_read_b64_tr_b16 a[10:11], v28 offset:10240
v_mfma_f32_16x16x32_bf16 v[200:203], a[132:135], a[188:191], v[200:203]
ds_read_b64_tr_b16 a[12:13], v28 offset:12288
v_mfma_f32_16x16x32_bf16 v[200:203], a[144:147], a[200:203], v[200:203]
buffer_store_dwordx4 v[76:79], v12, s[28:31], s80 offen offset:2048 sc1
v_mfma_f32_16x16x32_bf16 v[200:203], a[156:159], a[212:215], v[200:203]
ds_read_b64_tr_b16 a[14:15], v28 offset:14336
v_mfma_f32_16x16x32_bf16 v[200:203], a[168:171], a[224:227], v[200:203]
ds_read_b64_tr_b16 a[16:17], v30 offset:0
v_mfma_f32_16x16x32_bf16 v[204:207], a[128:131], v[96:99], 0
ds_read_b64_tr_b16 a[18:19], v30 offset:2048
v_mfma_f32_16x16x32_bf16 v[204:207], a[140:143], v[108:111], v[204:207]
ds_read_b64_tr_b16 a[20:21], v30 offset:4096
v_mfma_f32_16x16x32_bf16 v[204:207], a[152:155], v[120:123], v[204:207]
ds_read_b64_tr_b16 a[22:23], v30 offset:6144
v_mfma_f32_16x16x32_bf16 v[204:207], a[164:167], v[132:135], v[204:207]
ds_read_b64_tr_b16 a[24:25], v30 offset:8192
v_mfma_f32_16x16x32_bf16 v[204:207], a[132:135], a[192:195], v[204:207]
ds_read_b64_tr_b16 a[26:27], v30 offset:10240
v_mfma_f32_16x16x32_bf16 v[204:207], a[144:147], a[204:207], v[204:207]
ds_read_b64_tr_b16 a[28:29], v30 offset:12288
v_mfma_f32_16x16x32_bf16 v[204:207], a[156:159], a[216:219], v[204:207]
ds_read_b64_tr_b16 a[30:31], v30 offset:14336
v_mfma_f32_16x16x32_bf16 v[204:207], a[168:171], a[228:231], v[204:207]
s_waitcnt lgkmcnt(6)
ds_read_b64_tr_b16 a[32:33], v29 offset:0
v_mfma_f32_16x16x32_bf16 v[184:187], a[0:3], v[136:139], v[184:187]
ds_read_b64_tr_b16 a[34:35], v29 offset:2048
v_mfma_f32_16x16x32_bf16 v[184:187], a[4:7], v[148:151], v[184:187]
ds_read_b64_tr_b16 a[36:37], v29 offset:4096
v_mfma_f32_16x16x32_bf16 v[184:187], a[8:11], v[160:163], v[184:187]
buffer_load_dwordx4 v9, s[20:23], s62 offen lds
v_mfma_f32_16x16x32_bf16 v[184:187], a[12:15], v[172:175], v[184:187]
ds_read_b64_tr_b16 a[38:39], v29 offset:6144
v_mfma_f32_16x16x32_bf16 v[184:187], a[16:19], a[64:67], v[184:187]
s_waitcnt lgkmcnt(5)
ds_read_b64_tr_b16 a[40:41], v29 offset:8192
v_mfma_f32_16x16x32_bf16 v[184:187], a[20:23], a[76:79], v[184:187]
ds_read_b64_tr_b16 a[42:43], v29 offset:10240
v_mfma_f32_16x16x32_bf16 v[184:187], a[24:27], a[88:91], v[184:187]
s_waitcnt lgkmcnt(5)
ds_read_b64_tr_b16 a[44:45], v29 offset:12288
v_mfma_f32_16x16x32_bf16 v[184:187], a[28:31], a[100:103], v[184:187]
s_add_u32 m0, s61, 94208
ds_read_b64_tr_b16 a[46:47], v29 offset:14336
v_mfma_f32_16x16x32_bf16 v[188:191], a[0:3], v[140:143], v[188:191]
s_add_u32 s62, s76, 0
buffer_load_dwordx4 v9, s[20:23], s63 offen lds
v_mfma_f32_16x16x32_bf16 v[188:191], a[4:7], v[152:155], v[188:191]
s_add_u32 m0, s61, 131072
ds_read_b64_tr_b16 a[48:49], v31 offset:0
v_mfma_f32_16x16x32_bf16 v[188:191], a[8:11], v[164:167], v[188:191]
s_add_u32 s63, s76, 28672
ds_read_b64_tr_b16 a[50:51], v31 offset:2048
v_cvt_pk_bf16_f32 v32, v184, v185
v_mfma_f32_16x16x32_bf16 v[188:191], a[12:15], v[176:179], v[188:191]
s_mul_i32 s75, s75, 96
buffer_load_dwordx4 v9, s[20:23], s62 offen lds
v_mfma_f32_16x16x32_bf16 v[188:191], a[16:19], a[68:71], v[188:191]
s_add_u32 m0, s61, 135168
ds_read_b64_tr_b16 a[52:53], v31 offset:4096
v_cvt_pk_bf16_f32 v33, v186, v187
v_mfma_f32_16x16x32_bf16 v[188:191], a[20:23], a[80:83], v[188:191]
s_add_u32 s62, s76, 57344
ds_read_b64_tr_b16 a[54:55], v31 offset:6144
v_mfma_f32_16x16x32_bf16 v[188:191], a[24:27], a[92:95], v[188:191]
s_add_u32 s75, s75, s94
ds_read_b64_tr_b16 a[56:57], v31 offset:8192
v_mfma_f32_16x16x32_bf16 v[188:191], a[28:31], a[104:107], v[188:191]
ds_read_b64_tr_b16 a[58:59], v31 offset:10240
v_mfma_f32_16x16x32_bf16 v[192:195], a[0:3], v[144:147], v[192:195]
buffer_load_dwordx4 v9, s[20:23], s63 offen lds
v_mfma_f32_16x16x32_bf16 v[192:195], a[4:7], v[156:159], v[192:195]
s_add_u32 m0, s61, 139264
ds_read_b64_tr_b16 a[60:61], v31 offset:12288
v_mfma_f32_16x16x32_bf16 v[192:195], a[8:11], v[168:171], v[192:195]
s_add_u32 s63, s76, 86016
ds_read_b64_tr_b16 a[62:63], v31 offset:14336
v_cvt_pk_bf16_f32 v36, v188, v189
v_mfma_f32_16x16x32_bf16 v[192:195], a[12:15], v[180:183], v[192:195]
v_cvt_pk_bf16_f32 v37, v190, v191
v_mfma_f32_16x16x32_bf16 v[192:195], a[16:19], a[72:75], v[192:195]
buffer_load_dwordx4 v9, s[20:23], s62 offen lds
v_mfma_f32_16x16x32_bf16 v[192:195], a[20:23], a[84:87], v[192:195]
s_add_u32 m0, s61, 143360
v_mfma_f32_16x16x32_bf16 v[192:195], a[24:27], a[96:99], v[192:195]
s_add_u32 s62, s76, 229376
v_mfma_f32_16x16x32_bf16 v[192:195], a[28:31], a[108:111], v[192:195]
s_waitcnt lgkmcnt(2)
v_mfma_f32_16x16x32_bf16 v[196:199], a[32:35], v[136:139], v[196:199]
v_mfma_f32_16x16x32_bf16 v[196:199], a[36:39], v[148:151], v[196:199]
buffer_load_dwordx4 v9, s[20:23], s63 offen lds
v_mfma_f32_16x16x32_bf16 v[196:199], a[40:43], v[160:163], v[196:199]
v_cvt_pk_bf16_f32 v40, v192, v193
v_cvt_pk_bf16_f32 v41, v194, v195
v_mfma_f32_16x16x32_bf16 v[196:199], a[44:47], v[172:175], v[196:199]
v_mfma_f32_16x16x32_bf16 v[196:199], a[48:51], a[64:67], v[196:199]
v_mfma_f32_16x16x32_bf16 v[196:199], a[52:55], a[76:79], v[196:199]
s_waitcnt vmcnt(6) lgkmcnt(0)
s_barrier
v_mfma_f32_16x16x32_bf16 v[196:199], a[56:59], a[88:91], v[196:199]
buffer_store_dwordx2 v[14:15], v13, s[36:39], s89 offen sc1
v_mfma_f32_16x16x32_bf16 v[196:199], a[60:63], a[100:103], v[196:199]
s_add_u32 m0, s61, 147456
ds_read_b64_tr_b16 a[0:1], v28 offset:32768
v_mfma_f32_16x16x32_bf16 v[200:203], a[32:35], v[140:143], v[200:203]
s_add_u32 s63, s76, 258048
buffer_load_dwordx4 v9, s[20:23], s62 offen lds
v_mfma_f32_16x16x32_bf16 v[200:203], a[36:39], v[152:155], v[200:203]
s_add_u32 m0, s61, 151552
ds_read_b64_tr_b16 a[2:3], v28 offset:34816
v_mfma_f32_16x16x32_bf16 v[200:203], a[40:43], v[164:167], v[200:203]
s_add_u32 s62, s76, 286720
buffer_load_dwordx4 v9, s[20:23], s63 offen lds
v_mfma_f32_16x16x32_bf16 v[200:203], a[44:47], v[176:179], v[200:203]
s_add_u32 m0, s61, 155648
ds_read_b64_tr_b16 a[4:5], v28 offset:36864
v_cvt_pk_bf16_f32 v34, v196, v197
v_mfma_f32_16x16x32_bf16 v[200:203], a[48:51], a[68:71], v[200:203]
s_add_u32 s63, s76, 315392
ds_read_b64_tr_b16 a[6:7], v28 offset:38912
v_cvt_pk_bf16_f32 v35, v198, v199
v_mfma_f32_16x16x32_bf16 v[200:203], a[52:55], a[80:83], v[200:203]
ds_read_b64_tr_b16 a[8:9], v28 offset:40960
v_mfma_f32_16x16x32_bf16 v[200:203], a[56:59], a[92:95], v[200:203]
buffer_load_dwordx4 v9, s[20:23], s62 offen lds
v_mfma_f32_16x16x32_bf16 v[200:203], a[60:63], a[104:107], v[200:203]
s_add_u32 m0, s61, 159744
ds_read_b64_tr_b16 a[10:11], v28 offset:43008
v_mfma_f32_16x16x32_bf16 v[204:207], a[32:35], v[144:147], v[204:207]
s_add_u32 s62, s76, 114688
ds_read_b64_tr_b16 a[12:13], v28 offset:45056
v_mfma_f32_16x16x32_bf16 v[204:207], a[36:39], v[156:159], v[204:207]
ds_read_b64_tr_b16 a[14:15], v28 offset:47104
v_mfma_f32_16x16x32_bf16 v[204:207], a[40:43], v[168:171], v[204:207]
ds_read_b64_tr_b16 a[16:17], v30 offset:32768
v_cvt_pk_bf16_f32 v38, v200, v201
v_mfma_f32_16x16x32_bf16 v[204:207], a[44:47], v[180:183], v[204:207]
buffer_load_dwordx4 v9, s[20:23], s63 offen lds
v_mfma_f32_16x16x32_bf16 v[204:207], a[48:51], a[72:75], v[204:207]
s_add_u32 m0, s61, 98304
ds_read_b64_tr_b16 a[18:19], v30 offset:34816
v_cvt_pk_bf16_f32 v39, v202, v203
v_mfma_f32_16x16x32_bf16 v[204:207], a[52:55], a[84:87], v[204:207]
s_add_u32 s63, s76, 143360
ds_read_b64_tr_b16 a[20:21], v30 offset:36864
v_mfma_f32_16x16x32_bf16 v[204:207], a[56:59], a[96:99], v[204:207]
ds_read_b64_tr_b16 a[22:23], v30 offset:38912
v_mfma_f32_16x16x32_bf16 v[204:207], a[60:63], a[108:111], v[204:207]
s_waitcnt lgkmcnt(5)
buffer_load_dwordx4 v9, s[20:23], s62 offen lds
v_mfma_f32_16x16x32_bf16 v[208:211], a[0:3], v[88:91], 0
ds_read_b64_tr_b16 a[24:25], v30 offset:40960
ds_read_b64_tr_b16 a[26:27], v30 offset:43008
v_mfma_f32_16x16x32_bf16 v[208:211], a[4:7], v[100:103], v[208:211]
ds_read_b64_tr_b16 a[28:29], v30 offset:45056
ds_read_b64_tr_b16 a[30:31], v30 offset:47104
v_mfma_f32_16x16x32_bf16 v[208:211], a[8:11], v[112:115], v[208:211]
s_waitcnt lgkmcnt(7)
buffer_load_dwordx2 v[84:85], v3, s[36:39], s95 offen sc1
v_mfma_f32_16x16x32_bf16 v[208:211], a[12:15], v[124:127], v[208:211]
s_waitcnt lgkmcnt(6)
ds_read_b64_tr_b16 a[32:33], v29 offset:32768
v_cvt_pk_bf16_f32 v42, v204, v205
v_mfma_f32_16x16x32_bf16 v[208:211], a[16:19], a[184:187], v[208:211]
s_waitcnt lgkmcnt(5)
buffer_store_dwordx4 v[32:35], v12, s[28:31], s81 offen offset:0 sc1
v_mfma_f32_16x16x32_bf16 v[208:211], a[20:23], a[196:199], v[208:211]
s_waitcnt lgkmcnt(3)
ds_read_b64_tr_b16 a[34:35], v29 offset:34816
v_cvt_pk_bf16_f32 v43, v206, v207
v_mfma_f32_16x16x32_bf16 v[208:211], a[24:27], a[208:211], v[208:211]
s_waitcnt lgkmcnt(2)
ds_read_b64_tr_b16 a[36:37], v29 offset:36864
v_mfma_f32_16x16x32_bf16 v[208:211], a[28:31], a[220:223], v[208:211]
s_add_u32 m0, s61, 102400
ds_read_b64_tr_b16 a[38:39], v29 offset:38912
v_mfma_f32_16x16x32_bf16 v[212:215], a[0:3], v[92:95], 0
s_add_u32 s62, s76, 172032
ds_read_b64_tr_b16 a[40:41], v29 offset:40960
v_mfma_f32_16x16x32_bf16 v[212:215], a[4:7], v[104:107], v[212:215]
ds_read_b64_tr_b16 a[42:43], v29 offset:43008
v_mfma_f32_16x16x32_bf16 v[212:215], a[8:11], v[116:119], v[212:215]
ds_read_b64_tr_b16 a[44:45], v29 offset:45056
v_mfma_f32_16x16x32_bf16 v[212:215], a[12:15], v[128:131], v[212:215]
ds_read_b64_tr_b16 a[46:47], v29 offset:47104
v_mfma_f32_16x16x32_bf16 v[212:215], a[16:19], a[188:191], v[212:215]
ds_read_b64_tr_b16 a[48:49], v31 offset:32768
v_mfma_f32_16x16x32_bf16 v[212:215], a[20:23], a[200:203], v[212:215]
ds_read_b64_tr_b16 a[50:51], v31 offset:34816
v_mfma_f32_16x16x32_bf16 v[212:215], a[24:27], a[212:215], v[212:215]
ds_read_b64_tr_b16 a[52:53], v31 offset:36864
v_mfma_f32_16x16x32_bf16 v[212:215], a[28:31], a[224:227], v[212:215]
ds_read_b64_tr_b16 a[54:55], v31 offset:38912
v_mfma_f32_16x16x32_bf16 v[216:219], a[0:3], v[96:99], 0
ds_read_b64_tr_b16 a[56:57], v31 offset:40960
v_mfma_f32_16x16x32_bf16 v[216:219], a[4:7], v[108:111], v[216:219]
ds_read_b64_tr_b16 a[58:59], v31 offset:43008
v_mfma_f32_16x16x32_bf16 v[216:219], a[8:11], v[120:123], v[216:219]
buffer_load_dwordx4 v9, s[20:23], s63 offen lds
v_mfma_f32_16x16x32_bf16 v[216:219], a[12:15], v[132:135], v[216:219]
s_add_u32 m0, s61, 106496
ds_read_b64_tr_b16 a[60:61], v31 offset:45056
v_mfma_f32_16x16x32_bf16 v[216:219], a[16:19], a[192:195], v[216:219]
s_add_u32 s63, s76, 200704
ds_read_b64_tr_b16 a[62:63], v31 offset:47104
v_add_u32 v28, 0x10000, v28
v_mfma_f32_16x16x32_bf16 v[216:219], a[20:23], a[204:207], v[216:219]
v_add_u32 v29, 0x10000, v29
v_add_u32 v30, 0x10000, v30
v_mfma_f32_16x16x32_bf16 v[216:219], a[24:27], a[216:219], v[216:219]
buffer_load_dwordx4 v9, s[20:23], s62 offen lds
v_mfma_f32_16x16x32_bf16 v[216:219], a[28:31], a[228:231], v[216:219]
s_waitcnt lgkmcnt(3)
v_add_u32 v31, 0x10000, v31
v_mfma_f32_16x16x32_bf16 v[220:223], a[32:35], v[88:91], 0
v_mfma_f32_16x16x32_bf16 v[220:223], a[36:39], v[100:103], v[220:223]
v_mfma_f32_16x16x32_bf16 v[220:223], a[40:43], v[112:115], v[220:223]
s_waitcnt vmcnt(14) lgkmcnt(0)
s_barrier
v_mfma_f32_16x16x32_bf16 v[220:223], a[44:47], v[124:127], v[220:223]
buffer_store_dwordx4 v[36:39], v12, s[28:31], s81 offen offset:1024 sc1
v_mfma_f32_16x16x32_bf16 v[220:223], a[48:51], a[184:187], v[220:223]
ds_read_b64_tr_b16 a[0:1], v28 offset:0
v_mfma_f32_16x16x32_bf16 v[220:223], a[52:55], a[196:199], v[220:223]
ds_read_b64_tr_b16 a[2:3], v28 offset:2048
v_mfma_f32_16x16x32_bf16 v[220:223], a[56:59], a[208:211], v[220:223]
ds_read_b64_tr_b16 a[4:5], v28 offset:4096
v_mfma_f32_16x16x32_bf16 v[220:223], a[60:63], a[220:223], v[220:223]
s_add_u32 m0, s61, 110592
ds_read_b64_tr_b16 a[6:7], v28 offset:6144
v_mfma_f32_16x16x32_bf16 v[224:227], a[32:35], v[92:95], 0
s_add_u32 s62, s76, 344064
ds_read_b64_tr_b16 a[8:9], v28 offset:8192
v_mfma_f32_16x16x32_bf16 v[224:227], a[36:39], v[104:107], v[224:227]
ds_read_b64_tr_b16 a[10:11], v28 offset:10240
v_mfma_f32_16x16x32_bf16 v[224:227], a[40:43], v[116:119], v[224:227]
ds_read_b64_tr_b16 a[12:13], v28 offset:12288
v_mfma_f32_16x16x32_bf16 v[224:227], a[44:47], v[128:131], v[224:227]
ds_read_b64_tr_b16 a[14:15], v28 offset:14336
v_mfma_f32_16x16x32_bf16 v[224:227], a[48:51], a[188:191], v[224:227]
ds_read_b64_tr_b16 a[16:17], v30 offset:0
v_mfma_f32_16x16x32_bf16 v[224:227], a[52:55], a[200:203], v[224:227]
buffer_store_dwordx4 v[40:43], v12, s[28:31], s81 offen offset:2048 sc1
v_mfma_f32_16x16x32_bf16 v[224:227], a[56:59], a[212:215], v[224:227]
buffer_load_dwordx4 v9, s[20:23], s63 offen lds
v_mfma_f32_16x16x32_bf16 v[224:227], a[60:63], a[224:227], v[224:227]
s_add_u32 m0, s61, 114688
s_waitcnt vmcnt(6)
v_cmp_eq_u64 vcc, v[84:85], v[14:15]
v_mfma_f32_16x16x32_bf16 v[228:231], a[32:35], v[96:99], 0
s_add_u32 s63, s76, 372736
ds_read_b64_tr_b16 a[18:19], v30 offset:2048
v_mfma_f32_16x16x32_bf16 v[228:231], a[36:39], v[108:111], v[228:231]
ds_read_b64_tr_b16 a[20:21], v30 offset:4096
v_mfma_f32_16x16x32_bf16 v[228:231], a[40:43], v[120:123], v[228:231]
s_bfe_u32 s97, s3, 0x80000
s_and_b32 s96, vcc_lo, s97
s_cmp_eq_u32 s96, s97
s_cbranch_scc0 L_retry0
L_ret0:
buffer_load_dwordx4 v9, s[20:23], s62 offen lds
v_mfma_f32_16x16x32_bf16 v[228:231], a[44:47], v[132:135], v[228:231]
s_add_u32 m0, s61, 118784
ds_read_b64_tr_b16 a[22:23], v30 offset:6144
v_mfma_f32_16x16x32_bf16 v[228:231], a[48:51], a[192:195], v[228:231]
s_add_u32 s62, s76, 401408
ds_read_b64_tr_b16 a[24:25], v30 offset:8192
v_mfma_f32_16x16x32_bf16 v[228:231], a[52:55], a[204:207], v[228:231]
ds_read_b64_tr_b16 a[26:27], v30 offset:10240
v_mfma_f32_16x16x32_bf16 v[228:231], a[56:59], a[216:219], v[228:231]
buffer_load_dwordx4 v9, s[20:23], s63 offen lds
v_mfma_f32_16x16x32_bf16 v[228:231], a[60:63], a[228:231], v[228:231]
s_waitcnt lgkmcnt(4)
ds_read_b64_tr_b16 a[28:29], v30 offset:12288
v_mfma_f32_16x16x32_bf16 v[208:211], a[0:3], v[136:139], v[208:211]
ds_read_b64_tr_b16 a[30:31], v30 offset:14336
v_mfma_f32_16x16x32_bf16 v[208:211], a[4:7], v[148:151], v[208:211]
ds_read_b64_tr_b16 a[32:33], v29 offset:0
v_mfma_f32_16x16x32_bf16 v[208:211], a[8:11], v[160:163], v[208:211]
ds_read_b64_tr_b16 a[34:35], v29 offset:2048
v_mfma_f32_16x16x32_bf16 v[208:211], a[12:15], v[172:175], v[208:211]
buffer_load_dwordx4 a[112:115], v12, s[28:31], s75 offen offset:0 sc1
v_mfma_f32_16x16x32_bf16 v[208:211], a[16:19], a[64:67], v[208:211]
s_waitcnt lgkmcnt(4)
ds_read_b64_tr_b16 a[36:37], v29 offset:4096
v_mfma_f32_16x16x32_bf16 v[208:211], a[20:23], a[76:79], v[208:211]
ds_read_b64_tr_b16 a[38:39], v29 offset:6144
v_mfma_f32_16x16x32_bf16 v[208:211], a[24:27], a[88:91], v[208:211]
s_waitcnt lgkmcnt(4)
ds_read_b64_tr_b16 a[40:41], v29 offset:8192
v_mfma_f32_16x16x32_bf16 v[208:211], a[28:31], a[100:103], v[208:211]
s_add_u32 m0, s61, 122880
buffer_load_dwordx4 a[116:119], v12, s[28:31], s75 offen offset:1024 sc1
v_mfma_f32_16x16x32_bf16 v[212:215], a[0:3], v[140:143], v[212:215]
s_add_u32 s63, s76, 430080
buffer_load_dwordx4 v9, s[20:23], s62 offen lds
v_mfma_f32_16x16x32_bf16 v[212:215], a[4:7], v[152:155], v[212:215]
s_add_u32 m0, s61, 126976
buffer_load_dwordx4 a[120:123], v12, s[28:31], s75 offen offset:2048 sc1
v_mfma_f32_16x16x32_bf16 v[212:215], a[8:11], v[164:167], v[212:215]
buffer_load_dwordx4 v9, s[20:23], s63 offen lds
v_mfma_f32_16x16x32_bf16 v[212:215], a[12:15], v[176:179], v[212:215]
s_add_u32 s76, s94, 86016
buffer_load_dwordx4 a[124:127], v12, s[28:31], s74 offen offset:0 sc1
v_mfma_f32_16x16x32_bf16 v[212:215], a[16:19], a[68:71], v[212:215]
buffer_load_dwordx4 a[128:131], v12, s[28:31], s74 offen offset:1024 sc1
v_mfma_f32_16x16x32_bf16 v[212:215], a[20:23], a[80:83], v[212:215]
buffer_load_dwordx4 a[132:135], v12, s[28:31], s74 offen offset:2048 sc1
v_mfma_f32_16x16x32_bf16 v[212:215], a[24:27], a[92:95], v[212:215]
buffer_load_dwordx4 a[136:139], v12, s[28:31], s73 offen offset:0 sc1
v_mfma_f32_16x16x32_bf16 v[212:215], a[28:31], a[104:107], v[212:215]
buffer_load_dwordx4 a[140:143], v12, s[28:31], s73 offen offset:1024 sc1
v_mfma_f32_16x16x32_bf16 v[216:219], a[0:3], v[144:147], v[216:219]
buffer_load_dwordx4 a[144:147], v12, s[28:31], s73 offen offset:2048 sc1
v_mfma_f32_16x16x32_bf16 v[216:219], a[4:7], v[156:159], v[216:219]
ds_read_b64_tr_b16 a[42:43], v29 offset:10240
v_cvt_pk_bf16_f32 v44, v208, v209
v_mfma_f32_16x16x32_bf16 v[216:219], a[8:11], v[168:171], v[216:219]
ds_read_b64_tr_b16 a[44:45], v29 offset:12288
v_cvt_pk_bf16_f32 v45, v210, v211
v_mfma_f32_16x16x32_bf16 v[216:219], a[12:15], v[180:183], v[216:219]
ds_read_b64_tr_b16 a[46:47], v29 offset:14336
v_cvt_pk_bf16_f32 v48, v212, v213
v_mfma_f32_16x16x32_bf16 v[216:219], a[16:19], a[72:75], v[216:219]
ds_read_b64_tr_b16 a[48:49], v31 offset:0
v_cvt_pk_bf16_f32 v49, v214, v215
v_mfma_f32_16x16x32_bf16 v[216:219], a[20:23], a[84:87], v[216:219]
ds_read_b64_tr_b16 a[50:51], v31 offset:2048
v_mfma_f32_16x16x32_bf16 v[216:219], a[24:27], a[96:99], v[216:219]
ds_read_b64_tr_b16 a[52:53], v31 offset:4096
v_mfma_f32_16x16x32_bf16 v[216:219], a[28:31], a[108:111], v[216:219]
s_waitcnt lgkmcnt(6)
ds_read_b64_tr_b16 a[54:55], v31 offset:6144
v_mfma_f32_16x16x32_bf16 v[220:223], a[32:35], v[136:139], v[220:223]
ds_read_b64_tr_b16 a[56:57], v31 offset:8192
ds_read_b64_tr_b16 a[58:59], v31 offset:10240
v_mfma_f32_16x16x32_bf16 v[220:223], a[36:39], v[148:151], v[220:223]
s_waitcnt lgkmcnt(7)
ds_read_b64_tr_b16 a[60:61], v31 offset:12288
ds_read_b64_tr_b16 a[62:63], v31 offset:14336
v_mfma_f32_16x16x32_bf16 v[220:223], a[40:43], v[160:163], v[220:223]
s_waitcnt lgkmcnt(8)
v_add_u32 v28, 0x10000, v28
v_add_u32 v29, 0x10000, v29
v_mfma_f32_16x16x32_bf16 v[220:223], a[44:47], v[172:175], v[220:223]
s_waitcnt lgkmcnt(6)
v_add_u32 v30, 0x10000, v30
v_add_u32 v31, 0x10000, v31
v_mfma_f32_16x16x32_bf16 v[220:223], a[48:51], a[64:67], v[220:223]
s_waitcnt lgkmcnt(4)
v_cvt_pk_bf16_f32 v52, v216, v217
v_cvt_pk_bf16_f32 v53, v218, v219
v_mfma_f32_16x16x32_bf16 v[220:223], a[52:55], a[76:79], v[220:223]
s_waitcnt lgkmcnt(2)
v_mfma_f32_16x16x32_bf16 v[220:223], a[56:59], a[88:91], v[220:223]
s_waitcnt lgkmcnt(0)
v_mfma_f32_16x16x32_bf16 v[220:223], a[60:63], a[100:103], v[220:223]
s_waitcnt vmcnt(14)
s_barrier
ds_read_b64_tr_b16 a[0:1], v28 offset:0
v_mfma_f32_16x16x32_bf16 v[224:227], a[32:35], v[140:143], v[224:227]
buffer_store_dwordx2 v[14:15], v13, s[36:39], s90 offen sc1
v_mfma_f32_16x16x32_bf16 v[224:227], a[36:39], v[152:155], v[224:227]
ds_read_b64_tr_b16 a[2:3], v28 offset:2048
v_mfma_f32_16x16x32_bf16 v[224:227], a[40:43], v[164:167], v[224:227]
ds_read_b64_tr_b16 a[4:5], v28 offset:4096
v_cvt_pk_bf16_f32 v46, v220, v221
v_mfma_f32_16x16x32_bf16 v[224:227], a[44:47], v[176:179], v[224:227]
ds_read_b64_tr_b16 a[6:7], v28 offset:6144
v_cvt_pk_bf16_f32 v47, v222, v223
v_mfma_f32_16x16x32_bf16 v[224:227], a[48:51], a[68:71], v[224:227]
buffer_store_dwordx4 v[44:47], v12, s[28:31], s82 offen offset:0 sc1
v_mfma_f32_16x16x32_bf16 v[224:227], a[52:55], a[80:83], v[224:227]
ds_read_b64_tr_b16 a[8:9], v28 offset:8192
v_mfma_f32_16x16x32_bf16 v[224:227], a[56:59], a[92:95], v[224:227]
ds_read_b64_tr_b16 a[10:11], v28 offset:10240
v_mfma_f32_16x16x32_bf16 v[224:227], a[60:63], a[104:107], v[224:227]
ds_read_b64_tr_b16 a[12:13], v28 offset:12288
v_mfma_f32_16x16x32_bf16 v[228:231], a[32:35], v[144:147], v[228:231]
ds_read_b64_tr_b16 a[14:15], v28 offset:14336
v_mfma_f32_16x16x32_bf16 v[228:231], a[36:39], v[156:159], v[228:231]
ds_read_b64_tr_b16 a[16:17], v30 offset:0
v_mfma_f32_16x16x32_bf16 v[228:231], a[40:43], v[168:171], v[228:231]
ds_read_b64_tr_b16 a[18:19], v30 offset:2048
v_cvt_pk_bf16_f32 v50, v224, v225
v_mfma_f32_16x16x32_bf16 v[228:231], a[44:47], v[180:183], v[228:231]
ds_read_b64_tr_b16 a[20:21], v30 offset:4096
v_cvt_pk_bf16_f32 v51, v226, v227
v_mfma_f32_16x16x32_bf16 v[228:231], a[48:51], a[72:75], v[228:231]
ds_read_b64_tr_b16 a[22:23], v30 offset:6144
v_mfma_f32_16x16x32_bf16 v[228:231], a[52:55], a[84:87], v[228:231]
ds_read_b64_tr_b16 a[24:25], v30 offset:8192
v_mfma_f32_16x16x32_bf16 v[228:231], a[56:59], a[96:99], v[228:231]
ds_read_b64_tr_b16 a[26:27], v30 offset:10240
v_mfma_f32_16x16x32_bf16 v[228:231], a[60:63], a[108:111], v[228:231]
s_waitcnt lgkmcnt(6)
ds_read_b64_tr_b16 a[28:29], v30 offset:12288
v_mfma_f32_16x16x32_bf16 v[184:187], a[0:3], v[88:91], 0
ds_read_b64_tr_b16 a[30:31], v30 offset:14336
v_mfma_f32_16x16x32_bf16 v[184:187], a[4:7], v[100:103], v[184:187]
buffer_store_dwordx4 v[48:51], v12, s[28:31], s82 offen offset:1024 sc1
v_mfma_f32_16x16x32_bf16 v[184:187], a[8:11], v[112:115], v[184:187]
ds_read_b64_tr_b16 a[32:33], v29 offset:0
v_cvt_pk_bf16_f32 v54, v228, v229
v_mfma_f32_16x16x32_bf16 v[184:187], a[12:15], v[124:127], v[184:187]
s_waitcnt lgkmcnt(5)
ds_read_b64_tr_b16 a[34:35], v29 offset:2048
v_cvt_pk_bf16_f32 v55, v230, v231
v_mfma_f32_16x16x32_bf16 v[184:187], a[16:19], a[184:187], v[184:187]
ds_read_b64_tr_b16 a[36:37], v29 offset:4096
v_mfma_f32_16x16x32_bf16 v[184:187], a[20:23], a[196:199], v[184:187]
s_waitcnt lgkmcnt(5)
ds_read_b64_tr_b16 a[38:39], v29 offset:6144
v_mfma_f32_16x16x32_bf16 v[184:187], a[24:27], a[208:211], v[184:187]
s_waitcnt lgkmcnt(4)
ds_read_b64_tr_b16 a[40:41], v29 offset:8192
v_mfma_f32_16x16x32_bf16 v[184:187], a[28:31], a[220:223], v[184:187]
buffer_store_dwordx4 v[52:55], v12, s[28:31], s82 offen offset:2048 sc1
v_mfma_f32_16x16x32_bf16 v[188:191], a[0:3], v[92:95], 0
ds_read_b64_tr_b16 a[42:43], v29 offset:10240
v_mfma_f32_16x16x32_bf16 v[188:191], a[4:7], v[104:107], v[188:191]
ds_read_b64_tr_b16 a[44:45], v29 offset:12288
v_mfma_f32_16x16x32_bf16 v[188:191], a[8:11], v[116:119], v[188:191]
ds_read_b64_tr_b16 a[46:47], v29 offset:14336
v_mfma_f32_16x16x32_bf16 v[188:191], a[12:15], v[128:131], v[188:191]
ds_read_b64_tr_b16 a[48:49], v31 offset:0
v_mfma_f32_16x16x32_bf16 v[188:191], a[16:19], a[188:191], v[188:191]
ds_read_b64_tr_b16 a[50:51], v31 offset:2048
v_mfma_f32_16x16x32_bf16 v[188:191], a[20:23], a[200:203], v[188:191]
ds_read_b64_tr_b16 a[52:53], v31 offset:4096
v_mfma_f32_16x16x32_bf16 v[188:191], a[24:27], a[212:215], v[188:191]
ds_read_b64_tr_b16 a[54:55], v31 offset:6144
v_mfma_f32_16x16x32_bf16 v[188:191], a[28:31], a[224:227], v[188:191]
ds_read_b64_tr_b16 a[56:57], v31 offset:8192
v_mfma_f32_16x16x32_bf16 v[192:195], a[0:3], v[96:99], 0
ds_read_b64_tr_b16 a[58:59], v31 offset:10240
v_mfma_f32_16x16x32_bf16 v[192:195], a[4:7], v[108:111], v[192:195]
ds_read_b64_tr_b16 a[60:61], v31 offset:12288
v_mfma_f32_16x16x32_bf16 v[192:195], a[8:11], v[120:123], v[192:195]
ds_read_b64_tr_b16 a[62:63], v31 offset:14336
v_add_u32 v28, 0xffff8000, v28
v_mfma_f32_16x16x32_bf16 v[192:195], a[12:15], v[132:135], v[192:195]
v_add_u32 v29, 0xffff8000, v29
v_add_u32 v30, 0xffff8000, v30
v_mfma_f32_16x16x32_bf16 v[192:195], a[16:19], a[192:195], v[192:195]
v_add_u32 v31, 0xffff8000, v31
v_mfma_f32_16x16x32_bf16 v[192:195], a[20:23], a[204:207], v[192:195]
v_mfma_f32_16x16x32_bf16 v[192:195], a[24:27], a[216:219], v[192:195]
v_mfma_f32_16x16x32_bf16 v[192:195], a[28:31], a[228:231], v[192:195]
s_waitcnt lgkmcnt(2)
v_mfma_f32_16x16x32_bf16 v[196:199], a[32:35], v[88:91], 0
s_waitcnt vmcnt(10) lgkmcnt(0)
s_barrier
v_mfma_f32_16x16x32_bf16 v[196:199], a[36:39], v[100:103], v[196:199]
ds_read_b64_tr_b16 a[0:1], v28 offset:0
v_mfma_f32_16x16x32_bf16 v[196:199], a[40:43], v[112:115], v[196:199]
buffer_load_dwordx2 v[86:87], v3, s[36:39], s95 offen sc1
v_mfma_f32_16x16x32_bf16 v[196:199], a[44:47], v[124:127], v[196:199]
ds_read_b64_tr_b16 a[2:3], v28 offset:2048
v_mfma_f32_16x16x32_bf16 v[196:199], a[48:51], a[184:187], v[196:199]
ds_read_b64_tr_b16 a[4:5], v28 offset:4096
v_mfma_f32_16x16x32_bf16 v[196:199], a[52:55], a[196:199], v[196:199]
ds_read_b64_tr_b16 a[6:7], v28 offset:6144
v_mfma_f32_16x16x32_bf16 v[196:199], a[56:59], a[208:211], v[196:199]
ds_read_b64_tr_b16 a[8:9], v28 offset:8192
v_mfma_f32_16x16x32_bf16 v[196:199], a[60:63], a[220:223], v[196:199]
ds_read_b64_tr_b16 a[10:11], v28 offset:10240
v_mfma_f32_16x16x32_bf16 v[200:203], a[32:35], v[92:95], 0
ds_read_b64_tr_b16 a[12:13], v28 offset:12288
v_mfma_f32_16x16x32_bf16 v[200:203], a[36:39], v[104:107], v[200:203]
ds_read_b64_tr_b16 a[14:15], v28 offset:14336
v_mfma_f32_16x16x32_bf16 v[200:203], a[40:43], v[116:119], v[200:203]
ds_read_b64_tr_b16 a[16:17], v30 offset:0
v_mfma_f32_16x16x32_bf16 v[200:203], a[44:47], v[128:131], v[200:203]
ds_read_b64_tr_b16 a[18:19], v30 offset:2048
v_mfma_f32_16x16x32_bf16 v[200:203], a[48:51], a[188:191], v[200:203]
ds_read_b64_tr_b16 a[20:21], v30 offset:4096
v_mfma_f32_16x16x32_bf16 v[200:203], a[52:55], a[200:203], v[200:203]
ds_read_b64_tr_b16 a[22:23], v30 offset:6144
v_mfma_f32_16x16x32_bf16 v[200:203], a[56:59], a[212:215], v[200:203]
ds_read_b64_tr_b16 a[24:25], v30 offset:8192
v_mfma_f32_16x16x32_bf16 v[200:203], a[60:63], a[224:227], v[200:203]
ds_read_b64_tr_b16 a[26:27], v30 offset:10240
v_mfma_f32_16x16x32_bf16 v[204:207], a[32:35], v[96:99], 0
ds_read_b64_tr_b16 a[28:29], v30 offset:12288
v_mfma_f32_16x16x32_bf16 v[204:207], a[36:39], v[108:111], v[204:207]
ds_read_b64_tr_b16 a[30:31], v30 offset:14336
v_mfma_f32_16x16x32_bf16 v[204:207], a[40:43], v[120:123], v[204:207]
ds_read_b64_tr_b16 a[32:33], v29 offset:0
v_mfma_f32_16x16x32_bf16 v[204:207], a[44:47], v[132:135], v[204:207]
ds_read_b64_tr_b16 a[34:35], v29 offset:2048
v_mfma_f32_16x16x32_bf16 v[204:207], a[48:51], a[192:195], v[204:207]
ds_read_b64_tr_b16 a[36:37], v29 offset:4096
v_mfma_f32_16x16x32_bf16 v[204:207], a[52:55], a[204:207], v[204:207]
ds_read_b64_tr_b16 a[38:39], v29 offset:6144
v_mfma_f32_16x16x32_bf16 v[204:207], a[56:59], a[216:219], v[204:207]
ds_read_b64_tr_b16 a[40:41], v29 offset:8192
v_mfma_f32_16x16x32_bf16 v[204:207], a[60:63], a[228:231], v[204:207]
s_waitcnt lgkmcnt(6)
ds_read_b64_tr_b16 a[42:43], v29 offset:10240
v_mfma_f32_16x16x32_bf16 v[184:187], a[0:3], v[136:139], v[184:187]
ds_read_b64_tr_b16 a[44:45], v29 offset:12288
v_mfma_f32_16x16x32_bf16 v[184:187], a[4:7], v[148:151], v[184:187]
ds_read_b64_tr_b16 a[46:47], v29 offset:14336
v_mfma_f32_16x16x32_bf16 v[184:187], a[8:11], v[160:163], v[184:187]
ds_read_b64_tr_b16 a[48:49], v31 offset:0
v_mfma_f32_16x16x32_bf16 v[184:187], a[12:15], v[172:175], v[184:187]
ds_read_b64_tr_b16 a[50:51], v31 offset:2048
v_mfma_f32_16x16x32_bf16 v[184:187], a[16:19], a[64:67], v[184:187]
ds_read_b64_tr_b16 a[52:53], v31 offset:4096
v_mfma_f32_16x16x32_bf16 v[184:187], a[20:23], a[76:79], v[184:187]
ds_read_b64_tr_b16 a[54:55], v31 offset:6144
v_mfma_f32_16x16x32_bf16 v[184:187], a[24:27], a[88:91], v[184:187]
s_waitcnt lgkmcnt(6)
ds_read_b64_tr_b16 a[56:57], v31 offset:8192
v_mfma_f32_16x16x32_bf16 v[184:187], a[28:31], a[100:103], v[184:187]
ds_read_b64_tr_b16 a[58:59], v31 offset:10240
v_mfma_f32_16x16x32_bf16 v[188:191], a[0:3], v[140:143], v[188:191]
ds_read_b64_tr_b16 a[60:61], v31 offset:12288
v_mfma_f32_16x16x32_bf16 v[188:191], a[4:7], v[152:155], v[188:191]
ds_read_b64_tr_b16 a[62:63], v31 offset:14336
v_mfma_f32_16x16x32_bf16 v[188:191], a[8:11], v[164:167], v[188:191]
v_mfma_f32_16x16x32_bf16 v[188:191], a[12:15], v[176:179], v[188:191]
v_mfma_f32_16x16x32_bf16 v[188:191], a[16:19], a[68:71], v[188:191]
s_waitcnt vmcnt(1)
s_barrier
v_mfma_f32_16x16x32_bf16 v[188:191], a[20:23], a[80:83], v[188:191]
buffer_store_dwordx2 v[14:15], v13, s[36:39], s91 offen sc1
v_mfma_f32_16x16x32_bf16 v[188:191], a[24:27], a[92:95], v[188:191]
v_mfma_f32_16x16x32_bf16 v[188:191], a[28:31], a[104:107], v[188:191]
v_mfma_f32_16x16x32_bf16 v[192:195], a[0:3], v[144:147], v[192:195]
v_mfma_f32_16x16x32_bf16 v[192:195], a[4:7], v[156:159], v[192:195]
v_mfma_f32_16x16x32_bf16 v[192:195], a[8:11], v[168:171], v[192:195]
s_waitcnt vmcnt(1)
v_cmp_eq_u64 vcc, v[86:87], v[14:15]
v_mfma_f32_16x16x32_bf16 v[192:195], a[12:15], v[180:183], v[192:195]
buffer_load_dwordx2 v[84:85], v3, s[36:39], s95 offen sc1
v_mfma_f32_16x16x32_bf16 v[192:195], a[16:19], a[72:75], v[192:195]
v_mfma_f32_16x16x32_bf16 v[192:195], a[20:23], a[84:87], v[192:195]
s_bfe_u32 s97, s3, 0x80008
s_and_b32 s96, vcc_lo, s97
s_cmp_eq_u32 s96, s97
s_cbranch_scc0 L_retry1
L_ret1:
v_mfma_f32_16x16x32_bf16 v[192:195], a[24:27], a[96:99], v[192:195]
buffer_load_dwordx4 a[148:151], v12, s[28:31], s72 offen offset:0 sc1
v_mfma_f32_16x16x32_bf16 v[192:195], a[28:31], a[108:111], v[192:195]
buffer_load_dwordx4 a[152:155], v12, s[28:31], s72 offen offset:1024 sc1
v_mfma_f32_16x16x32_bf16 v[196:199], a[32:35], v[136:139], v[196:199]
v_mfma_f32_16x16x32_bf16 v[196:199], a[36:39], v[148:151], v[196:199]
v_mfma_f32_16x16x32_bf16 v[196:199], a[40:43], v[160:163], v[196:199]
s_waitcnt lgkmcnt(0)
buffer_load_dwordx4 a[156:159], v12, s[28:31], s72 offen offset:2048 sc1
v_mfma_f32_16x16x32_bf16 v[196:199], a[44:47], v[172:175], v[196:199]
v_mfma_f32_16x16x32_bf16 v[196:199], a[48:51], a[64:67], v[196:199]
v_mfma_f32_16x16x32_bf16 v[196:199], a[52:55], a[76:79], v[196:199]
v_mfma_f32_16x16x32_bf16 v[196:199], a[56:59], a[88:91], v[196:199]
v_mfma_f32_16x16x32_bf16 v[196:199], a[60:63], a[100:103], v[196:199]
buffer_load_dwordx4 a[160:163], v12, s[28:31], s71 offen offset:0 sc1
v_mfma_f32_16x16x32_bf16 v[200:203], a[32:35], v[140:143], v[200:203]
v_mfma_f32_16x16x32_bf16 v[200:203], a[36:39], v[152:155], v[200:203]
v_mfma_f32_16x16x32_bf16 v[200:203], a[40:43], v[164:167], v[200:203]
v_mfma_f32_16x16x32_bf16 v[200:203], a[44:47], v[176:179], v[200:203]
buffer_load_dwordx4 a[164:167], v12, s[28:31], s71 offen offset:1024 sc1
v_mfma_f32_16x16x32_bf16 v[200:203], a[48:51], a[68:71], v[200:203]
v_mfma_f32_16x16x32_bf16 v[200:203], a[52:55], a[80:83], v[200:203]
v_mfma_f32_16x16x32_bf16 v[200:203], a[56:59], a[92:95], v[200:203]
buffer_load_dwordx4 a[168:171], v12, s[28:31], s71 offen offset:2048 sc1
v_mfma_f32_16x16x32_bf16 v[200:203], a[60:63], a[104:107], v[200:203]
v_mfma_f32_16x16x32_bf16 v[204:207], a[32:35], v[144:147], v[204:207]
v_mfma_f32_16x16x32_bf16 v[204:207], a[36:39], v[156:159], v[204:207]
v_mfma_f32_16x16x32_bf16 v[204:207], a[40:43], v[168:171], v[204:207]
v_mfma_f32_16x16x32_bf16 v[204:207], a[44:47], v[180:183], v[204:207]
v_mfma_f32_16x16x32_bf16 v[204:207], a[48:51], a[72:75], v[204:207]
v_mfma_f32_16x16x32_bf16 v[204:207], a[52:55], a[84:87], v[204:207]
v_mfma_f32_16x16x32_bf16 v[204:207], a[56:59], a[96:99], v[204:207]
v_mfma_f32_16x16x32_bf16 v[204:207], a[60:63], a[108:111], v[204:207]
s_cmp_eq_u32 s60, 7
s_cbranch_scc1 L_x_lastsend
v_mfma_f32_16x16x32_bf16 v[184:187], v[58:61], a[112:115], v[184:187]
v_mfma_f32_16x16x32_bf16 v[196:199], v[56:59], a[112:115], v[196:199]
v_mfma_f32_16x16x32_bf16 v[188:191], v[58:61], a[116:119], v[188:191]
v_mfma_f32_16x16x32_bf16 v[200:203], v[56:59], a[116:119], v[200:203]
v_mfma_f32_16x16x32_bf16 v[192:195], v[58:61], a[120:123], v[192:195]
v_mfma_f32_16x16x32_bf16 v[204:207], v[56:59], a[120:123], v[204:207]
v_mfma_f32_16x16x32_bf16 v[184:187], v[58:61], a[124:127], v[184:187]
s_waitcnt vmcnt(6)
v_cmp_eq_u64 vcc, v[84:85], v[14:15]
v_mfma_f32_16x16x32_bf16 v[196:199], v[56:59], a[124:127], v[196:199]
v_mfma_f32_16x16x32_bf16 v[188:191], v[58:61], a[128:131], v[188:191]
v_mfma_f32_16x16x32_bf16 v[200:203], v[56:59], a[128:131], v[200:203]
v_mfma_f32_16x16x32_bf16 v[192:195], v[58:61], a[132:135], v[192:195]
s_bfe_u32 s97, s3, 0x80010
s_and_b32 s96, vcc_lo, s97
s_cmp_eq_u32 s96, s97
s_cbranch_scc0 L_retry2
L_ret2:
buffer_load_dwordx4 a[172:175], v12, s[28:31], s70 offen offset:0 sc1
v_mfma_f32_16x16x32_bf16 v[204:207], v[56:59], a[132:135], v[204:207]
buffer_load_dwordx4 a[176:179], v12, s[28:31], s70 offen offset:1024 sc1
v_mfma_f32_16x16x32_bf16 v[184:187], v[58:61], a[136:139], v[184:187]
buffer_load_dwordx4 a[180:183], v12, s[28:31], s70 offen offset:2048 sc1
v_mfma_f32_16x16x32_bf16 v[196:199], v[56:59], a[136:139], v[196:199]
buffer_load_dwordx4 a[232:235], v12, s[28:31], s76 offen offset:0 sc1
v_mfma_f32_16x16x32_bf16 v[188:191], v[58:61], a[140:143], v[188:191]
buffer_load_dwordx4 a[236:239], v12, s[28:31], s76 offen offset:1024 sc1
v_mfma_f32_16x16x32_bf16 v[200:203], v[56:59], a[140:143], v[200:203]
buffer_load_dwordx4 a[240:243], v12, s[28:31], s76 offen offset:2048 sc1
v_mfma_f32_16x16x32_bf16 v[192:195], v[58:61], a[144:147], v[192:195]
v_mfma_f32_16x16x32_bf16 v[204:207], v[56:59], a[144:147], v[204:207]
s_waitcnt vmcnt(11)
v_mfma_f32_16x16x32_bf16 v[184:187], v[58:61], a[148:151], v[184:187]
v_mfma_f32_16x16x32_bf16 v[196:199], v[56:59], a[148:151], v[196:199]
s_waitcnt vmcnt(10)
v_mfma_f32_16x16x32_bf16 v[188:191], v[58:61], a[152:155], v[188:191]
v_mfma_f32_16x16x32_bf16 v[200:203], v[56:59], a[152:155], v[200:203]
s_waitcnt vmcnt(9)
v_mfma_f32_16x16x32_bf16 v[192:195], v[58:61], a[156:159], v[192:195]
v_mfma_f32_16x16x32_bf16 v[204:207], v[56:59], a[156:159], v[204:207]
s_waitcnt vmcnt(8)
v_mfma_f32_16x16x32_bf16 v[184:187], v[58:61], a[160:163], v[184:187]
v_mfma_f32_16x16x32_bf16 v[196:199], v[56:59], a[160:163], v[196:199]
s_waitcnt vmcnt(7)
v_mfma_f32_16x16x32_bf16 v[188:191], v[58:61], a[164:167], v[188:191]
v_mfma_f32_16x16x32_bf16 v[200:203], v[56:59], a[164:167], v[200:203]
s_waitcnt vmcnt(6)
v_mfma_f32_16x16x32_bf16 v[192:195], v[58:61], a[168:171], v[192:195]
v_mfma_f32_16x16x32_bf16 v[204:207], v[56:59], a[168:171], v[204:207]
s_waitcnt vmcnt(5)
v_mfma_f32_16x16x32_bf16 v[184:187], v[58:61], a[172:175], v[184:187]
v_mfma_f32_16x16x32_bf16 v[196:199], v[56:59], a[172:175], v[196:199]
s_waitcnt vmcnt(4)
v_mfma_f32_16x16x32_bf16 v[188:191], v[58:61], a[176:179], v[188:191]
v_mfma_f32_16x16x32_bf16 v[200:203], v[56:59], a[176:179], v[200:203]
s_waitcnt vmcnt(3)
v_mfma_f32_16x16x32_bf16 v[192:195], v[58:61], a[180:183], v[192:195]
v_mfma_f32_16x16x32_bf16 v[204:207], v[56:59], a[180:183], v[204:207]
s_waitcnt vmcnt(2)
v_mfma_f32_16x16x32_bf16 v[184:187], v[58:61], a[232:235], v[184:187]
v_mfma_f32_16x16x32_bf16 v[196:199], v[56:59], a[232:235], v[196:199]
s_waitcnt vmcnt(1)
v_mfma_f32_16x16x32_bf16 v[188:191], v[58:61], a[236:239], v[188:191]
v_mfma_f32_16x16x32_bf16 v[200:203], v[56:59], a[236:239], v[200:203]
s_waitcnt vmcnt(0)
v_mfma_f32_16x16x32_bf16 v[192:195], v[58:61], a[240:243], v[192:195]
v_mfma_f32_16x16x32_bf16 v[204:207], v[56:59], a[240:243], v[204:207]
v_cvt_pk_bf16_f32 v68, v184, v185
v_cvt_pk_bf16_f32 v69, v186, v187
buffer_store_dwordx2 v[68:69], v82, s[24:27], 0 offen offset:0
v_cvt_pk_bf16_f32 v70, v196, v197
v_cvt_pk_bf16_f32 v71, v198, v199
buffer_store_dwordx2 v[70:71], v82, s[24:27], 0 offen offset:32
v_cvt_pk_bf16_f32 v72, v188, v189
v_cvt_pk_bf16_f32 v73, v190, v191
buffer_store_dwordx2 v[72:73], v82, s[24:27], s64 offen offset:0
v_cvt_pk_bf16_f32 v74, v200, v201
v_cvt_pk_bf16_f32 v75, v202, v203
buffer_store_dwordx2 v[74:75], v82, s[24:27], s64 offen offset:32
v_cvt_pk_bf16_f32 v76, v192, v193
v_cvt_pk_bf16_f32 v77, v194, v195
buffer_store_dwordx2 v[76:77], v82, s[24:27], s65 offen offset:0
v_cvt_pk_bf16_f32 v78, v204, v205
v_cvt_pk_bf16_f32 v79, v206, v207
buffer_store_dwordx2 v[78:79], v82, s[24:27], s65 offen offset:32
s_endpgm
L_x_lastsend:
s_nop 7
v_cvt_pk_bf16_f32 v68, v184, v185
v_cvt_pk_bf16_f32 v69, v186, v187
v_cvt_pk_bf16_f32 v70, v196, v197
v_cvt_pk_bf16_f32 v71, v198, v199
buffer_store_dwordx4 v[68:71], v12, s[28:31], s83 offen offset:0 sc1
v_cvt_pk_bf16_f32 v72, v188, v189
v_cvt_pk_bf16_f32 v73, v190, v191
v_cvt_pk_bf16_f32 v74, v200, v201
v_cvt_pk_bf16_f32 v75, v202, v203
buffer_store_dwordx4 v[72:75], v12, s[28:31], s83 offen offset:1024 sc1
v_cvt_pk_bf16_f32 v76, v192, v193
v_cvt_pk_bf16_f32 v77, v194, v195
v_cvt_pk_bf16_f32 v78, v204, v205
v_cvt_pk_bf16_f32 v79, v206, v207
buffer_store_dwordx4 v[76:79], v12, s[28:31], s83 offen offset:2048 sc1
s_waitcnt vmcnt(0)
s_barrier
buffer_store_dwordx2 v[14:15], v13, s[36:39], s92 offen sc1
L_end:
s_endpgm
L_restart:
s_waitcnt vmcnt(0) lgkmcnt(0)
s_nop 15
s_barrier
s_mov_b32 s68, 1
s_xor_b32 s60, s60, 3
v_lshrrev_b32 v83, 3, v0
v_bfe_u32 v84, v0, 4, 3
v_and_b32 v85, 7, v0
v_xor_b32 v84, v84, v85
v_mul_u32_u24 v83, 896, v83
v_lshl_add_u32 v4, v84, 4, v83
s_mul_i32 s94, s59, 86016
s_add_u32 s4, s40, s94
s_addc_u32 s5, s41, 0
s_mov_b32 s6, 86016
s_mov_b32 s7, 0x00020000
s_branch L_start
L_retry0:
s_mov_b32 s67, 0
L_retry0b:
buffer_load_dwordx2 v[84:85], v3, s[36:39], s95 offen sc1
s_waitcnt vmcnt(0)
v_cmp_eq_u64 vcc, v[84:85], v[14:15]
s_add_u32 s67, s67, 1
s_nop 3
s_and_b32 s96, vcc_lo, s97
s_cmp_eq_u32 s96, s97
s_cbranch_scc1 L_ret0
s_cmp_lt_u32 s67, 0x40000
s_cbranch_scc1 L_retry0b
s_branch L_ret0
L_retry1:
s_mov_b32 s67, 0
L_retry1b:
buffer_load_dwordx2 v[86:87], v3, s[36:39], s95 offen sc1
s_waitcnt vmcnt(0)
v_cmp_eq_u64 vcc, v[86:87], v[14:15]
s_add_u32 s67, s67, 1
s_nop 3
s_and_b32 s96, vcc_lo, s97
s_cmp_eq_u32 s96, s97
s_cbranch_scc1 L_ret1
s_cmp_lt_u32 s67, 0x40000
s_cbranch_scc1 L_retry1b
s_branch L_ret1
L_retry2:
s_mov_b32 s67, 0
L_retry2b:
buffer_load_dwordx2 v[84:85], v3, s[36:39], s95 offen sc1
s_waitcnt vmcnt(0)
v_cmp_eq_u64 vcc, v[84:85], v[14:15]
s_add_u32 s67, s67, 1
s_nop 3
s_and_b32 s96, vcc_lo, s97
s_cmp_eq_u32 s96, s97
s_cbranch_scc1 L_ret2
s_cmp_lt_u32 s67, 0x40000
s_cbranch_scc1 L_retry2b
s_branch L_ret2
L_maxpass:
s_nop 7
v_and_b32 v1, 15, v2
v_lshrrev_b32 v3, 4, v2
v_lshlrev_b32 v1, 9, v1
v_lshl_add_u32 v1, v3, 4, v1
s_mov_b32 s97, 0
L_maxloop:
buffer_load_dwordx4 a[96:99], v1, s[12:15], s97 offen offset:0
buffer_load_dwordx4 a[100:103], v1, s[12:15], s97 offen offset:64
buffer_load_dwordx4 a[104:107], v1, s[12:15], s97 offen offset:128
buffer_load_dwordx4 a[108:111], v1, s[12:15], s97 offen offset:192
buffer_load_dwordx4 a[112:115], v1, s[12:15], s97 offen offset:256
buffer_load_dwordx4 a[116:119], v1, s[12:15], s97 offen offset:320
buffer_load_dwordx4 a[120:123], v1, s[12:15], s97 offen offset:384
buffer_load_dwordx4 a[124:127], v1, s[12:15], s97 offen offset:448
s_waitcnt vmcnt(0)
v_mfma_f32_16x16x32_bf16 v[232:235], a[96:99], v[88:91], 0
v_mfma_f32_16x16x32_bf16 v[232:235], a[100:103], v[100:103], v[232:235]
v_mfma_f32_16x16x32_bf16 v[232:235], a[104:107], v[112:115], v[232:235]
v_mfma_f32_16x16x32_bf16 v[232:235], a[108:111], v[124:127], v[232:235]
v_mfma_f32_16x16x32_bf16 v[232:235], a[112:115], v[136:139], v[232:235]
v_mfma_f32_16x16x32_bf16 v[232:235], a[116:119], v[148:151], v[232:235]
v_mfma_f32_16x16x32_bf16 v[232:235], a[120:123], v[160:163], v[232:235]
v_mfma_f32_16x16x32_bf16 v[232:235], a[124:127], v[172:175], v[232:235]
v_mfma_f32_16x16x32_bf16 v[236:239], a[96:99], v[92:95], 0
v_mfma_f32_16x16x32_bf16 v[236:239], a[100:103], v[104:107], v[236:239]
v_mfma_f32_16x16x32_bf16 v[236:239], a[104:107], v[116:119], v[236:239]
v_mfma_f32_16x16x32_bf16 v[236:239], a[108:111], v[128:131], v[236:239]
v_mfma_f32_16x16x32_bf16 v[236:239], a[112:115], v[140:143], v[236:239]
v_mfma_f32_16x16x32_bf16 v[236:239], a[116:119], v[152:155], v[236:239]
v_mfma_f32_16x16x32_bf16 v[236:239], a[120:123], v[164:167], v[236:239]
v_mfma_f32_16x16x32_bf16 v[236:239], a[124:127], v[176:179], v[236:239]
v_mfma_f32_16x16x32_bf16 v[240:243], a[96:99], v[96:99], 0
v_mfma_f32_16x16x32_bf16 v[240:243], a[100:103], v[108:111], v[240:243]
v_mfma_f32_16x16x32_bf16 v[240:243], a[104:107], v[120:123], v[240:243]
v_mfma_f32_16x16x32_bf16 v[240:243], a[108:111], v[132:135], v[240:243]
v_mfma_f32_16x16x32_bf16 v[240:243], a[112:115], v[144:147], v[240:243]
v_mfma_f32_16x16x32_bf16 v[240:243], a[116:119], v[156:159], v[240:243]
v_mfma_f32_16x16x32_bf16 v[240:243], a[120:123], v[168:171], v[240:243]
v_mfma_f32_16x16x32_bf16 v[240:243], a[124:127], v[180:183], v[240:243]
s_nop 15
v_max3_f32 v84, v84, v232, v233
v_max3_f32 v84, v84, v234, v235
v_max3_f32 v85, v85, v236, v237
v_max3_f32 v85, v85, v238, v239
v_max3_f32 v86, v86, v240, v241
v_max3_f32 v86, v86, v242, v243
s_add_u32 s97, s97, 8192
s_cmp_lt_u32 s97, 262144
s_cbranch_scc1 L_maxloop
s_nop 7
s_branch L_maxret
L_codeend:
.section .rodata,"a"
.p2align 6
.amdhsa_kernel standalone__gqa_block_cached__near_ridge_kernel
  .amdhsa_next_free_vgpr 512
  .amdhsa_next_free_sgpr 102
  .amdhsa_accum_offset 256
  .amdhsa_group_segment_fixed_size 0
  .amdhsa_kernarg_size 64
  .amdhsa_user_sgpr_count 2
  .amdhsa_user_sgpr_kernarg_segment_ptr 1
  .amdhsa_system_sgpr_workgroup_id_x 1
.end_amdhsa_kernel
```
